```python
import torch

def _softmax(x, axis=-1):
    return torch.softmax(x, dim=axis)
def _gelu(x):
    return torch.nn.functional.gelu(x, approximate="tanh")
def _silu(x):
    return torch.nn.functional.silu(x)
def _sigmoid(x):
    return torch.sigmoid(x)
def _layernorm(x, axis=-1, eps=1e-5):
    m = x.mean(dim=axis, keepdim=True)
    v = x.var(dim=axis, keepdim=True, unbiased=False)
    return (x - m) / torch.sqrt(v + eps)
def _scatter_add(tgt, idx, src, axis=0):
    return tgt.clone().index_add_(axis, idx, src)
def _segment_sum(src, seg, n):
    out = torch.zeros((n,) + src.shape[1:], dtype=src.dtype)
    return out.index_add_(0, seg, src)
def _pad(x, pw):
    flat = tuple(v for pair in reversed(pw) for v in pair)
    return torch.nn.functional.pad(x, flat)

kernel_name = 'concat_heads__ssm_conv_s4__spectral_gfnet__prompt'

def setup_inputs():

    _w = (lambda a: (lambda t: t.to(torch.bfloat16) if t.is_floating_point() else t)(torch.as_tensor(a)))
    def _A_setup():
        B, L, D, N = 1, 2048, 512, 128
        A_re = -(lambda _x: torch.exp(torch.as_tensor(_x)))((lambda *s: torch.randn(*s, dtype=torch.bfloat16) * 6.4)(D, N))
        A_im = torch.pi * (lambda *s: torch.randn(*s, dtype=torch.bfloat16) * 0.05)(D, N)
        B_re = (lambda *s: torch.randn(*s, dtype=torch.bfloat16) * 0.1)(D, N)
        B_im = (lambda *s: torch.randn(*s, dtype=torch.bfloat16) * 0.1)(D, N)
        C_re = (lambda *s: torch.randn(*s, dtype=torch.bfloat16) * 0.1)(D, N)
        C_im = (lambda *s: torch.randn(*s, dtype=torch.bfloat16) * 0.1)(D, N)
        log_dt = (lambda *s: torch.randn(*s, dtype=torch.bfloat16) * 0.05)(D) * 0.5 - 4.0
        Dskip = (lambda *s: torch.randn(*s, dtype=torch.bfloat16) * 0.05)(D)
        return {
            "u": _w((lambda *s: torch.randn(*s, dtype=torch.bfloat16) * 0.05)(B, L, D)),
            "A_re": _w(A_re),
            "A_im": _w(A_im),
            "B_re": _w(B_re),
            "B_im": _w(B_im),
            "C_re": _w(C_re),
            "C_im": _w(C_im),
            "log_dt": _w(log_dt),
            "Dskip": _w(Dskip),
        }
    _A_in = _A_setup()

    def _B_setup():
        B, S, D = 1, 2048, 512
        Df = D // 2 + 1
        return {
            "x": _w((lambda *s: torch.randn(*s, dtype=torch.bfloat16) * 0.05)(B, S, D)),
            "w_r": _w((lambda *s: torch.randn(*s, dtype=torch.bfloat16) * 1.6)(S, Df) * 0.02),
            "w_i": _w((lambda *s: torch.randn(*s, dtype=torch.bfloat16) * 1.6)(S, Df) * 0.02),
        }
    _B_in = _B_setup()

    return {
        "A_u": _A_in["u"],
        "A_A_re": _A_in["A_re"],
        "A_A_im": _A_in["A_im"],
        "A_B_re": _A_in["B_re"],
        "A_B_im": _A_in["B_im"],
        "A_C_re": _A_in["C_re"],
        "A_C_im": _A_in["C_im"],
        "A_log_dt": _A_in["log_dt"],
        "A_Dskip": _A_in["Dskip"],
        "B_x": _B_in["x"],
        "B_w_r": _B_in["w_r"],
        "B_w_i": _B_in["w_i"],
    }

def reference(A_u, A_A_re, A_A_im, A_B_re, A_B_im, A_C_re, A_C_im, A_log_dt, A_Dskip, B_x, B_w_r, B_w_i):
    def _A_ref(u, A_re, A_im, B_re, B_im, C_re, C_im, log_dt, Dskip):
        Bsz, L, D = u.shape
        dt = torch.exp(log_dt)[:, None]
        A = A_re + 1j * A_im
        Bc = B_re + 1j * B_im
        Cc = C_re + 1j * C_im
        logdA = dt * A
        dB = dt * Bc
        l = (lambda x, dt: x.to(dt))(torch.arange(L), A_re.dtype)
        P = torch.exp(logdA[:, :, None] * l[None, None, :])
        K = torch.einsum("dn,dnl,dn->dl", Cc, P, dB).real
        L2 = 2 * L
        Kp = _pad(K, ((0, 0), (0, L)))
        up = (lambda x, *d: x.permute(*d))(u, 0, 2, 1)
        up = _pad(up, ((0, 0), (0, 0), (0, L)))
        Kf = (lambda x, axes=(-2,-1): torch.fft.rfft2(x.float(), dim=axes))(Kp[:, None, :], axes=(-2, -1))
        Uf = (lambda x, axes=(-2,-1): torch.fft.rfft2(x.float(), dim=axes))(up[:, :, None, :], axes=(-2, -1))
        Yf = Uf * Kf[None, :, :, :]
        y = (lambda x, s, axes=(-2,-1): torch.fft.irfft2(x, s=s, dim=axes).to(torch.bfloat16))(Yf, (1, L2), axes=(-2, -1))[:, :, 0, :L]
        y = (lambda x, *d: x.permute(*d))(y, 0, 2, 1) + u * Dskip[None, None, :]
        return y

    def _B_ref(x, w_r, w_i):
        B, S, D = x.shape
        X = (lambda x, axes=(-2,-1): torch.fft.rfft2(x.float(), dim=axes))(x, axes=(-2, -1))
        W = w_r + 1j * w_i
        X = X * W
        y = (lambda x, s, axes=(-2,-1): torch.fft.irfft2(x, s=s, dim=axes).to(torch.bfloat16))(X, (S, D), axes=(-2, -1))
        return y

    a = _A_ref(A_u, A_A_re, A_A_im, A_B_re, A_B_im, A_C_re, A_C_im, A_log_dt, A_Dskip)
    b = _B_ref(B_x, B_w_r, B_w_i)
    return torch.concatenate([a, b], axis=-1)
```

```asm
; @launch grid=(256,1,1) block=(512,1,1) lds=159744
.amdgcn_target "amdgcn-amd-amdhsa--gfx950"
.text
.globl concat_heads__ssm_conv_s4__spectral_gfnet__prompt_kernel
.p2align 8
.type concat_heads__ssm_conv_s4__spectral_gfnet__prompt_kernel,@function
concat_heads__ssm_conv_s4__spectral_gfnet__prompt_kernel:
    s_cmp_ge_u32 s2, 256
    s_cbranch_scc1 L_end
    s_load_dwordx16 s[16:31], s[0:1], 0
    s_load_dwordx8 s[32:39], s[0:1], 64
    s_load_dwordx2 s[56:57], s[0:1], 96
    s_load_dwordx4 s[40:43], s[0:1], 104
    s_getpc_b64 s[62:63]
L_pc:
    v_lshrrev_b32 v4, 6, v0
    v_and_b32 v1, 63, v0
    v_readfirstlane_b32 s3, v4
    v_lshlrev_b32 v8, 4, v1
    v_mov_b32 v9, 0
    s_and_b32 s8, s2, 7
    s_lshr_b32 s9, s2, 3
    s_lshl_b32 s7, s9, 3
    s_add_u32 s7, s7, s3
    s_lshl_b32 s7, s7, 8
    s_add_u32 s60, s62, s7
    s_addc_u32 s61, s63, 0
    v_lshlrev_b32 v10, 2, v1
    v_mov_b32 v11, 0
    v_lshl_add_u64 v[10:11], v[10:11], 0, s[60:61]
    global_load_dword v12, v[10:11], off offset:1024
    s_add_u32 s62, s62, TABLE - L_pc
    s_addc_u32 s63, s63, 0
    v_and_b32 v2, 15, v0
    v_bfe_u32 v3, v0, 4, 2
    v_mov_b32 v5, 0
    v_mov_b32 v6, 1
    s_mov_b32 s49, 0x80008000
    s_mov_b32 s54, 0x10000000
    s_mov_b32 s55, 0x20000
    s_mov_b32 s58, 0x400000
    s_mov_b32 s59, 0x20000
    s_cmp_lt_u32 s3, 4
    s_cbranch_scc1 L_B
    s_setprio 3
    s_sub_u32 s4, s3, 4
    s_lshr_b32 s44, s4, 1
    s_and_b32 s45, s4, 1
    v_lshrrev_b32 v20, 3, v1
    v_bfe_u32 v21, v1, 4, 1
    s_lshl_b32 s12, s45, 2
    v_or_b32 v21, s12, v21
    v_and_b32 v22, 7, v1
    v_xor_b32 v22, v22, v21
    s_lshl_b32 s12, s9, 16
    s_lshl_b32 s13, s4, 14
    s_add_u32 s12, s12, s13
    s_lshl_b32 s13, s8, 7
    s_add_u32 s12, s12, s13
    v_lshlrev_b32 v20, 10, v20
    v_add_u32 v20, s12, v20
    v_lshl_add_u32 v22, v22, 4, v20
    v_xor_b32 v23, 32, v22
    v_add_u32 v23, 8192, v23
    s_lshl_b32 s12, s4, 11
    s_add_u32 s12, s12, 128
    s_mov_b32 m0, s12
    s_lshl_b32 s7, s2, 1
    s_add_u32 s7, s7, s44
    s_lshl_b32 s13, s7, 1
    v_mov_b32 v21, s13
    s_lshl_b32 s7, s7, 8
    s_lshl_b32 s13, s45, 7
    s_add_u32 s7, s7, s13
    v_lshl_add_u32 v20, v1, 1, s7
    s_waitcnt lgkmcnt(0)
    global_load_ushort v19, v21, s[30:31]
    global_load_ushort v13, v20, s[18:19] nt
    global_load_ushort v14, v20, s[20:21] nt
    global_load_ushort v15, v20, s[22:23] nt
    global_load_ushort v16, v20, s[24:25] nt
    global_load_ushort v17, v20, s[26:27] nt
    global_load_ushort v18, v20, s[28:29] nt
    global_load_lds_dwordx4 v22, s[16:17] nt
    s_add_u32 s12, s12, 1024
    s_mov_b32 m0, s12
    s_setprio 0
    global_load_lds_dwordx4 v23, s[16:17] nt
    s_mov_b32 s52, s42
    s_mov_b32 s53, s43
    s_add_u32 s14, s42, 10600448
    s_addc_u32 s15, s43, 0
    s_load_dword s6, s[14:15], 0
    s_branch L_A
L_B:
    s_mov_b32 s4, s3
    s_lshl_b32 s7, s2, 10
    s_lshl_b32 s12, s4, 19
    s_add_u32 s7, s7, s12
    v_add_u32 v7, s7, v8
    s_mul_i32 s12, s4, 2304
    s_add_u32 s12, s12, 16512
    s_mov_b32 m0, s12
    v_lshlrev_b32 v4, 2, v1
    v_and_b32 v4, 0x7c, v4
    ds_write_b32 v4, v5 offset:0
    s_waitcnt lgkmcnt(0)
    global_load_lds_dwordx4 v7, s[34:35] nt
    s_add_u32 s12, s12, 1152
    v_add_u32 v7, 0x40000, v7
    s_mov_b32 m0, s12
    s_cmp_eq_u32 s9, 31
    global_load_lds_dwordx4 v7, s[34:35] nt
    s_cselect_b32 s46, s4, 0
    s_mov_b32 s52, s42
    s_mov_b32 s53, s43
    s_add_u32 s14, s42, 10600448
    s_addc_u32 s15, s43, 0
    s_load_dword s6, s[14:15], 0
    s_lshl_b32 s7, s8, 5
    s_add_u32 s7, s7, s9
    s_lshl_b32 s7, s7, 8
    s_add_u32 s7, s7, 28672
    s_add_u32 s60, s62, s7
    s_addc_u32 s61, s63, 0
    v_lshlrev_b32 v10, 2, v1
    v_mov_b32 v11, 0
    v_lshl_add_u64 v[10:11], v[10:11], 0, s[60:61]
    global_load_dword v12, v[10:11], off
    s_mul_i32 s13, s8, 514
    s_lshl_b32 s7, s9, 3
    s_lshl_b32 s12, s4, 1
    s_add_u32 s7, s7, s12
    s_mul_i32 s7, s7, 4112
    s_add_u32 s7, s7, s13
    v_lshrrev_b32 v28, 5, v1
    v_mul_u32_u24 v28, 4112, v28
    v_and_b32 v29, 31, v1
    v_lshl_add_u32 v28, v29, 4, v28
    v_add_u32 v28, s7, v28
    global_load_dwordx4 v[20:23], v28, s[36:37]
    global_load_dwordx4 v[24:27], v28, s[38:39]
    s_lshl_b32 s7, s4, 4
    v_add_u32 v136, s7, v2
    v_cvt_f32_u32 v137, v136
    v_cvt_f32_u32 v139, v3
    v_mul_f32 v137, 0x3c800000, v137
    v_mul_f32 v138, 4.0, v139
    v_mul_f32 v138, v138, v137
    v_mul_f32 v166, 0x41800000, v137
    v_add_f32 v166, v166, v138
    v_add_f32 v193, v138, v137
    v_add_f32 v197, v166, v137
    v_add_f32 v194, v193, v137
    v_add_f32 v198, v197, v137
    v_add_f32 v195, v194, v137
    v_add_f32 v199, v198, v137
    v_cos_f32 v176, v138
    v_sin_f32 v184, v138
    v_cos_f32 v177, v193
    v_sin_f32 v185, v193
    v_cos_f32 v178, v194
    v_sin_f32 v186, v194
    v_cos_f32 v179, v195
    v_sin_f32 v187, v195
    v_cos_f32 v180, v166
    v_sin_f32 v188, v166
    v_cos_f32 v181, v197
    v_sin_f32 v189, v197
    v_cos_f32 v182, v198
    v_sin_f32 v190, v198
    v_cos_f32 v183, v199
    v_sin_f32 v191, v199
    v_and_b32 v147, 1, v136
    v_mul_lo_u32 v147, v147, s49
    v_cvt_pk_bf16_f32 v36, v176, v177
    v_cvt_pk_bf16_f32 v44, -v184, -v185
    v_cvt_pk_bf16_f32 v37, v178, v179
    v_cvt_pk_bf16_f32 v45, -v186, -v187
    v_cvt_pk_bf16_f32 v38, v180, v181
    v_cvt_pk_bf16_f32 v46, -v188, -v189
    v_cvt_pk_bf16_f32 v39, v182, v183
    v_cvt_pk_bf16_f32 v47, -v190, -v191
    v_xor_b32 v40, v36, v147
    v_xor_b32 v48, v44, v147
    v_xor_b32 v41, v37, v147
    v_xor_b32 v49, v45, v147
    v_xor_b32 v42, v38, v147
    v_xor_b32 v50, v46, v147
    v_xor_b32 v43, v39, v147
    v_xor_b32 v51, v47, v147
    s_barrier
    s_mul_i32 s18, s2, 8320
    s_lshl_b32 s7, s4, 8
    v_lshrrev_b32 v150, 2, v2
    v_lshrrev_b32 v152, 1, v3
    s_add_u32 s16, s18, s7
    v_and_b32 v140, 1, v3
    v_cvt_f32_u32 v144, v150
    v_and_b32 v151, 3, v2
    v_cvt_f32_u32 v146, v152
    s_add_u32 s17, s16, 4096
    v_lshlrev_b32 v140, 2, v140
    v_cvt_f32_u32 v145, v151
    v_mul_f32 v153, v146, v144
    s_and_b32 s19, s2, 127
    v_cvt_f32_u32 v140, v140
    v_mul_f32 v145, 0x3e000000, v145
    v_mul_f32 v153, 0x3e000000, v153
    s_lshr_b32 s12, s2, 7
    v_fma_f32 v153, v140, v145, v153
    v_mul_f32 v154, 0x3e800000, v144
    s_mul_i32 s19, s19, 4224
    s_lshl_b32 s12, s12, 6
    v_add_f32 v154, v154, v153
    s_add_u32 s19, s19, s12
    v_mul_f32 v148, 0x3e000000, v137
    v_add_f32 v157, v153, v145
    v_add_f32 v161, v154, v145
    s_lshl_b32 s7, s4, 10
    v_mul_f32 v149, v140, v148
    v_add_f32 v158, v157, v145
    v_add_f32 v162, v161, v145
    v_and_b32 v164, 60, v1
    s_add_u32 s19, s19, s7
    v_add_f32 v193, v149, v148
    v_add_f32 v159, v158, v145
    v_add_f32 v163, v162, v145
    v_lshlrev_b32 v164, 2, v164
    v_and_b32 v165, 1, v1
    s_add_u32 s19, s19, 9502720
    v_add_f32 v194, v193, v148
    v_and_b32 v141, 1, v150
    v_cos_f32 v176, v153
    v_sin_f32 v184, v153
    v_cos_f32 v177, v157
    v_sin_f32 v185, v157
    v_cos_f32 v178, v158
    v_sin_f32 v186, v158
    v_cos_f32 v179, v159
    v_sin_f32 v187, v159
    v_cos_f32 v180, v154
    v_sin_f32 v188, v154
    v_cos_f32 v181, v161
    v_sin_f32 v189, v161
    v_cos_f32 v182, v162
    v_sin_f32 v190, v162
    v_cos_f32 v183, v163
    v_sin_f32 v191, v163
    v_lshl_add_u32 v164, v165, 3, v164
    s_mul_i32 s13, s8, 514
    s_lshl_b32 s7, s9, 4
    v_add_f32 v195, v194, v148
    v_mul_lo_u32 v141, v141, s49
    v_mul_lo_u32 v142, v152, s49
    v_and_b32 v165, 2, v1
    v_lshlrev_b32 v167, 10, v150
    v_lshlrev_b32 v168, 7, v150
    s_add_u32 s7, s7, s13
    s_mul_i32 s44, s4, 263168
    v_cos_f32 v52, v149
    v_sin_f32 v56, v149
    v_cos_f32 v53, v193
    v_sin_f32 v57, v193
    v_cos_f32 v54, v194
    v_sin_f32 v58, v194
    v_cos_f32 v55, v195
    v_sin_f32 v59, v195
    v_xor_b32 v143, v141, v142
    v_cvt_pk_bf16_f32 v60, v176, v177
    v_cvt_pk_bf16_f32 v76, v184, v185
    v_cvt_pk_bf16_f32 v92, -v184, -v185
    v_cvt_pk_bf16_f32 v61, v178, v179
    v_cvt_pk_bf16_f32 v77, v186, v187
    v_cvt_pk_bf16_f32 v93, -v186, -v187
    v_cvt_pk_bf16_f32 v62, v180, v181
    v_cvt_pk_bf16_f32 v78, v188, v189
    v_cvt_pk_bf16_f32 v94, -v188, -v189
    v_cvt_pk_bf16_f32 v63, v182, v183
    v_cvt_pk_bf16_f32 v79, v190, v191
    v_cvt_pk_bf16_f32 v95, -v190, -v191
    v_mul_u32_u24 v165, 576, v165
    v_lshl_add_u32 v167, v151, 6, v167
    v_lshl_add_u32 v168, v151, 4, v168
    s_add_u32 s7, s7, s44
    v_mul_u32_u24 v16, 4112, v1
    v_xor_b32 v64, v60, v142
    v_xor_b32 v80, v76, v142
    v_xor_b32 v96, v92, v142
    v_xor_b32 v68, v60, v141
    v_xor_b32 v84, v76, v141
    v_xor_b32 v100, v92, v141
    v_xor_b32 v72, v60, v143
    v_xor_b32 v88, v76, v143
    v_xor_b32 v104, v92, v143
    v_xor_b32 v65, v61, v142
    v_xor_b32 v81, v77, v142
    v_xor_b32 v97, v93, v142
    v_xor_b32 v69, v61, v141
    v_xor_b32 v85, v77, v141
    v_xor_b32 v101, v93, v141
    v_xor_b32 v73, v61, v143
    v_xor_b32 v89, v77, v143
    v_xor_b32 v105, v93, v143
    v_xor_b32 v66, v62, v142
    v_xor_b32 v82, v78, v142
    v_xor_b32 v98, v94, v142
    v_xor_b32 v70, v62, v141
    v_xor_b32 v86, v78, v141
    v_xor_b32 v102, v94, v141
    v_xor_b32 v74, v62, v143
    v_xor_b32 v90, v78, v143
    v_xor_b32 v106, v94, v143
    v_xor_b32 v67, v63, v142
    v_xor_b32 v83, v79, v142
    v_xor_b32 v99, v95, v142
    v_xor_b32 v71, v63, v141
    v_xor_b32 v87, v79, v141
    v_xor_b32 v103, v95, v141
    v_xor_b32 v75, v63, v143
    v_xor_b32 v91, v79, v143
    v_xor_b32 v107, v95, v143
    v_add_u32 v13, v164, v165
    v_lshl_add_u32 v14, v3, 4, v167
    v_lshl_add_u32 v15, v3, 2, v168
    v_add_u32 v17, 122880, v8
    v_add_u32 v16, s7, v16
    s_lshl_b32 s12, s4, 11
    s_lshl_b32 s7, s8, 13
    s_add_u32 s7, s7, s12
    s_add_u32 s7, s7, 28672
    s_add_u32 s60, s62, s7
    s_addc_u32 s61, s63, 0
    s_add_u32 s12, s12, 147456
    s_mov_b32 m0, s12
    v_lshl_add_u64 v[10:11], v[8:9], 0, s[60:61]
    global_load_lds_dwordx4 v[10:11], off offset:0
    global_load_lds_dwordx4 v[10:11], off offset:1024
    s_lshl_b32 s7, s4, 10
    s_mov_b32 s12, s7
    s_add_u32 s7, s7, 24576
    s_add_u32 s60, s62, s7
    s_addc_u32 s61, s63, 0
    s_add_u32 s12, s12, 155648
    s_mov_b32 m0, s12
    v_lshl_add_u64 v[10:11], v[8:9], 0, s[60:61]
    global_load_lds_dwordx4 v[10:11], off offset:0
    s_lshr_b32 s12, s9, 1
    s_and_b32 s12, s12, 3
    s_lshr_b32 s45, s9, 3
    s_and_b32 s47, s9, 1
    s_lshl_b32 s22, s12, 3
    s_add_u32 s22, s22, s8
    s_lshl_b32 s22, s22, 3
    s_add_u32 s22, s22, s45
    s_lshl_b32 s22, s22, 1
    s_add_u32 s22, s22, s47
    s_mul_i32 s61, s4, 135168
    s_lshl_b32 s22, s22, 3
    s_add_u32 s22, s22, s61
    s_add_u32 s22, s22, 9502720
    s_add_u32 s23, s22, 67584
    s_lshl_b32 s20, s8, 2
    s_add_u32 s20, s20, s12
    v_lshrrev_b32 v144, 2, v1
    v_lshrrev_b32 v147, 3, v2
    s_lshl_b32 s20, s20, 2
    v_and_b32 v145, 1, v1
    v_and_b32 v155, 7, v144
    v_lshrrev_b32 v156, 5, v1
    v_lshlrev_b32 v149, 8, v147
    s_add_u32 s20, s20, s45
    v_lshl_add_u32 v155, v155, 1, v145
    v_lshlrev_b32 v157, 2, v156
    v_and_b32 v146, 1, v3
    v_lshl_add_u32 v149, v3, 10, v149
    v_and_b32 v140, 4, v2
    v_and_b32 v151, 7, v2
    v_lshrrev_b32 v154, 1, v3
    s_lshl_b32 s20, s20, 1
    v_bfe_u32 v137, v1, 1, 1
    v_xor_b32 v155, v155, v157
    v_and_b32 v148, 3, v2
    v_lshl_add_u32 v149, v140, 1, v149
    v_mul_u32_u24 v151, 1040, v151
    v_lshl_add_u32 v153, v146, 4, v2
    v_lshlrev_b32 v154, 19, v154
    s_add_u32 s20, s20, s47
    v_lshl_add_u32 v136, v137, 7, v144
    v_mul_u32_u24 v138, 4224, v144
    v_mul_u32_u24 v139, 4160, v145
    v_lshlrev_b32 v155, 4, v155
    v_lshl_or_b32 v150, v146, 1, v147
    v_lshl_add_u32 v142, v148, 4, v149
    v_lshl_add_u32 v151, v3, 8, v151
    v_lshl_add_u32 v120, v153, 4, v154
    s_mul_i32 s50, s4, 266240
    s_lshl_b32 s20, s20, 5
    v_mul_u32_u24 v136, 8320, v136
    v_lshl_add_u32 v138, v137, 6, v138
    v_lshl_add_u32 v139, v137, 11, v139
    v_lshl_add_u32 v155, v156, 8, v155
    v_lshl_add_u32 v141, v148, 6, v149
    v_lshl_add_u32 v116, v150, 6, v142
    v_lshlrev_b32 v143, 10, v3
    v_lshl_add_u32 v151, v147, 5, v151
    v_lshlrev_b32 v158, 7, v3
    v_sub_u32 v153, 63, v153
    s_add_u32 s20, s20, s50
    v_lshl_add_u32 v108, v145, 4, v136
    v_lshl_add_u32 v109, v145, 2, v138
    v_lshl_add_u32 v110, v144, 4, v139
    v_lshl_add_u32 v111, v137, 12, v155
    v_lshl_add_u32 v112, v150, 4, v141
    v_xor_b32 v117, 64, v116
    v_xor_b32 v118, 128, v116
    v_xor_b32 v119, 192, v116
    v_lshl_add_u32 v114, v2, 4, v143
    v_add_u32 v113, 34048, v151
    v_lshl_add_u32 v122, v2, 2, v158
    v_lshl_add_u32 v121, v153, 4, v154
    v_lshlrev_b32 v115, 13, v146
    v_lshlrev_b32 v123, 11, v147
    s_add_u32 s21, s20, 133120
    s_lshr_b32 s12, s4, 1
    s_and_b32 s47, s4, 1
    s_lshl_b32 s44, s4, 10
    s_lshl_b32 s7, s12, 5
    v_xor_b32 v110, s7, v110
    s_mul_i32 s7, s12, 4160
    s_lshl_b32 s45, s4, 9
    v_add_u32 v112, s7, v112
    s_lshl_b32 s7, s4, 2
    v_add_u32 v114, s7, v114
    v_add_u32 v110, s45, v110
    s_lshl_b32 s7, s12, 4
    s_lshl_b32 s45, s47, 2
    s_add_u32 s7, s7, s45
    v_add_u32 v113, s7, v113
    s_mul_i32 s7, s4, 1040
    v_add_u32 v127, s7, v8
    s_lshl_b32 s7, s47, 7
    s_or_b32 s7, s7, s44
    s_lshl_b32 s51, s8, 5
    s_add_u32 s51, s51, s9
    s_mul_i32 s12, s51, 8320
    s_add_u32 s12, s12, 2129920
    s_add_u32 s24, s12, s44
    s_add_u32 s25, s24, 4096
    v_xor_b32 v111, s7, v111
    s_and_b32 s67, s51, 127
    s_lshr_b32 s7, s51, 7
    s_mul_i32 s67, s67, 4224
    s_lshl_b32 s7, s7, 6
    s_add_u32 s67, s67, s7
    s_lshl_b32 s7, s4, 9
    s_add_u32 s67, s67, s7
    s_add_u32 s67, s67, 10043392
    s_add_u32 s50, s50, 2129920
    s_lshl_b32 s26, s51, 5
    s_add_u32 s26, s26, s50
    s_add_u32 s27, s26, 133120
    s_lshr_b32 s28, s51, 3
    s_lshl_b32 s28, s28, 4
    s_and_b32 s7, s51, 7
    s_add_u32 s28, s28, s7
    s_lshl_b32 s28, s28, 3
    s_add_u32 s28, s28, s61
    s_add_u32 s28, s28, 10043392
    s_add_u32 s29, s28, 67584
    s_lshl_b32 s30, s2, 11
    s_lshl_b32 s7, s4, 20
    s_add_u32 s30, s30, s7
    s_add_u32 s30, s30, 1024
    s_lshl_b32 s31, s2, 3
    s_add_u32 s31, s31, 10584064
    v_add_u32 v128, s44, v8
    v_xor_b32 v129, 16, v110
    s_add_u32 s66, s31, 4096
    v_xor_b32 v124, 16, v112
    v_xor_b32 v125, 32, v112
    v_xor_b32 v126, 48, v112
    s_waitcnt lgkmcnt(0)
    s_mul_i32 s5, s6, 0x9e3779b1
    s_add_u32 s5, s5, 0x7f4a7c15
    s_setprio 2
    s_waitcnt vmcnt(6)
    s_mov_b64 exec, 1
    ds_add_u32 v5, v6 offset:24
    s_mov_b64 exec, -1
L_gb_1:
    ds_read_b32 v7, v5 offset:24
    s_waitcnt lgkmcnt(0)
    v_cmp_gt_u32 vcc, 8, v7
    s_nop 0
    s_cbranch_vccnz L_gb_1
    global_load_dwordx4 v[20:23], v16, s[36:37]
    global_load_dwordx4 v[24:27], v16, s[38:39]
    ds_read_b64_tr_b16 v[136:137], v13 offset:16512
    ds_read_b64_tr_b16 v[138:139], v13 offset:16768
    ds_read_b64_tr_b16 v[140:141], v13 offset:17024
    ds_read_b64_tr_b16 v[142:143], v13 offset:17280
    ds_read_b64_tr_b16 v[144:145], v13 offset:18816
    ds_read_b64_tr_b16 v[146:147], v13 offset:19072
    ds_read_b64_tr_b16 v[148:149], v13 offset:19328
    ds_read_b64_tr_b16 v[150:151], v13 offset:19584
    ds_read_b64_tr_b16 v[152:153], v13 offset:21120
    ds_read_b64_tr_b16 v[154:155], v13 offset:21376
    ds_read_b64_tr_b16 v[156:157], v13 offset:21632
    ds_read_b64_tr_b16 v[158:159], v13 offset:21888
    ds_read_b64_tr_b16 v[160:161], v13 offset:23424
    ds_read_b64_tr_b16 v[162:163], v13 offset:23680
    ds_read_b64_tr_b16 v[164:165], v13 offset:23936
    ds_read_b64_tr_b16 v[166:167], v13 offset:24192
    s_waitcnt lgkmcnt(14)
    v_mfma_f32_16x16x32_bf16 v[184:187], v[136:139], v[44:47], 0
    v_mfma_f32_16x16x32_bf16 v[168:171], v[136:139], v[36:39], 0
    s_waitcnt lgkmcnt(10)
    v_mfma_f32_16x16x32_bf16 v[188:191], v[144:147], v[44:47], 0
    v_mfma_f32_16x16x32_bf16 v[172:175], v[144:147], v[36:39], 0
    v_mfma_f32_16x16x32_bf16 v[184:187], v[140:143], v[48:51], v[184:187]
    v_mfma_f32_16x16x32_bf16 v[168:171], v[140:143], v[40:43], v[168:171]
    s_waitcnt lgkmcnt(8)
    v_mfma_f32_16x16x32_bf16 v[188:191], v[148:151], v[48:51], v[188:191]
    s_nop 4
    v_mul_f32 v217, v184, v52
    v_mul_f32 v221, v185, v53
    v_mfma_f32_16x16x32_bf16 v[172:175], v[148:151], v[40:43], v[172:175]
    v_mul_f32 v225, v186, v54
    v_mul_f32 v229, v187, v55
    s_waitcnt lgkmcnt(6)
    v_mfma_f32_16x16x32_bf16 v[192:195], v[152:155], v[44:47], 0
    v_mul_f32 v216, v184, v56
    v_fma_f32 v219, -v168, v56, v217
    v_mfma_f32_16x16x32_bf16 v[176:179], v[152:155], v[36:39], 0
    v_mul_f32 v220, v185, v57
    v_fma_f32 v223, -v169, v57, v221
    s_waitcnt lgkmcnt(2)
    v_mfma_f32_16x16x32_bf16 v[196:199], v[160:163], v[44:47], 0
    v_mul_f32 v224, v186, v58
    v_fma_f32 v227, -v170, v58, v225
    v_mfma_f32_16x16x32_bf16 v[180:183], v[160:163], v[36:39], 0
    v_mul_f32 v228, v187, v59
    v_fma_f32 v231, -v171, v59, v229
    v_mfma_f32_16x16x32_bf16 v[192:195], v[156:159], v[48:51], v[192:195]
    v_fma_f32 v218, v168, v52, v216
    v_fma_f32 v222, v169, v53, v220
    v_mfma_f32_16x16x32_bf16 v[176:179], v[156:159], v[40:43], v[176:179]
    v_cvt_pk_bf16_f32 v208, v219, v223
    v_fma_f32 v226, v170, v54, v224
    s_waitcnt lgkmcnt(0)
    v_mfma_f32_16x16x32_bf16 v[196:199], v[164:167], v[48:51], v[196:199]
    v_fma_f32 v230, v171, v55, v228
    v_cvt_pk_bf16_f32 v209, v227, v231
    v_mfma_f32_16x16x32_bf16 v[180:183], v[164:167], v[40:43], v[180:183]
    v_mul_f32 v217, v188, v52
    v_mul_f32 v221, v189, v53
    v_mul_f32 v225, v190, v54
    v_mul_f32 v229, v191, v55
    v_cvt_pk_bf16_f32 v200, v218, v222
    v_cvt_pk_bf16_f32 v201, v226, v230
    v_mul_f32 v216, v188, v56
    v_fma_f32 v219, -v172, v56, v217
    v_mul_f32 v220, v189, v57
    v_fma_f32 v223, -v173, v57, v221
    v_mul_f32 v224, v190, v58
    v_fma_f32 v227, -v174, v58, v225
    v_mul_f32 v228, v191, v59
    v_fma_f32 v231, -v175, v59, v229
    v_fma_f32 v218, v172, v52, v216
    v_fma_f32 v222, v173, v53, v220
    v_cvt_pk_bf16_f32 v210, v219, v223
    v_fma_f32 v226, v174, v54, v224
    v_fma_f32 v230, v175, v55, v228
    v_cvt_pk_bf16_f32 v211, v227, v231
    v_cvt_pk_bf16_f32 v202, v218, v222
    v_cvt_pk_bf16_f32 v203, v226, v230
    v_mfma_f32_16x16x32_bf16 v[144:147], v[208:211], v[60:63], 0
    v_mul_f32 v217, v192, v52
    v_mul_f32 v221, v193, v53
    v_mfma_f32_16x16x32_bf16 v[148:151], v[208:211], v[64:67], 0
    v_mul_f32 v225, v194, v54
    v_mul_f32 v229, v195, v55
    v_mfma_f32_16x16x32_bf16 v[136:139], v[200:203], v[60:63], 0
    v_mul_f32 v216, v192, v56
    v_fma_f32 v219, -v176, v56, v217
    v_mfma_f32_16x16x32_bf16 v[140:143], v[200:203], v[64:67], 0
    v_mul_f32 v220, v193, v57
    v_fma_f32 v223, -v177, v57, v221
    v_mul_f32 v224, v194, v58
    v_fma_f32 v227, -v178, v58, v225
    v_mul_f32 v228, v195, v59
    v_fma_f32 v231, -v179, v59, v229
    v_fma_f32 v218, v176, v52, v216
    v_fma_f32 v222, v177, v53, v220
    v_cvt_pk_bf16_f32 v212, v219, v223
    v_fma_f32 v226, v178, v54, v224
    v_fma_f32 v230, v179, v55, v228
    v_cvt_pk_bf16_f32 v213, v227, v231
    v_mul_f32 v217, v196, v52
    v_mul_f32 v221, v197, v53
    v_mul_f32 v225, v198, v54
    v_mul_f32 v229, v199, v55
    v_cvt_pk_bf16_f32 v204, v218, v222
    v_cvt_pk_bf16_f32 v205, v226, v230
    v_mul_f32 v216, v196, v56
    v_fma_f32 v219, -v180, v56, v217
    v_mul_f32 v220, v197, v57
    v_fma_f32 v223, -v181, v57, v221
    v_mul_f32 v224, v198, v58
    v_fma_f32 v227, -v182, v58, v225
    v_mul_f32 v228, v199, v59
    v_fma_f32 v231, -v183, v59, v229
    v_mfma_f32_16x16x32_bf16 v[144:147], v[200:203], v[92:95], v[144:147]
    v_fma_f32 v218, v180, v52, v216
    v_fma_f32 v222, v181, v53, v220
    v_mfma_f32_16x16x32_bf16 v[148:151], v[200:203], v[96:99], v[148:151]
    v_cvt_pk_bf16_f32 v214, v219, v223
    v_fma_f32 v226, v182, v54, v224
    v_fma_f32 v230, v183, v55, v228
    v_cvt_pk_bf16_f32 v215, v227, v231
    v_mfma_f32_16x16x32_bf16 v[136:139], v[208:211], v[76:79], v[136:139]
    v_cvt_pk_bf16_f32 v206, v218, v222
    v_cvt_pk_bf16_f32 v207, v226, v230
    v_mfma_f32_16x16x32_bf16 v[140:143], v[208:211], v[80:83], v[140:143]
    v_mfma_f32_16x16x32_bf16 v[144:147], v[212:215], v[68:71], v[144:147]
    v_mfma_f32_16x16x32_bf16 v[148:151], v[212:215], v[72:75], v[148:151]
    v_mfma_f32_16x16x32_bf16 v[136:139], v[204:207], v[68:71], v[136:139]
    v_mfma_f32_16x16x32_bf16 v[140:143], v[204:207], v[72:75], v[140:143]
    v_mfma_f32_16x16x32_bf16 v[144:147], v[204:207], v[100:103], v[144:147]
    v_mfma_f32_16x16x32_bf16 v[148:151], v[204:207], v[104:107], v[148:151]
    v_mfma_f32_16x16x32_bf16 v[136:139], v[212:215], v[84:87], v[136:139]
    s_nop 5
    v_cvt_pk_bf16_f32 v154, v144, v145
    v_cvt_pk_bf16_f32 v155, v146, v147
    v_mfma_f32_16x16x32_bf16 v[140:143], v[212:215], v[88:91], v[140:143]
    v_cvt_pk_bf16_f32 v158, v148, v149
    v_cvt_pk_bf16_f32 v159, v150, v151
    v_lshl_add_u32 v160, v154, 5, v155
    v_cvt_pk_bf16_f32 v153, v138, v139
    v_lshl_add_u32 v161, v158, 5, v159
    v_cvt_pk_bf16_f32 v152, v136, v137
    v_lshl_add_u32 v160, v153, 9, v160
    s_nop 0
    v_cvt_pk_bf16_f32 v157, v142, v143
    v_cvt_pk_bf16_f32 v156, v140, v141
    v_lshl_add_u32 v161, v157, 9, v161
    v_xad_u32 v160, v152, s5, v160
    v_xad_u32 v161, v156, s5, v161
    buffer_store_dwordx4 v[152:155], v14, s[52:55], s16 offen sc1
    buffer_store_dwordx4 v[156:159], v14, s[52:55], s17 offen sc1
    buffer_store_dword v160, v15, s[52:55], s19 offen offset:0 sc1
    buffer_store_dword v161, v15, s[52:55], s19 offen offset:512 sc1
    s_cmp_eq_u32 s4, 0
    s_cbranch_scc0 L_n1_2
    v_xor_b32 v208, 0x80000000, v200
    v_xor_b32 v209, 0x80000000, v201
    v_xor_b32 v210, 0x80000000, v202
    v_xor_b32 v211, 0x80000000, v203
    v_xor_b32 v212, 0x80000000, v204
    v_xor_b32 v213, 0x80000000, v205
    v_mfma_f32_16x16x32_bf16 v[168:171], v[208:211], v[60:63], 0
    v_xor_b32 v214, 0x80000000, v206
    v_xor_b32 v215, 0x80000000, v207
    v_mfma_f32_16x16x32_bf16 v[184:187], v[208:211], v[92:95], 0
    s_add_u32 s7, s18, 8192
    v_lshlrev_b32 v220, 1, v2
    v_mfma_f32_16x16x32_bf16 v[172:175], v[208:211], v[64:67], 0
    v_mfma_f32_16x16x32_bf16 v[188:191], v[208:211], v[96:99], 0
    v_mfma_f32_16x16x32_bf16 v[168:171], v[212:215], v[68:71], v[168:171]
    v_mfma_f32_16x16x32_bf16 v[184:187], v[212:215], v[100:103], v[184:187]
    v_mfma_f32_16x16x32_bf16 v[172:175], v[212:215], v[72:75], v[172:175]
    v_mfma_f32_16x16x32_bf16 v[188:191], v[212:215], v[104:107], v[188:191]
    s_nop 5
    v_cvt_pk_bf16_f32 v216, v168, v184
    v_xor_b32 v217, s5, v216
    v_cvt_pk_bf16_f32 v218, v172, v188
    v_xor_b32 v219, s5, v218
    s_mov_b64 exec, 0x1111
    buffer_store_dwordx2 v[216:217], v220, s[52:55], s7 offen sc1
    buffer_store_dwordx2 v[218:219], v220, s[52:55], s7 offen offset:32 sc1
    s_mov_b64 exec, -1
L_n1_2:
    s_setprio 0
    s_waitcnt vmcnt(5)
    ds_write_b128 v128, v[20:23] offset:34048
    s_waitcnt vmcnt(4)
    ds_write_b128 v128, v[24:27] offset:38144
    s_mov_b64 exec, 1
    ds_add_u32 v5, v6 offset:4
    s_mov_b64 exec, -1
L_gb_3:
    ds_read_b32 v7, v5 offset:4
    s_waitcnt lgkmcnt(0)
    v_cmp_gt_u32 vcc, 4, v7
    s_nop 0
    s_cbranch_vccnz L_gb_3
    s_waitcnt vmcnt(0)
    buffer_load_dwordx4 v[152:155], v108, s[52:55], s20 offen sc1
    buffer_load_dwordx4 v[156:159], v108, s[52:55], s21 offen sc1
    buffer_load_dword v160, v109, s[52:55], s22 offen sc1
    buffer_load_dword v161, v109, s[52:55], s23 offen sc1
    ds_read_b128 v[36:39], v17 offset:24576
    ds_read_b128 v[40:43], v17 offset:25600
    ds_read_b128 v[44:47], v17 offset:26624
    ds_read_b128 v[48:51], v17 offset:27648
    ds_read_b128 v[52:55], v17 offset:28672
    ds_read_b128 v[56:59], v17 offset:29696
    ds_read_b128 v[60:63], v17 offset:30720
    ds_read_b128 v[64:67], v17 offset:31744
    ds_read_b128 v[68:71], v17 offset:32768
    ds_read_b128 v[72:75], v17 offset:33792
    ds_read_b128 v[76:79], v17 offset:34816
    ds_read_b128 v[80:83], v17 offset:35840
    ds_read_b32 v164, v114 offset:34048
    ds_read_b32 v168, v114 offset:38144
    ds_read_b32 v165, v114 offset:34304
    ds_read_b32 v169, v114 offset:38400
    ds_read_b32 v166, v114 offset:34560
    ds_read_b32 v170, v114 offset:38656
    ds_read_b32 v167, v114 offset:34816
    ds_read_b32 v171, v114 offset:38912
    s_waitcnt lgkmcnt(7)
    v_lshlrev_b32 v136, 16, v164
    v_and_b32 v140, 0xffff0000, v164
    s_waitcnt lgkmcnt(6)
    v_lshlrev_b32 v144, 16, v168
    v_and_b32 v148, 0xffff0000, v168
    s_waitcnt lgkmcnt(5)
    v_lshlrev_b32 v137, 16, v165
    v_and_b32 v141, 0xffff0000, v165
    s_waitcnt lgkmcnt(4)
    v_lshlrev_b32 v145, 16, v169
    v_and_b32 v149, 0xffff0000, v169
    s_waitcnt lgkmcnt(3)
    v_lshlrev_b32 v138, 16, v166
    v_and_b32 v142, 0xffff0000, v166
    s_waitcnt lgkmcnt(2)
    v_lshlrev_b32 v146, 16, v170
    v_and_b32 v150, 0xffff0000, v170
    s_waitcnt lgkmcnt(1)
    v_lshlrev_b32 v139, 16, v167
    v_and_b32 v143, 0xffff0000, v167
    s_waitcnt lgkmcnt(0)
    v_lshlrev_b32 v147, 16, v171
    v_and_b32 v151, 0xffff0000, v171
    s_or_b32 s7, s9, s4
    s_cbranch_scc1 L_dc_4
    v_mul_f32 v136, 0.5, v136
    v_mul_f32 v144, 0.5, v144
    v_mul_f32 v137, 0.5, v137
    v_mul_f32 v145, 0.5, v145
    v_mul_f32 v138, 0.5, v138
    v_mul_f32 v146, 0.5, v146
    v_mul_f32 v139, 0.5, v139
    v_mul_f32 v147, 0.5, v147
L_dc_4:
    s_setprio 2
    s_mov_b32 s48, 65536
    s_waitcnt vmcnt(0)
L_chk_5:
    v_lshl_add_u32 v162, v154, 5, v155
    v_lshl_add_u32 v163, v158, 5, v159
    v_lshl_add_u32 v162, v153, 9, v162
    v_lshl_add_u32 v163, v157, 9, v163
    v_xad_u32 v162, v152, s5, v162
    v_xad_u32 v163, v156, s5, v163
    v_cmp_ne_u32 vcc, v162, v160
    v_cmp_ne_u32 s[10:11], v163, v161
    s_nop 0
    s_or_b64 s[10:11], s[10:11], vcc
    s_and_b64 exec, s[10:11], s[10:11]
    s_cbranch_scc0 L_ok_6
    s_sub_u32 s48, s48, 1
    s_cbranch_scc1 L_ok_6
    buffer_load_dwordx4 v[152:155], v108, s[52:55], s20 offen sc1
    buffer_load_dwordx4 v[156:159], v108, s[52:55], s21 offen sc1
    buffer_load_dword v160, v109, s[52:55], s22 offen sc1
    buffer_load_dword v161, v109, s[52:55], s23 offen sc1
    s_waitcnt vmcnt(0)
    s_branch L_chk_5
L_ok_6:
    s_mov_b64 exec, -1
    ds_write_b128 v110, v[152:155] offset:25728
    ds_write_b128 v129, v[156:159] offset:25984
    s_cmp_eq_u32 s46, 3
    s_cbranch_scc0 L_nt_7
    s_lshl_b32 s32, s8, 3
    s_add_u32 s32, s32, 8192
    s_add_u32 s33, s32, 532480
    s_add_u32 s34, s32, 1064960
    s_add_u32 s35, s32, 1597440
    v_mul_u32_u24 v13, 8320, v1
    s_add_u32 s7, s13, 512
    v_lshl_add_u32 v164, v3, 6, v2
    v_mul_u32_u24 v164, 4112, v164
    v_add_u32 v164, s7, v164
    buffer_load_dwordx2 v[20:21], v13, s[52:55], s32 offen sc1
    buffer_load_dwordx2 v[22:23], v13, s[52:55], s33 offen sc1
    buffer_load_dwordx2 v[24:25], v13, s[52:55], s34 offen sc1
    buffer_load_dwordx2 v[26:27], v13, s[52:55], s35 offen sc1
    global_load_ushort v28, v164, s[36:37]
    global_load_ushort v32, v164, s[38:39]
    v_add_u32 v164, 65792, v164
    global_load_ushort v29, v164, s[36:37]
    global_load_ushort v33, v164, s[38:39]
    v_add_u32 v164, 65792, v164
    global_load_ushort v30, v164, s[36:37]
    global_load_ushort v34, v164, s[38:39]
    v_add_u32 v164, 65792, v164
    global_load_ushort v31, v164, s[36:37]
    global_load_ushort v35, v164, s[38:39]
    v_add_u32 v164, 65792, v164
L_nt_7:
    s_mov_b64 exec, 1
    ds_add_u32 v5, v6 offset:8
    s_mov_b64 exec, -1
L_gb_8:
    ds_read_b32 v7, v5 offset:8
    s_waitcnt lgkmcnt(0)
    v_cmp_gt_u32 vcc, 4, v7
    s_nop 0
    s_cbranch_vccnz L_gb_8
    s_or_b32 s7, s2, s4
    s_cbranch_scc1 L_ep_9
    s_add_u32 s7, s6, 1
    v_mov_b32 v162, s7
    s_mov_b32 s7, 10600448
    s_mov_b64 exec, 1
    buffer_store_dword v162, v5, s[52:55], s7 offen sc1
    s_mov_b64 exec, -1
L_ep_9:
    s_and_b32 s7, s4, 1
    s_cbranch_scc1 L_odd_10
    ds_read_b64_tr_b16 v[152:153], v112 offset:25728
    ds_read_b64_tr_b16 v[154:155], v112 offset:26240
    ds_read_b64_tr_b16 v[156:157], v124 offset:25728
    ds_read_b64_tr_b16 v[158:159], v124 offset:26240
    ds_read_b64_tr_b16 v[160:161], v125 offset:25728
    ds_read_b64_tr_b16 v[162:163], v125 offset:26240
    ds_read_b64_tr_b16 v[164:165], v126 offset:25728
    ds_read_b64_tr_b16 v[166:167], v126 offset:26240
    s_waitcnt lgkmcnt(6)
    v_mfma_f32_16x16x32_bf16 v[184:187], v[152:155], v[40:43], 0
    s_waitcnt lgkmcnt(4)
    v_mfma_f32_16x16x32_bf16 v[188:191], v[156:159], v[40:43], 0
    v_mfma_f32_16x16x32_bf16 v[168:171], v[152:155], v[36:39], 0
    s_nop 4
    v_mul_f32 v208, v184, v56
    v_mul_f32 v209, v184, v52
    v_mfma_f32_16x16x32_bf16 v[172:175], v[156:159], v[36:39], 0
    v_mul_f32 v216, v185, v56
    v_mul_f32 v217, v185, v52
    s_waitcnt lgkmcnt(2)
    v_mfma_f32_16x16x32_bf16 v[192:195], v[160:163], v[40:43], 0
    v_mul_f32 v212, v188, v57
    v_mul_f32 v213, v188, v53
    s_waitcnt lgkmcnt(0)
    v_mfma_f32_16x16x32_bf16 v[196:199], v[164:167], v[40:43], 0
    v_mul_f32 v220, v189, v57
    v_mul_f32 v221, v189, v53
    v_mfma_f32_16x16x32_bf16 v[176:179], v[160:163], v[36:39], 0
    v_fma_f32 v210, v168, v52, v208
    v_fma_f32 v211, -v168, v56, v209
    v_mfma_f32_16x16x32_bf16 v[180:183], v[164:167], v[36:39], 0
    v_fma_f32 v218, v169, v52, v216
    v_fma_f32 v219, -v169, v56, v217
    v_fma_f32 v214, v172, v53, v212
    v_fma_f32 v215, -v172, v57, v213
    v_fma_f32 v222, v173, v53, v220
    v_fma_f32 v223, -v173, v57, v221
    v_cvt_pk_bf16_f32 v200, v210, v211
    v_cvt_pk_bf16_f32 v204, v218, v219
    v_cvt_pk_bf16_f32 v201, v214, v215
    v_cvt_pk_bf16_f32 v205, v222, v223
    v_mul_f32 v208, v192, v58
    v_mul_f32 v209, v192, v54
    v_mul_f32 v216, v193, v58
    v_mul_f32 v217, v193, v54
    v_mul_f32 v212, v196, v59
    v_mul_f32 v213, v196, v55
    v_mul_f32 v220, v197, v59
    v_mul_f32 v221, v197, v55
    v_fma_f32 v210, v176, v54, v208
    v_fma_f32 v211, -v176, v58, v209
    v_fma_f32 v218, v177, v54, v216
    v_fma_f32 v219, -v177, v58, v217
    v_fma_f32 v214, v180, v55, v212
    v_fma_f32 v215, -v180, v59, v213
    v_fma_f32 v222, v181, v55, v220
    v_fma_f32 v223, -v181, v59, v221
    v_cvt_pk_bf16_f32 v202, v210, v211
    v_cvt_pk_bf16_f32 v206, v218, v219
    v_cvt_pk_bf16_f32 v203, v214, v215
    v_cvt_pk_bf16_f32 v207, v222, v223
    s_branch L_join_11
L_odd_10:
    ds_read_b64_tr_b16 v[152:153], v112 offset:25728
    ds_read_b64_tr_b16 v[154:155], v112 offset:26240
    ds_read_b64_tr_b16 v[156:157], v124 offset:25728
    ds_read_b64_tr_b16 v[158:159], v124 offset:26240
    ds_read_b64_tr_b16 v[160:161], v125 offset:25728
    ds_read_b64_tr_b16 v[162:163], v125 offset:26240
    ds_read_b64_tr_b16 v[164:165], v126 offset:25728
    ds_read_b64_tr_b16 v[166:167], v126 offset:26240
    s_waitcnt lgkmcnt(6)
    v_mfma_f32_16x16x32_bf16 v[184:187], v[152:155], v[40:43], 0
    s_waitcnt lgkmcnt(4)
    v_mfma_f32_16x16x32_bf16 v[188:191], v[156:159], v[40:43], 0
    v_mfma_f32_16x16x32_bf16 v[168:171], v[152:155], v[36:39], 0
    s_nop 4
    v_mul_f32 v208, v186, v56
    v_mul_f32 v209, v186, v52
    v_mfma_f32_16x16x32_bf16 v[172:175], v[156:159], v[36:39], 0
    v_mul_f32 v216, v187, v56
    v_mul_f32 v217, v187, v52
    s_waitcnt lgkmcnt(2)
    v_mfma_f32_16x16x32_bf16 v[192:195], v[160:163], v[40:43], 0
    v_mul_f32 v212, v190, v57
    v_mul_f32 v213, v190, v53
    s_waitcnt lgkmcnt(0)
    v_mfma_f32_16x16x32_bf16 v[196:199], v[164:167], v[40:43], 0
    v_mul_f32 v220, v191, v57
    v_mul_f32 v221, v191, v53
    v_mfma_f32_16x16x32_bf16 v[176:179], v[160:163], v[36:39], 0
    v_fma_f32 v210, v170, v52, v208
    v_fma_f32 v211, -v170, v56, v209
    v_mfma_f32_16x16x32_bf16 v[180:183], v[164:167], v[36:39], 0
    v_fma_f32 v218, v171, v52, v216
    v_fma_f32 v219, -v171, v56, v217
    v_fma_f32 v214, v174, v53, v212
    v_fma_f32 v215, -v174, v57, v213
    v_fma_f32 v222, v175, v53, v220
    v_fma_f32 v223, -v175, v57, v221
    v_cvt_pk_bf16_f32 v200, v210, v211
    v_cvt_pk_bf16_f32 v204, v218, v219
    v_cvt_pk_bf16_f32 v201, v214, v215
    v_cvt_pk_bf16_f32 v205, v222, v223
    v_mul_f32 v208, v194, v58
    v_mul_f32 v209, v194, v54
    v_mul_f32 v216, v195, v58
    v_mul_f32 v217, v195, v54
    v_mul_f32 v212, v198, v59
    v_mul_f32 v213, v198, v55
    v_mul_f32 v220, v199, v59
    v_mul_f32 v221, v199, v55
    v_fma_f32 v210, v178, v54, v208
    v_fma_f32 v211, -v178, v58, v209
    v_fma_f32 v218, v179, v54, v216
    v_fma_f32 v219, -v179, v58, v217
    v_fma_f32 v214, v182, v55, v212
    v_fma_f32 v215, -v182, v59, v213
    v_fma_f32 v222, v183, v55, v220
    v_fma_f32 v223, -v183, v59, v221
    v_cvt_pk_bf16_f32 v202, v210, v211
    v_cvt_pk_bf16_f32 v206, v218, v219
    v_cvt_pk_bf16_f32 v203, v214, v215
    v_cvt_pk_bf16_f32 v207, v222, v223
L_join_11:
    s_nop 7
    v_mfma_f32_16x16x32_bf16 v[176:179], v[72:75], v[200:203], 0
    v_mfma_f32_16x16x32_bf16 v[180:183], v[72:75], v[204:207], 0
    v_mfma_f32_16x16x32_bf16 v[168:171], v[68:71], v[200:203], 0
    s_nop 5
    v_mul_f32 v208, v176, v144
    v_mul_f32 v209, v176, v136
    v_mfma_f32_16x16x32_bf16 v[172:175], v[68:71], v[204:207], 0
    v_mul_f32 v212, v177, v145
    v_mul_f32 v213, v177, v137
    v_mul_f32 v216, v180, v148
    v_mul_f32 v217, v180, v140
    v_mul_f32 v220, v181, v149
    v_mul_f32 v221, v181, v141
    v_fma_f32 v210, v168, v136, -v208
    v_fma_f32 v211, v168, v144, v209
    v_fma_f32 v214, v169, v137, -v212
    v_fma_f32 v215, v169, v145, v213
    v_fma_f32 v218, v172, v140, -v216
    v_fma_f32 v219, v172, v148, v217
    v_fma_f32 v222, v173, v141, -v220
    v_fma_f32 v223, v173, v149, v221
    v_cvt_pk_bf16_f32 v200, v210, v211
    v_cvt_pk_bf16_f32 v201, v214, v215
    v_mul_f32 v208, v178, v146
    v_mul_f32 v209, v178, v138
    v_mul_f32 v212, v179, v147
    v_mul_f32 v213, v179, v139
    v_cvt_pk_bf16_f32 v204, v218, v219
    v_cvt_pk_bf16_f32 v205, v222, v223
    v_mul_f32 v216, v182, v150
    v_mul_f32 v217, v182, v142
    v_mul_f32 v220, v183, v151
    v_mul_f32 v221, v183, v143
    v_fma_f32 v210, v170, v138, -v208
    v_fma_f32 v211, v170, v146, v209
    v_fma_f32 v214, v171, v139, -v212
    v_fma_f32 v215, v171, v147, v213
    v_fma_f32 v218, v174, v142, -v216
    v_fma_f32 v219, v174, v150, v217
    v_fma_f32 v222, v175, v143, -v220
    v_fma_f32 v223, v175, v151, v221
    v_cvt_pk_bf16_f32 v202, v210, v211
    v_cvt_pk_bf16_f32 v203, v214, v215
    v_cvt_pk_bf16_f32 v206, v218, v219
    v_cvt_pk_bf16_f32 v207, v222, v223
    v_mfma_f32_16x16x32_bf16 v[176:179], v[200:203], v[80:83], 0
    s_nop 0
    v_mfma_f32_16x16x32_bf16 v[180:183], v[204:207], v[80:83], 0
    v_mfma_f32_16x16x32_bf16 v[168:171], v[200:203], v[76:79], 0
    s_nop 4
    v_mul_f32 v208, v176, v64
    v_mul_f32 v209, v176, v60
    v_mfma_f32_16x16x32_bf16 v[172:175], v[204:207], v[76:79], 0
    v_mul_f32 v212, v177, v65
    v_mul_f32 v213, v177, v61
    v_mul_f32 v216, v180, v64
    v_mul_f32 v217, v180, v60
    v_mul_f32 v220, v181, v65
    v_mul_f32 v221, v181, v61
    v_fma_f32 v210, v168, v60, -v208
    v_fma_f32 v211, v168, v64, v209
    v_fma_f32 v214, v169, v61, -v212
    v_fma_f32 v215, v169, v65, v213
    v_fma_f32 v218, v172, v60, -v216
    v_fma_f32 v219, v172, v64, v217
    v_fma_f32 v222, v173, v61, -v220
    v_fma_f32 v223, v173, v65, v221
    v_cvt_pk_bf16_f32 v200, v210, v211
    v_cvt_pk_bf16_f32 v201, v214, v215
    v_mul_f32 v208, v178, v66
    v_mul_f32 v209, v178, v62
    v_mul_f32 v212, v179, v67
    v_mul_f32 v213, v179, v63
    v_cvt_pk_bf16_f32 v204, v218, v219
    v_cvt_pk_bf16_f32 v205, v222, v223
    v_mul_f32 v216, v182, v66
    v_mul_f32 v217, v182, v62
    v_mul_f32 v220, v183, v67
    v_mul_f32 v221, v183, v63
    v_fma_f32 v210, v170, v62, -v208
    v_fma_f32 v211, v170, v66, v209
    v_fma_f32 v214, v171, v63, -v212
    v_fma_f32 v215, v171, v67, v213
    v_fma_f32 v218, v174, v62, -v216
    v_fma_f32 v219, v174, v66, v217
    v_fma_f32 v222, v175, v63, -v220
    v_fma_f32 v223, v175, v67, v221
    v_cvt_pk_bf16_f32 v202, v210, v211
    v_cvt_pk_bf16_f32 v203, v214, v215
    v_cvt_pk_bf16_f32 v206, v218, v219
    v_cvt_pk_bf16_f32 v207, v222, v223
    v_mfma_f32_16x16x32_bf16 v[152:155], v[44:47], v[200:203], 0
    v_mfma_f32_16x16x32_bf16 v[160:163], v[48:51], v[200:203], 0
    v_mfma_f32_16x16x32_bf16 v[156:159], v[44:47], v[204:207], 0
    v_mfma_f32_16x16x32_bf16 v[164:167], v[48:51], v[204:207], 0
    s_nop 6
    v_cvt_pk_bf16_f32 v200, v152, v156
    v_cvt_pk_bf16_f32 v201, v153, v157
    v_cvt_pk_bf16_f32 v202, v154, v158
    v_cvt_pk_bf16_f32 v203, v155, v159
    v_cvt_pk_bf16_f32 v204, v160, v164
    v_cvt_pk_bf16_f32 v205, v161, v165
    v_cvt_pk_bf16_f32 v206, v162, v166
    v_cvt_pk_bf16_f32 v207, v163, v167
    ds_write2_b32 v113, v200, v204 offset0:0 offset1:2
    ds_write2_b32 v113, v201, v205 offset0:16 offset1:18
    ds_write2_b32 v113, v202, v206 offset0:32 offset1:34
    ds_write2_b32 v113, v203, v207 offset0:48 offset1:50
    s_mov_b64 exec, 1
    ds_add_u32 v5, v6 offset:12
    s_mov_b64 exec, -1
L_gb_12:
    ds_read_b32 v7, v5 offset:12
    s_waitcnt lgkmcnt(0)
    v_cmp_gt_u32 vcc, 4, v7
    s_nop 0
    s_cbranch_vccnz L_gb_12
    ds_read_b128 v[184:187], v127 offset:34048
    ds_read_b128 v[188:191], v127 offset:38208
    s_waitcnt lgkmcnt(1)
    v_lshl_add_u32 v192, v186, 5, v187
    v_lshl_add_u32 v192, v185, 9, v192
    v_xad_u32 v192, v184, s5, v192
    s_waitcnt lgkmcnt(0)
    v_lshl_add_u32 v193, v190, 5, v191
    v_lshl_add_u32 v193, v189, 9, v193
    v_xad_u32 v193, v188, s5, v193
    buffer_store_dwordx4 v[184:187], v8, s[52:55], s24 offen sc1
    buffer_store_dwordx4 v[188:191], v8, s[52:55], s25 offen sc1
    buffer_store_dword v192, v122, s[52:55], s67 offen sc1
    buffer_store_dword v193, v122, s[52:55], s67 offen offset:2048 sc1
    s_cmp_eq_u32 s46, 3
    s_cbranch_scc0 L_n2_13
    s_mov_b32 s48, 65536
    s_waitcnt vmcnt(4)
L_chk_14:
    v_xad_u32 v208, v20, s5, 0
    v_xad_u32 v209, v22, s5, 0
    v_xad_u32 v210, v24, s5, 0
    v_xad_u32 v211, v26, s5, 0
    v_cmp_ne_u32 s[10:11], v208, v21
    v_cmp_ne_u32 vcc, v209, v23
    s_nop 0
    s_or_b64 s[10:11], s[10:11], vcc
    v_cmp_ne_u32 vcc, v210, v25
    s_nop 0
    s_or_b64 s[10:11], s[10:11], vcc
    v_cmp_ne_u32 vcc, v211, v27
    s_nop 0
    s_or_b64 s[10:11], s[10:11], vcc
    s_and_b64 exec, s[10:11], s[10:11]
    s_cbranch_scc0 L_ok_15
    s_sub_u32 s48, s48, 1
    s_cbranch_scc1 L_ok_15
    buffer_load_dwordx2 v[20:21], v13, s[52:55], s32 offen sc1
    buffer_load_dwordx2 v[22:23], v13, s[52:55], s33 offen sc1
    buffer_load_dwordx2 v[24:25], v13, s[52:55], s34 offen sc1
    buffer_load_dwordx2 v[26:27], v13, s[52:55], s35 offen sc1
    s_waitcnt vmcnt(0)
    s_branch L_chk_14
L_ok_15:
    s_mov_b64 exec, -1
    v_lshlrev_b32 v216, 6, v2
    v_lshl_add_u32 v217, v3, 2, v216
    v_lshl_add_u32 v218, v3, 4, v216
    ds_write_b32 v217, v20 offset:50560
    ds_write_b32 v217, v22 offset:50576
    v_lshlrev_b32 v28, 16, v28
    ds_write_b32 v217, v24 offset:50592
    ds_write_b32 v217, v26 offset:50608
    v_lshlrev_b32 v29, 16, v29
    ds_read_b128 v[152:155], v218 offset:50560
    v_lshlrev_b32 v32, 16, v32
    v_lshlrev_b32 v33, 16, v33
    v_mul_f32 v28, 0.5, v28
    v_mul_f32 v29, 0.5, v29
    v_mul_f32 v32, 0.5, v32
    v_mul_f32 v33, 0.5, v33
    v_lshlrev_b32 v30, 16, v30
    v_lshlrev_b32 v31, 16, v31
    v_lshlrev_b32 v34, 16, v34
    v_lshlrev_b32 v35, 16, v35
    v_mul_f32 v30, 0.5, v30
    v_mul_f32 v31, 0.5, v31
    v_mul_f32 v34, 0.5, v34
    v_mul_f32 v35, 0.5, v35
    s_lshl_b32 s7, s8, 11
    v_lshlrev_b32 v219, 9, v3
    s_add_u32 s7, s7, 10584064
    v_lshl_add_u32 v219, v2, 3, v219
    s_waitcnt lgkmcnt(0)
    v_mfma_f32_16x16x32_bf16 v[160:163], v[152:155], v[40:43], 0
    v_mfma_f32_16x16x32_bf16 v[156:159], v[152:155], v[36:39], 0
    s_nop 6
    v_mul_f32 v208, v160, v56
    v_mul_f32 v209, v160, v52
    v_mul_f32 v212, v161, v57
    v_mul_f32 v213, v161, v53
    v_fma_f32 v210, v156, v52, v208
    v_fma_f32 v211, -v156, v56, v209
    v_fma_f32 v214, v157, v53, v212
    v_fma_f32 v215, -v157, v57, v213
    v_cvt_pk_bf16_f32 v200, v210, v211
    v_cvt_pk_bf16_f32 v201, v214, v215
    v_mul_f32 v208, v162, v58
    v_mul_f32 v209, v162, v54
    v_mul_f32 v212, v163, v59
    v_mul_f32 v213, v163, v55
    v_fma_f32 v210, v158, v54, v208
    v_fma_f32 v211, -v158, v58, v209
    v_fma_f32 v214, v159, v55, v212
    v_fma_f32 v215, -v159, v59, v213
    v_cvt_pk_bf16_f32 v202, v210, v211
    v_cvt_pk_bf16_f32 v203, v214, v215
    s_nop 1
    v_mfma_f32_16x16x32_bf16 v[176:179], v[72:75], v[200:203], 0
    v_mfma_f32_16x16x32_bf16 v[168:171], v[68:71], v[200:203], 0
    s_nop 6
    v_mul_f32 v208, v176, v32
    v_mul_f32 v209, v176, v28
    v_mul_f32 v212, v177, v33
    v_mul_f32 v213, v177, v29
    v_fma_f32 v210, v168, v28, -v208
    v_fma_f32 v211, v168, v32, v209
    v_fma_f32 v214, v169, v29, -v212
    v_fma_f32 v215, v169, v33, v213
    v_cvt_pk_bf16_f32 v200, v210, v211
    v_cvt_pk_bf16_f32 v201, v214, v215
    v_mul_f32 v208, v178, v34
    v_mul_f32 v209, v178, v30
    v_mul_f32 v212, v179, v35
    v_mul_f32 v213, v179, v31
    v_fma_f32 v210, v170, v30, -v208
    v_fma_f32 v211, v170, v34, v209
    v_fma_f32 v214, v171, v31, -v212
    v_fma_f32 v215, v171, v35, v213
    v_cvt_pk_bf16_f32 v202, v210, v211
    v_cvt_pk_bf16_f32 v203, v214, v215
    s_nop 1
    v_mfma_f32_16x16x32_bf16 v[176:179], v[200:203], v[80:83], 0
    v_mfma_f32_16x16x32_bf16 v[168:171], v[200:203], v[76:79], 0
    s_nop 6
    v_mul_f32 v208, v176, v64
    v_mul_f32 v209, v176, v60
    v_mul_f32 v212, v177, v65
    v_mul_f32 v213, v177, v61
    v_fma_f32 v210, v168, v60, -v208
    v_fma_f32 v211, v168, v64, v209
    v_fma_f32 v214, v169, v61, -v212
    v_fma_f32 v215, v169, v65, v213
    v_cvt_pk_bf16_f32 v200, v210, v211
    v_cvt_pk_bf16_f32 v201, v214, v215
    v_mul_f32 v208, v178, v66
    v_mul_f32 v209, v178, v62
    v_mul_f32 v212, v179, v67
    v_mul_f32 v213, v179, v63
    v_fma_f32 v210, v170, v62, -v208
    v_fma_f32 v211, v170, v66, v209
    v_fma_f32 v214, v171, v63, -v212
    v_fma_f32 v215, v171, v67, v213
    v_cvt_pk_bf16_f32 v202, v210, v211
    v_cvt_pk_bf16_f32 v203, v214, v215
    s_nop 1
    v_mfma_f32_16x16x32_bf16 v[172:175], v[44:47], v[200:203], 0
    v_mfma_f32_16x16x32_bf16 v[180:183], v[48:51], v[200:203], 0
    s_nop 7
    v_cvt_pk_bf16_f32 v20, v172, v180
    v_cvt_pk_bf16_f32 v22, v173, v181
    v_cvt_pk_bf16_f32 v24, v174, v182
    v_cvt_pk_bf16_f32 v26, v175, v183
    v_xor_b32 v21, s5, v20
    v_xor_b32 v23, s5, v22
    v_xor_b32 v25, s5, v24
    v_xor_b32 v27, s5, v26
    s_waitcnt vmcnt(0)
    buffer_store_dwordx2 v[20:21], v219, s[52:55], s7 offen offset:0 sc1
    buffer_store_dwordx2 v[22:23], v219, s[52:55], s7 offen offset:128 sc1
    buffer_store_dwordx2 v[24:25], v219, s[52:55], s7 offen offset:256 sc1
    buffer_store_dwordx2 v[26:27], v219, s[52:55], s7 offen offset:384 sc1
    s_branch L_n3_16
L_n2_13:
L_n3_16:
    s_setprio 0
    v_lshrrev_b32 v202, 3, v2
    s_lshl_b32 s7, s4, 1
    v_add_u32 v196, s7, v202
    v_cvt_f32_u32 v196, v196
    v_mul_f32 v196, 0x3e000000, v196
    v_cvt_f32_u32 v198, v3
    v_cvt_f32_u32 v204, v2
    v_mul_f32 v203, v196, v198
    v_add_f32 v204, 0.5, v204
    v_and_b32 v197, 7, v2
    v_mul_f32 v198, 4.0, v198
    v_mul_f32 v204, 0x3c800000, v204
    v_cvt_f32_u32 v197, v197
    v_mul_f32 v205, v198, v204
    v_mul_f32 v206, 0x41800000, v204
    v_mul_f32 v197, 0x3e000000, v197
    v_add_f32 v206, v206, v205
    v_mul_f32 v208, v196, v198
    v_add_f32 v213, v203, v197
    v_add_f32 v217, v205, v204
    v_add_f32 v221, v206, v204
    v_add_f32 v225, v208, v196
    v_and_b32 v207, 1, v2
    v_cmp_gt_u32 vcc, 2, v3
    v_add_f32 v214, v213, v197
    v_add_f32 v218, v217, v204
    v_add_f32 v222, v221, v204
    v_add_f32 v226, v225, v196
    v_cvt_f32_u32 v209, v207
    v_add_f32 v215, v214, v197
    v_add_f32 v219, v218, v204
    v_add_f32 v223, v222, v204
    v_add_f32 v227, v226, v196
    v_fma_f32 v209, v209, -2.0, 1.0
    v_cos_f32 v136, v203
    v_sin_f32 v140, v203
    v_cos_f32 v137, v213
    v_sin_f32 v141, v213
    v_cos_f32 v138, v214
    v_sin_f32 v142, v214
    v_cos_f32 v139, v215
    v_sin_f32 v143, v215
    v_cos_f32 v228, v205
    v_sin_f32 v236, v205
    v_cos_f32 v229, v217
    v_sin_f32 v237, v217
    v_cos_f32 v230, v218
    v_sin_f32 v238, v218
    v_cos_f32 v231, v219
    v_sin_f32 v239, v219
    v_cos_f32 v232, v206
    v_sin_f32 v240, v206
    v_cos_f32 v233, v221
    v_sin_f32 v241, v221
    v_cos_f32 v234, v222
    v_sin_f32 v242, v222
    v_cos_f32 v235, v223
    v_sin_f32 v243, v223
    v_cos_f32 v144, v208
    v_sin_f32 v148, v208
    v_cos_f32 v145, v225
    v_sin_f32 v149, v225
    v_cos_f32 v146, v226
    v_sin_f32 v150, v226
    v_cos_f32 v147, v227
    v_sin_f32 v151, v227
    v_mul_lo_u32 v200, v207, s49
    v_cndmask_b32 v209, 0, v209, vcc
    v_mul_lo_u32 v199, v202, s49
    v_xor_b32 v201, s49, v200
    v_cvt_pk_bf16_f32 v84, v136, -v140
    v_cvt_pk_bf16_f32 v88, v140, v136
    v_cvt_pk_bf16_f32 v85, v137, -v141
    v_cvt_pk_bf16_f32 v89, v141, v137
    v_cvt_pk_bf16_f32 v86, v138, -v142
    v_cvt_pk_bf16_f32 v90, v142, v138
    v_cvt_pk_bf16_f32 v87, v139, -v143
    v_cvt_pk_bf16_f32 v91, v143, v139
    v_cvt_pk_bf16_f32 v152, v228, v229
    v_cvt_pk_bf16_f32 v168, v236, v237
    v_cvt_pk_bf16_f32 v156, v228, -v237
    v_cvt_pk_bf16_f32 v172, v236, v229
    v_cvt_pk_bf16_f32 v153, v230, v231
    v_cvt_pk_bf16_f32 v169, v238, v239
    v_cvt_pk_bf16_f32 v157, -v230, v239
    v_cvt_pk_bf16_f32 v173, -v238, -v231
    v_cvt_pk_bf16_f32 v154, v232, v233
    v_cvt_pk_bf16_f32 v170, v240, v241
    v_cvt_pk_bf16_f32 v158, v232, -v241
    v_cvt_pk_bf16_f32 v174, v240, v233
    v_cvt_pk_bf16_f32 v155, v234, v235
    v_cvt_pk_bf16_f32 v171, v242, v243
    v_cvt_pk_bf16_f32 v159, -v234, v243
    v_cvt_pk_bf16_f32 v175, -v242, -v235
    v_mul_f32 v144, v209, v144
    v_mul_f32 v148, v209, v148
    v_mul_f32 v145, v209, v145
    v_mul_f32 v149, v209, v149
    v_mul_f32 v146, v209, v146
    v_mul_f32 v150, v209, v150
    v_mul_f32 v147, v209, v147
    v_mul_f32 v151, v209, v151
    v_xor_b32 v92, v84, v199
    v_xor_b32 v96, v88, v199
    v_xor_b32 v93, v85, v199
    v_xor_b32 v97, v89, v199
    v_xor_b32 v94, v86, v199
    v_xor_b32 v98, v90, v199
    v_xor_b32 v95, v87, v199
    v_xor_b32 v99, v91, v199
    v_xor_b32 v160, v168, v201
    v_xor_b32 v176, v152, v200
    v_xor_b32 v164, v172, v201
    v_xor_b32 v180, v156, v200
    v_xor_b32 v161, v169, v201
    v_xor_b32 v177, v153, v200
    v_xor_b32 v165, v173, v201
    v_xor_b32 v181, v157, v200
    v_xor_b32 v162, v170, v201
    v_xor_b32 v178, v154, v200
    v_xor_b32 v166, v174, v201
    v_xor_b32 v182, v158, v200
    v_xor_b32 v163, v171, v201
    v_xor_b32 v179, v155, v200
    v_xor_b32 v167, v175, v201
    v_xor_b32 v183, v159, v200
    v_cvt_pk_bf16_f32 v100, v144, -v148
    v_cvt_pk_bf16_f32 v101, v145, -v149
    v_cvt_pk_bf16_f32 v102, v146, -v150
    v_cvt_pk_bf16_f32 v103, v147, -v151
    v_and_b32 v196, 7, v2
    v_add_u32 v196, -4, v196
    v_cvt_f32_i32 v196, v196
    v_lshlrev_b32 v197, 2, v3
    v_mul_f32 v196, 0x3b000000, v196
    v_cvt_f32_u32 v197, v197
    v_mul_f32 v198, v197, v196
    v_mul_f32 v202, 0x41800000, v196
    v_add_f32 v199, v198, v202
    v_add_f32 v200, v199, v202
    v_add_f32 v201, v200, v202
    v_add_f32 v205, v198, v196
    v_add_f32 v209, v199, v196
    v_add_f32 v213, v200, v196
    v_add_f32 v217, v201, v196
    v_add_f32 v206, v205, v196
    v_add_f32 v210, v209, v196
    v_add_f32 v214, v213, v196
    v_add_f32 v218, v217, v196
    v_add_f32 v207, v206, v196
    v_add_f32 v211, v210, v196
    v_add_f32 v215, v214, v196
    v_add_f32 v219, v218, v196
    v_cos_f32 v36, v198
    v_sin_f32 v52, v198
    v_cos_f32 v37, v205
    v_sin_f32 v53, v205
    v_cos_f32 v38, v206
    v_sin_f32 v54, v206
    v_cos_f32 v39, v207
    v_sin_f32 v55, v207
    v_cos_f32 v40, v199
    v_sin_f32 v56, v199
    v_cos_f32 v41, v209
    v_sin_f32 v57, v209
    v_cos_f32 v42, v210
    v_sin_f32 v58, v210
    v_cos_f32 v43, v211
    v_sin_f32 v59, v211
    v_cos_f32 v44, v200
    v_sin_f32 v60, v200
    v_cos_f32 v45, v213
    v_sin_f32 v61, v213
    v_cos_f32 v46, v214
    v_sin_f32 v62, v214
    v_cos_f32 v47, v215
    v_sin_f32 v63, v215
    v_cos_f32 v48, v201
    v_sin_f32 v64, v201
    v_cos_f32 v49, v217
    v_sin_f32 v65, v217
    v_cos_f32 v50, v218
    v_sin_f32 v66, v218
    v_cos_f32 v51, v219
    v_sin_f32 v67, v219
    buffer_load_dwordx4 v[184:187], v108, s[52:55], s26 offen sc1
    buffer_load_dwordx4 v[188:191], v108, s[52:55], s27 offen sc1
    buffer_load_dword v192, v109, s[52:55], s28 offen sc1
    buffer_load_dword v193, v109, s[52:55], s29 offen sc1
    s_setprio 2
    s_mov_b32 s48, 65536
    s_waitcnt vmcnt(0)
L_chk_17:
    v_lshl_add_u32 v194, v186, 5, v187
    v_lshl_add_u32 v195, v190, 5, v191
    v_lshl_add_u32 v194, v185, 9, v194
    v_lshl_add_u32 v195, v189, 9, v195
    v_xad_u32 v194, v184, s5, v194
    v_xad_u32 v195, v188, s5, v195
    v_cmp_ne_u32 vcc, v194, v192
    v_cmp_ne_u32 s[10:11], v195, v193
    s_nop 0
    s_or_b64 s[10:11], s[10:11], vcc
    s_and_b64 exec, s[10:11], s[10:11]
    s_cbranch_scc0 L_ok_18
    s_sub_u32 s48, s48, 1
    s_cbranch_scc1 L_ok_18
    buffer_load_dwordx4 v[184:187], v108, s[52:55], s26 offen sc1
    buffer_load_dwordx4 v[188:191], v108, s[52:55], s27 offen sc1
    buffer_load_dword v192, v109, s[52:55], s28 offen sc1
    buffer_load_dword v193, v109, s[52:55], s29 offen sc1
    s_waitcnt vmcnt(0)
    s_branch L_chk_17
L_ok_18:
    s_mov_b64 exec, -1
    ds_write_b128 v111, v[184:187] offset:42368
    ds_write_b128 v111, v[188:191] offset:42880
    buffer_load_dwordx2 v[68:69], v115, s[52:55], s31 offen offset:0 sc1
    buffer_load_dwordx2 v[70:71], v115, s[52:55], s31 offen offset:2048 sc1
    buffer_load_dwordx2 v[72:73], v115, s[52:55], s66 offen offset:0 sc1
    buffer_load_dwordx2 v[74:75], v115, s[52:55], s66 offen offset:2048 sc1
    s_mov_b64 exec, 1
    ds_add_u32 v5, v6 offset:20
    s_mov_b64 exec, -1
L_gb_19:
    ds_read_b32 v7, v5 offset:20
    s_waitcnt lgkmcnt(0)
    v_cmp_gt_u32 vcc, 4, v7
    s_nop 0
    s_cbranch_vccnz L_gb_19
    ds_read_b64_tr_b16 v[184:185], v116 offset:42368
    ds_read_b64_tr_b16 v[186:187], v116 offset:42880
    ds_read_b64_tr_b16 v[188:189], v116 offset:46464
    ds_read_b64_tr_b16 v[190:191], v116 offset:46976
    ds_read_b64_tr_b16 v[192:193], v117 offset:42368
    ds_read_b64_tr_b16 v[194:195], v117 offset:42880
    ds_read_b64_tr_b16 v[196:197], v117 offset:46464
    ds_read_b64_tr_b16 v[198:199], v117 offset:46976
    ds_read_b64_tr_b16 v[200:201], v118 offset:42368
    ds_read_b64_tr_b16 v[202:203], v118 offset:42880
    ds_read_b64_tr_b16 v[204:205], v118 offset:46464
    ds_read_b64_tr_b16 v[206:207], v118 offset:46976
    ds_read_b64_tr_b16 v[208:209], v119 offset:42368
    ds_read_b64_tr_b16 v[210:211], v119 offset:42880
    ds_read_b64_tr_b16 v[212:213], v119 offset:46464
    ds_read_b64_tr_b16 v[214:215], v119 offset:46976
    s_waitcnt lgkmcnt(14)
    v_mfma_f32_16x16x32_bf16 v[136:139], v[184:187], v[88:91], 0
    v_mfma_f32_16x16x32_bf16 v[216:219], v[184:187], v[84:87], 0
    s_waitcnt lgkmcnt(10)
    v_mfma_f32_16x16x32_bf16 v[140:143], v[192:195], v[88:91], 0
    v_mfma_f32_16x16x32_bf16 v[220:223], v[192:195], v[84:87], 0
    v_mfma_f32_16x16x32_bf16 v[136:139], v[188:191], v[96:99], v[136:139]
    s_waitcnt lgkmcnt(6)
    v_mfma_f32_16x16x32_bf16 v[144:147], v[200:203], v[88:91], 0
    v_mfma_f32_16x16x32_bf16 v[216:219], v[188:191], v[92:95], v[216:219]
    s_nop 4
    v_mul_f32 v232, v136, v52
    v_mul_f32 v233, v136, v36
    v_mfma_f32_16x16x32_bf16 v[224:227], v[200:203], v[84:87], 0
    v_mul_f32 v236, v137, v53
    v_mul_f32 v237, v137, v37
    v_mfma_f32_16x16x32_bf16 v[140:143], v[196:199], v[96:99], v[140:143]
    v_mul_f32 v240, v138, v54
    v_mul_f32 v241, v138, v38
    s_waitcnt lgkmcnt(2)
    v_mfma_f32_16x16x32_bf16 v[148:151], v[208:211], v[88:91], 0
    v_mul_f32 v244, v139, v55
    v_mul_f32 v245, v139, v39
    v_mfma_f32_16x16x32_bf16 v[220:223], v[196:199], v[92:95], v[220:223]
    v_fma_f32 v234, v216, v36, -v232
    v_fma_f32 v235, v216, v52, v233
    v_mfma_f32_16x16x32_bf16 v[228:231], v[208:211], v[84:87], 0
    v_fma_f32 v238, v217, v37, -v236
    v_fma_f32 v239, v217, v53, v237
    v_mfma_f32_16x16x32_bf16 v[144:147], v[204:207], v[96:99], v[144:147]
    v_fma_f32 v242, v218, v38, -v240
    v_fma_f32 v243, v218, v54, v241
    v_mfma_f32_16x16x32_bf16 v[224:227], v[204:207], v[92:95], v[224:227]
    v_fma_f32 v246, v219, v39, -v244
    v_fma_f32 v247, v219, v55, v245
    s_waitcnt lgkmcnt(0)
    v_mfma_f32_16x16x32_bf16 v[148:151], v[212:215], v[96:99], v[148:151]
    v_cvt_pk_bf16_f32 v184, v234, v238
    v_cvt_pk_bf16_f32 v188, v235, v239
    v_mfma_f32_16x16x32_bf16 v[228:231], v[212:215], v[92:95], v[228:231]
    v_cvt_pk_bf16_f32 v185, v242, v246
    v_cvt_pk_bf16_f32 v189, v243, v247
    v_mul_f32 v232, v140, v56
    v_mul_f32 v233, v140, v40
    v_mul_f32 v236, v141, v57
    v_mul_f32 v237, v141, v41
    v_mul_f32 v240, v142, v58
    v_mul_f32 v241, v142, v42
    v_mul_f32 v244, v143, v59
    v_mul_f32 v245, v143, v43
    v_fma_f32 v234, v220, v40, -v232
    v_fma_f32 v235, v220, v56, v233
    v_fma_f32 v238, v221, v41, -v236
    v_fma_f32 v239, v221, v57, v237
    v_fma_f32 v242, v222, v42, -v240
    v_fma_f32 v243, v222, v58, v241
    v_fma_f32 v246, v223, v43, -v244
    v_fma_f32 v247, v223, v59, v245
    v_cvt_pk_bf16_f32 v186, v234, v238
    v_cvt_pk_bf16_f32 v190, v235, v239
    v_cvt_pk_bf16_f32 v187, v242, v246
    v_cvt_pk_bf16_f32 v191, v243, v247
    v_mul_f32 v232, v144, v60
    v_mul_f32 v233, v144, v44
    v_mul_f32 v236, v145, v61
    v_mul_f32 v237, v145, v45
    v_mul_f32 v240, v146, v62
    v_mul_f32 v241, v146, v46
    v_mul_f32 v244, v147, v63
    v_mul_f32 v245, v147, v47
    v_fma_f32 v234, v224, v44, -v232
    v_fma_f32 v235, v224, v60, v233
    v_fma_f32 v238, v225, v45, -v236
    v_fma_f32 v239, v225, v61, v237
    v_fma_f32 v242, v226, v46, -v240
    v_fma_f32 v243, v226, v62, v241
    v_fma_f32 v246, v227, v47, -v244
    v_fma_f32 v247, v227, v63, v245
    v_cvt_pk_bf16_f32 v192, v234, v238
    v_cvt_pk_bf16_f32 v196, v235, v239
    v_cvt_pk_bf16_f32 v193, v242, v246
    v_cvt_pk_bf16_f32 v197, v243, v247
    v_mul_f32 v232, v148, v64
    v_mul_f32 v233, v148, v48
    v_mul_f32 v236, v149, v65
    v_mul_f32 v237, v149, v49
    v_mul_f32 v240, v150, v66
    v_mul_f32 v241, v150, v50
    v_mul_f32 v244, v151, v67
    v_mul_f32 v245, v151, v51
    v_fma_f32 v234, v228, v48, -v232
    v_fma_f32 v235, v228, v64, v233
    v_fma_f32 v238, v229, v49, -v236
    v_fma_f32 v239, v229, v65, v237
    v_fma_f32 v242, v230, v50, -v240
    v_fma_f32 v243, v230, v66, v241
    v_fma_f32 v246, v231, v51, -v244
    v_fma_f32 v247, v231, v67, v245
    v_mfma_f32_16x16x32_bf16 v[200:203], v[184:187], v[152:155], 0
    v_cvt_pk_bf16_f32 v194, v234, v238
    v_cvt_pk_bf16_f32 v198, v235, v239
    v_mfma_f32_16x16x32_bf16 v[208:211], v[188:191], v[168:171], 0
    v_cvt_pk_bf16_f32 v195, v242, v246
    v_cvt_pk_bf16_f32 v199, v243, v247
    v_mfma_f32_16x16x32_bf16 v[204:207], v[184:187], v[156:159], 0
    v_mfma_f32_16x16x32_bf16 v[212:215], v[188:191], v[172:175], 0
    v_mfma_f32_16x16x32_bf16 v[200:203], v[192:195], v[160:163], v[200:203]
    v_mfma_f32_16x16x32_bf16 v[208:211], v[196:199], v[176:179], v[208:211]
    v_mfma_f32_16x16x32_bf16 v[204:207], v[192:195], v[164:167], v[204:207]
    v_mfma_f32_16x16x32_bf16 v[212:215], v[196:199], v[180:183], v[212:215]
    s_mov_b32 s48, 65536
    s_waitcnt vmcnt(0)
L_chk_20:
    v_xad_u32 v232, v68, s5, 0
    v_xad_u32 v233, v70, s5, 0
    v_xad_u32 v234, v72, s5, 0
    v_xad_u32 v235, v74, s5, 0
    v_cmp_ne_u32 s[10:11], v232, v69
    v_cmp_ne_u32 vcc, v233, v71
    s_nop 0
    s_or_b64 s[10:11], s[10:11], vcc
    v_cmp_ne_u32 vcc, v234, v73
    s_nop 0
    s_or_b64 s[10:11], s[10:11], vcc
    v_cmp_ne_u32 vcc, v235, v75
    s_nop 0
    s_or_b64 s[10:11], s[10:11], vcc
    s_and_b64 exec, s[10:11], s[10:11]
    s_cbranch_scc0 L_ok_21
    s_sub_u32 s48, s48, 1
    s_cbranch_scc1 L_ok_21
    buffer_load_dwordx2 v[68:69], v115, s[52:55], s31 offen offset:0 sc1
    buffer_load_dwordx2 v[70:71], v115, s[52:55], s31 offen offset:2048 sc1
    buffer_load_dwordx2 v[72:73], v115, s[52:55], s66 offen offset:0 sc1
    buffer_load_dwordx2 v[74:75], v115, s[52:55], s66 offen offset:2048 sc1
    s_waitcnt vmcnt(0)
    s_branch L_chk_20
L_ok_21:
    s_mov_b64 exec, -1
    v_mov_b32 v76, v68
    v_mov_b32 v77, v70
    v_mov_b32 v78, v72
    v_mov_b32 v79, v74
    s_nop 1
    v_mfma_f32_16x16x32_bf16 v[200:203], v[100:103], v[76:79], v[200:203]
    v_mfma_f32_16x16x32_bf16 v[204:207], v[100:103], v[76:79], v[204:207]
    s_nop 6
    v_sub_f32 v232, v200, v208
    v_sub_f32 v233, v201, v209
    v_sub_f32 v234, v202, v210
    v_sub_f32 v235, v203, v211
    v_sub_f32 v240, v204, v212
    v_sub_f32 v241, v205, v213
    v_sub_f32 v242, v206, v214
    v_sub_f32 v243, v207, v215
    v_add_f32 v236, v200, v208
    v_add_f32 v237, v201, v209
    v_add_f32 v238, v202, v210
    v_add_f32 v239, v203, v211
    v_add_f32 v244, v204, v212
    v_add_f32 v245, v205, v213
    v_add_f32 v246, v206, v214
    v_add_f32 v247, v207, v215
    v_cvt_pk_bf16_f32 v216, v232, v233
    v_cvt_pk_bf16_f32 v217, v234, v235
    v_cvt_pk_bf16_f32 v218, v240, v241
    v_cvt_pk_bf16_f32 v219, v242, v243
    v_cvt_pk_bf16_f32 v220, v236, v237
    v_cvt_pk_bf16_f32 v221, v238, v239
    v_cvt_pk_bf16_f32 v222, v244, v245
    v_cvt_pk_bf16_f32 v223, v246, v247
    v_permlane16_swap_b32 v216, v218
    v_permlane16_swap_b32 v217, v219
    v_permlane16_swap_b32 v220, v222
    v_permlane16_swap_b32 v221, v223
    buffer_store_dwordx4 v[216:219], v120, s[56:59], s30 offen nt
    buffer_store_dwordx4 v[220:223], v121, s[56:59], s30 offen nt
    s_endpgm
L_A:
    s_barrier
    v_and_b32 v76, 3, v2
    v_lshrrev_b32 v79, 1, v3
    v_lshl_add_u32 v81, v79, 2, v76
    v_lshrrev_b32 v77, 2, v2
    v_lshlrev_b32 v81, 10, v81
    v_and_b32 v78, 1, v3
    v_lshrrev_b32 v80, 3, v2
    v_lshl_add_u32 v81, v77, 7, v81
    v_lshl_add_u32 v81, v78, 3, v81
    v_lshl_add_u32 v82, v76, 1, v80
    v_lshl_add_u32 v81, v82, 4, v81
    s_lshl_b32 s7, s4, 5
    v_xor_b32 v64, s7, v81
    s_lshl_b32 s7, s44, 4
    s_add_u32 s7, s7, 36
    s_mul_i32 s25, s44, 4576
    s_add_u32 s25, s25, 112448
    s_mul_i32 s26, s44, 1600
    s_add_u32 s26, s26, 109248
    s_mul_i32 s27, s44, 28832
    s_add_u32 s27, s27, 51584
    s_lshl_b32 s28, s45, 8
    v_mov_b32 v73, s7
    s_lshl_b32 s29, s4, 11
    s_lshl_b32 s7, s8, 5
    s_add_u32 s7, s7, s9
    s_mul_i32 s12, s7, 10240
    s_add_u32 s12, s12, 4259840
    s_add_u32 s16, s12, s29
    s_lshl_b32 s7, s4, 9
    s_add_u32 s31, s12, s7
    s_add_u32 s31, s31, 8192
    s_lshr_b32 s12, s2, 5
    s_mul_i32 s34, s4, 40960
    s_mul_i32 s12, s12, 327680
    s_add_u32 s12, s12, s34
    s_add_u32 s12, s12, 4259840
    s_lshl_b32 s13, s2, 1
    s_and_b32 s13, s13, 63
    s_lshl_b32 s17, s13, 7
    s_add_u32 s17, s17, s12
    s_lshl_b32 s18, s13, 5
    s_add_u32 s18, s18, s12
    s_add_u32 s18, s18, 8192
    s_add_u32 s37, s17, 163840
    s_add_u32 s38, s18, 163840
    s_mul_i32 s12, s2, 10240
    s_add_u32 s12, s12, 6881280
    s_add_u32 s19, s12, s29
    s_lshl_b32 s35, s45, 10
    s_lshl_b32 s13, s44, 5
    s_add_u32 s35, s35, s13
    s_add_u32 s35, s35, s12
    s_add_u32 s35, s35, 8192
    s_mul_i32 s12, s8, 327680
    s_add_u32 s12, s12, s34
    s_add_u32 s12, s12, 6881280
    s_lshl_b32 s20, s9, 7
    s_add_u32 s20, s20, s12
    s_add_u32 s21, s20, 163840
    s_lshl_b32 s22, s9, 6
    s_add_u32 s22, s22, s12
    v_mov_b32 v84, 0
    v_mov_b32 v85, 0
    v_mov_b32 v86, 0
    v_mov_b32 v87, 0
    v_add_u32 v88, s25, v8
    v_mov_b32 v89, s26
    s_add_u32 s22, s22, 8192
    ds_write_b128 v88, v[84:87]
    ds_write_b128 v89, v[84:87]
    s_add_u32 s36, s22, 163840
    s_lshl_b32 s23, s9, 17
    s_lshl_b32 s12, s8, 7
    s_add_u32 s23, s23, s12
    s_lshl_b32 s7, s4, 15
    v_lshl_add_u32 v83, v79, 2, v77
    s_add_u32 s23, s23, s7
    v_lshl_add_u32 v82, v78, 2, v76
    v_lshlrev_b32 v83, 4, v83
    s_add_u32 s24, s23, 16384
    v_lshl_add_u32 v66, v82, 7, v83
    s_add_u32 s32, s32, s12
    v_xor_b32 v65, 16, v64
    v_lshrrev_b32 v67, 2, v66
    s_addc_u32 s33, s33, 0
    s_mul_i32 s39, s4, 14416
    s_waitcnt lgkmcnt(0)
    s_mul_i32 s5, s6, 0x9e3779b1
    s_add_u32 s5, s5, 0x7f4a7c15
    s_mov_b64 exec, 1
    ds_add_u32 v5, v6 offset:24
    s_mov_b64 exec, -1
    v_sub_u32 v96, 5, v3
    v_xor_b32 v105, 3, v76
    v_lshl_add_u32 v108, v78, 4, v2
    v_and_b32 v92, 7, v1
    v_and_b32 v95, 1, v2
    v_min_u32 v96, 4, v96
    v_lshlrev_b32 v97, 3, v3
    s_mov_b32 s7, 0x60400100
    v_mul_u32_u24 v105, 4160, v105
    v_lshlrev_b32 v106, 3, v77
    v_lshl_add_u32 v108, v108, 1, v79
    v_lshlrev_b32 v93, 4, v3
    v_lshl_add_u32 v95, v95, 2, v77
    v_lshlrev_b32 v23, v96, 16
    v_bfe_u32 v98, s7, v97, 8
    v_bfe_u32 v100, v1, 1, 2
    v_mul_u32_u24 v102, 10240, v3
    v_mul_u32_u24 v104, 4576, v80
    v_sub_u32 v105, v105, v106
    v_and_b32 v110, 7, v108
    v_xor_b32 v112, v78, v92
    v_and_b32 v113, 2, v2
    v_mul_u32_u24 v94, 272, v2
    v_mul_u32_u24 v95, 272, v95
    v_lshlrev_b32 v96, v96, v2
    s_mov_b32 s7, 0x80040404
    v_lshlrev_b32 v99, 6, v3
    v_mul_u32_u24 v100, 4160, v100
    v_and_b32 v101, 1, v1
    v_lshl_add_u32 v103, v92, 4, v102
    v_lshl_add_u32 v104, v92, 4, v104
    v_add_u32 v105, 280, v105
    v_lshl_add_u32 v107, v2, 5, v93
    v_lshrrev_b32 v109, 3, v108
    v_lshlrev_b32 v110, 2, v110
    v_lshl_add_u32 v111, v3, 1, v80
    v_lshlrev_b32 v112, 4, v112
    v_lshlrev_b32 v113, 3, v113
    v_add_u32 v20, v94, v93
    v_add_u32 v21, v95, v93
    v_lshl_add_u32 v22, v98, 3, v96
    v_bfe_u32 v24, s7, v97, 8
    v_lshl_add_u32 v25, v2, 1, v99
    v_lshlrev_b32 v26, 5, v1
    v_lshl_add_u32 v27, v101, 4, v100
    v_lshl_add_u32 v28, v2, 4, v102
    v_lshl_add_u32 v29, v2, 2, v102
    v_lshl_add_u32 v35, v80, 12, v103
    v_lshl_add_u32 v30, v3, 7, v104
    v_add_u32 v31, v105, v93
    v_add_u32 v32, 256, v107
    v_lshlrev_b32 v33, 4, v108
    v_lshl_add_u32 v34, v109, 6, v110
    v_lshl_add_u32 v36, v111, 7, v112
    v_xor_b32 v37, v113, v66
    v_mov_b32 v39, v83
    v_lshl_add_u32 v38, v82, 11, v83
    s_lshl_b32 s7, s45, 10
    s_sub_u32 s7, 2047, s7
    v_sub_u32 v92, s7, v8
    v_max_i32 v93, 255, v92
    v_cvt_f32_i32 v94, v93
    v_sub_u32 v92, v92, v93
    s_sub_u32 s7, s26, 34032
    v_add_f32 v95, 0xbf800000, v94
    v_add_f32 v96, 0xc0000000, v94
    v_add_f32 v97, 0xc0400000, v94
    v_add_f32 v98, 0xc0800000, v94
    v_add_f32 v99, 0xc0a00000, v94
    v_add_f32 v100, 0xc0c00000, v94
    v_add_f32 v101, 0xc0e00000, v94
    v_add_f32 v102, 0xc1000000, v94
    v_add_f32 v103, 0xc1100000, v94
    v_add_f32 v104, 0xc1200000, v94
    v_add_f32 v105, 0xc1300000, v94
    v_add_f32 v106, 0xc1400000, v94
    v_add_f32 v107, 0xc1500000, v94
    v_add_f32 v108, 0xc1600000, v94
    v_add_f32 v109, 0xc1700000, v94
    v_add_f32 v110, 0xc1800000, v94
    v_add_f32 v111, 0xc1880000, v94
    v_add_f32 v112, 0xc1900000, v94
    v_add_f32 v113, 0xc1980000, v94
    v_lshl_add_u32 v92, v92, 1, s7
    v_cvt_pk_bf16_f32 v116, v94, v95
    v_cvt_pk_bf16_f32 v117, v96, v97
    v_cvt_pk_bf16_f32 v118, v98, v99
    v_cvt_pk_bf16_f32 v119, v100, v101
    v_cvt_pk_bf16_f32 v120, v102, v103
    v_cvt_pk_bf16_f32 v121, v104, v105
    v_cvt_pk_bf16_f32 v122, v106, v107
    v_cvt_pk_bf16_f32 v123, v108, v109
    v_cvt_pk_bf16_f32 v124, v110, v111
    v_cvt_pk_bf16_f32 v125, v112, v113
    v_mad_u32_u16 v40, v116, 2, v92 op_sel:[0,0,0,0]
    v_mad_u32_u16 v41, v116, 2, v92 op_sel:[1,0,0,0]
    v_mad_u32_u16 v42, v117, 2, v92 op_sel:[0,0,0,0]
    v_mad_u32_u16 v43, v117, 2, v92 op_sel:[1,0,0,0]
    v_mad_u32_u16 v44, v118, 2, v92 op_sel:[0,0,0,0]
    v_mad_u32_u16 v45, v118, 2, v92 op_sel:[1,0,0,0]
    v_mad_u32_u16 v46, v119, 2, v92 op_sel:[0,0,0,0]
    v_mad_u32_u16 v47, v119, 2, v92 op_sel:[1,0,0,0]
    v_mad_u32_u16 v48, v120, 2, v92 op_sel:[0,0,0,0]
    v_mad_u32_u16 v49, v120, 2, v92 op_sel:[1,0,0,0]
    v_mad_u32_u16 v50, v121, 2, v92 op_sel:[0,0,0,0]
    v_mad_u32_u16 v51, v121, 2, v92 op_sel:[1,0,0,0]
    v_mad_u32_u16 v52, v122, 2, v92 op_sel:[0,0,0,0]
    v_mad_u32_u16 v53, v122, 2, v92 op_sel:[1,0,0,0]
    v_mad_u32_u16 v54, v123, 2, v92 op_sel:[0,0,0,0]
    v_mad_u32_u16 v55, v123, 2, v92 op_sel:[1,0,0,0]
    v_mad_u32_u16 v56, v124, 2, v92 op_sel:[0,0,0,0]
    v_mad_u32_u16 v57, v124, 2, v92 op_sel:[1,0,0,0]
    v_mad_u32_u16 v58, v125, 2, v92 op_sel:[0,0,0,0]
    s_setprio 1
    s_waitcnt vmcnt(8)
    v_lshlrev_b32 v19, 16, v19
    s_mov_b32 s46, 0x3fb8aa3b
    v_mul_f32 v74, s46, v19
    s_mov_b32 s47, 0x32a57060
    v_fma_f32 v75, v19, s46, -v74
    v_fma_f32 v75, v19, s47, v75
    v_exp_f32 v76, v74
    v_mul_f32 v75, 0x3f317218, v75
    v_fma_f32 v76, v76, v75, v76
    v_cvt_pk_bf16_f32 v76, v76, v76
    s_waitcnt vmcnt(6)
    v_lshlrev_b32 v14, 16, v14
    v_and_b32 v76, 0xffff0000, v76
    v_mul_f32 v14, v76, v14
    v_lshlrev_b32 v13, 16, v13
    v_mul_f32 v14, 0x3e22f983, v14
    v_mul_f32 v13, v76, v13
    v_mul_f32 v80, 0x41000000, v14
    v_mul_f32 v83, 0x3f800000, v14
    v_mul_f32 v86, 0x43800000, v14
    v_mul_f32 v13, 0x3fb8aa3b, v13
    v_fract_f32 v80, v80
    v_fract_f32 v83, v83
    v_fract_f32 v86, v86
    s_waitcnt vmcnt(5)
    v_lshlrev_b32 v15, 16, v15
    s_waitcnt vmcnt(4)
    v_lshlrev_b32 v16, 16, v16
    v_mul_f32 v79, 0x41000000, v13
    v_cos_f32 v81, v80
    v_mul_f32 v82, 0x3f800000, v13
    v_cos_f32 v84, v83
    v_mul_f32 v85, 0x43800000, v13
    v_cos_f32 v87, v86
    s_waitcnt vmcnt(2)
    v_lshlrev_b32 v18, 16, v18
    v_mul_f32 v15, v76, v15
    v_mul_f32 v16, v76, v16
    v_exp_f32 v79, v79
    v_sin_f32 v80, v80
    v_exp_f32 v82, v82
    v_sin_f32 v83, v83
    v_exp_f32 v85, v85
    v_sin_f32 v86, v86
    v_lshlrev_b32 v17, 16, v17
    v_mul_f32 v77, v18, v16
    v_mul_f32 v78, v18, v15
    v_fma_f32 v96, v17, v15, -v77
    v_fma_f32 v97, v17, v16, v78
    v_mul_f32 v92, v79, v81
    v_mul_f32 v93, v79, v80
    v_mul_f32 v90, v82, v84
    v_mul_f32 v91, v82, v83
    v_mul_f32 v94, v85, v87
    v_mul_f32 v95, v85, v86
    s_setprio 3
    s_waitcnt vmcnt(0)
    s_mov_b64 exec, 1
    ds_add_u32 v5, v6 offset:28
    s_mov_b64 exec, -1
L_gb_22:
    ds_read_b32 v7, v5 offset:28
    s_waitcnt lgkmcnt(0)
    v_cmp_gt_u32 vcc, 4, v7
    s_nop 0
    s_cbranch_vccnz L_gb_22
    ds_read_b64_tr_b16 v[164:165], v64 offset:128
    ds_read_b64_tr_b16 v[166:167], v64 offset:640
    ds_read_b64_tr_b16 v[168:169], v65 offset:128
    ds_read_b64_tr_b16 v[170:171], v65 offset:640
    s_waitcnt lgkmcnt(2)
    v_lshl_add_u32 v172, v166, 5, v167
    v_lshl_add_u32 v172, v165, 9, v172
    s_waitcnt lgkmcnt(0)
    v_lshl_add_u32 v173, v170, 5, v171
    v_lshl_add_u32 v173, v169, 9, v173
    v_xad_u32 v172, v164, s5, v172
    v_xad_u32 v173, v168, s5, v173
    buffer_store_dwordx4 v[164:167], v66, s[52:55], s16 offen offset:0 sc1
    buffer_store_dwordx4 v[168:171], v66, s[52:55], s16 offen offset:1024 sc1
    buffer_store_dword v172, v67, s[52:55], s31 offen offset:0 sc1
    buffer_store_dword v173, v67, s[52:55], s31 offen offset:256 sc1
    s_setprio 1
    v_pk_mul_f32 v[146:147], v[92:93], v[92:93] op_sel:[0,0] op_sel_hi:[1,0]
    v_pk_fma_f32 v[142:143], v[92:93], v[92:93], v[146:147] op_sel:[1,1,0] op_sel_hi:[0,1,1] neg_lo:[1,0,0]
    v_pk_mul_f32 v[150:151], v[142:143], v[92:93] op_sel:[0,0] op_sel_hi:[1,0]
    v_pk_fma_f32 v[144:145], v[142:143], v[92:93], v[150:151] op_sel:[1,1,0] op_sel_hi:[0,1,1] neg_lo:[1,0,0]
    v_pk_mul_f32 v[146:147], v[144:145], v[92:93] op_sel:[0,0] op_sel_hi:[1,0]
    v_pk_fma_f32 v[138:139], v[144:145], v[92:93], v[146:147] op_sel:[1,1,0] op_sel_hi:[0,1,1] neg_lo:[1,0,0]
    v_pk_mul_f32 v[150:151], v[138:139], v[92:93] op_sel:[0,0] op_sel_hi:[1,0]
    v_pk_fma_f32 v[140:141], v[138:139], v[92:93], v[150:151] op_sel:[1,1,0] op_sel_hi:[0,1,1] neg_lo:[1,0,0]
    v_cvt_pk_bf16_f32 v156, v142, v143
    v_pk_mul_f32 v[146:147], v[140:141], v[92:93] op_sel:[0,0] op_sel_hi:[1,0]
    v_pk_fma_f32 v[142:143], v[140:141], v[92:93], v[146:147] op_sel:[1,1,0] op_sel_hi:[0,1,1] neg_lo:[1,0,0]
    s_add_u32 s7, s39, 16384
    v_cvt_pk_bf16_f32 v158, v144, v145
    v_pk_mul_f32 v[150:151], v[142:143], v[92:93] op_sel:[0,0] op_sel_hi:[1,0]
    s_mov_b32 m0, s7
    v_pk_fma_f32 v[144:145], v[142:143], v[92:93], v[150:151] op_sel:[1,1,0] op_sel_hi:[0,1,1] neg_lo:[1,0,0]
    v_mov_b32 v161, 0x3f80
    v_cvt_pk_bf16_f32 v154, v92, v93
    v_cvt_pk_bf16_f32 v160, v138, v139
    v_pk_mul_f32 v[146:147], v[144:145], v[92:93] op_sel:[0,0] op_sel_hi:[1,0]
    ds_write_addtid_b32 v161 offset:40912
    ds_write_addtid_b32 v154 offset:41184
    v_pk_fma_f32 v[138:139], v[144:145], v[92:93], v[146:147] op_sel:[1,1,0] op_sel_hi:[0,1,1] neg_lo:[1,0,0]
    v_cvt_pk_bf16_f32 v155, v96, -v97
    v_pk_mul_f32 v[148:149], v[96:97], v[90:91] op_sel:[0,0] op_sel_hi:[1,0]
    v_cvt_pk_bf16_f32 v154, v140, v141
    v_pk_mul_f32 v[150:151], v[138:139], v[92:93] op_sel:[0,0] op_sel_hi:[1,0]
    ds_write_addtid_b32 v155 offset:35200
    ds_write_addtid_b32 v156 offset:41456
    v_pk_fma_f32 v[98:99], v[96:97], v[90:91], v[148:149] op_sel:[1,1,0] op_sel_hi:[0,1,1] neg_lo:[1,0,0]
    v_pk_fma_f32 v[140:141], v[138:139], v[92:93], v[150:151] op_sel:[1,1,0] op_sel_hi:[0,1,1] neg_lo:[1,0,0]
    v_cvt_pk_bf16_f32 v157, v98, -v99
    v_pk_mul_f32 v[152:153], v[98:99], v[90:91] op_sel:[0,0] op_sel_hi:[1,0]
    v_cvt_pk_bf16_f32 v156, v142, v143
    v_pk_mul_f32 v[146:147], v[140:141], v[92:93] op_sel:[0,0] op_sel_hi:[1,0]
    ds_write_addtid_b32 v157 offset:35472
    ds_write_addtid_b32 v158 offset:41728
    v_pk_fma_f32 v[100:101], v[98:99], v[90:91], v[152:153] op_sel:[1,1,0] op_sel_hi:[0,1,1] neg_lo:[1,0,0]
    v_pk_fma_f32 v[142:143], v[140:141], v[92:93], v[146:147] op_sel:[1,1,0] op_sel_hi:[0,1,1] neg_lo:[1,0,0]
    v_cvt_pk_bf16_f32 v159, v100, -v101
    v_pk_mul_f32 v[148:149], v[100:101], v[90:91] op_sel:[0,0] op_sel_hi:[1,0]
    v_cvt_pk_bf16_f32 v158, v144, v145
    v_pk_mul_f32 v[150:151], v[142:143], v[92:93] op_sel:[0,0] op_sel_hi:[1,0]
    ds_write_addtid_b32 v159 offset:35744
    ds_write_addtid_b32 v160 offset:42000
    v_pk_fma_f32 v[102:103], v[100:101], v[90:91], v[148:149] op_sel:[1,1,0] op_sel_hi:[0,1,1] neg_lo:[1,0,0]
    v_pk_fma_f32 v[144:145], v[142:143], v[92:93], v[150:151] op_sel:[1,1,0] op_sel_hi:[0,1,1] neg_lo:[1,0,0]
    v_cvt_pk_bf16_f32 v161, v102, -v103
    v_pk_mul_f32 v[152:153], v[102:103], v[90:91] op_sel:[0,0] op_sel_hi:[1,0]
    v_cvt_pk_bf16_f32 v160, v138, v139
    v_pk_mul_f32 v[146:147], v[144:145], v[92:93] op_sel:[0,0] op_sel_hi:[1,0]
    ds_write_addtid_b32 v161 offset:36016
    ds_write_addtid_b32 v154 offset:42272
    v_pk_fma_f32 v[104:105], v[102:103], v[90:91], v[152:153] op_sel:[1,1,0] op_sel_hi:[0,1,1] neg_lo:[1,0,0]
    v_pk_fma_f32 v[138:139], v[144:145], v[92:93], v[146:147] op_sel:[1,1,0] op_sel_hi:[0,1,1] neg_lo:[1,0,0]
    v_cvt_pk_bf16_f32 v155, v104, -v105
    v_pk_mul_f32 v[148:149], v[104:105], v[90:91] op_sel:[0,0] op_sel_hi:[1,0]
    v_cvt_pk_bf16_f32 v154, v140, v141
    v_pk_mul_f32 v[150:151], v[138:139], v[92:93] op_sel:[0,0] op_sel_hi:[1,0]
    ds_write_addtid_b32 v155 offset:36288
    ds_write_addtid_b32 v156 offset:42544
    v_pk_fma_f32 v[106:107], v[104:105], v[90:91], v[148:149] op_sel:[1,1,0] op_sel_hi:[0,1,1] neg_lo:[1,0,0]
    v_pk_fma_f32 v[140:141], v[138:139], v[92:93], v[150:151] op_sel:[1,1,0] op_sel_hi:[0,1,1] neg_lo:[1,0,0]
    v_cvt_pk_bf16_f32 v157, v106, -v107
    v_pk_mul_f32 v[152:153], v[106:107], v[90:91] op_sel:[0,0] op_sel_hi:[1,0]
    v_cvt_pk_bf16_f32 v156, v142, v143
    v_pk_mul_f32 v[146:147], v[140:141], v[92:93] op_sel:[0,0] op_sel_hi:[1,0]
    ds_write_addtid_b32 v157 offset:36560
    ds_write_addtid_b32 v158 offset:42816
    v_pk_fma_f32 v[108:109], v[106:107], v[90:91], v[152:153] op_sel:[1,1,0] op_sel_hi:[0,1,1] neg_lo:[1,0,0]
    v_pk_fma_f32 v[142:143], v[140:141], v[92:93], v[146:147] op_sel:[1,1,0] op_sel_hi:[0,1,1] neg_lo:[1,0,0]
    v_cvt_pk_bf16_f32 v159, v108, -v109
    v_pk_mul_f32 v[148:149], v[108:109], v[90:91] op_sel:[0,0] op_sel_hi:[1,0]
    v_pk_mul_f32 v[152:153], v[96:97], v[94:95] op_sel:[0,0] op_sel_hi:[1,0]
    v_cvt_pk_bf16_f32 v158, v144, v145
    v_pk_mul_f32 v[150:151], v[142:143], v[92:93] op_sel:[0,0] op_sel_hi:[1,0]
    ds_write_addtid_b32 v159 offset:36832
    ds_write_addtid_b32 v160 offset:43088
    v_pk_fma_f32 v[110:111], v[108:109], v[90:91], v[148:149] op_sel:[1,1,0] op_sel_hi:[0,1,1] neg_lo:[1,0,0]
    v_pk_fma_f32 v[112:113], v[96:97], v[94:95], v[152:153] op_sel:[1,1,0] op_sel_hi:[0,1,1] neg_lo:[1,0,0]
    v_pk_fma_f32 v[144:145], v[142:143], v[92:93], v[150:151] op_sel:[1,1,0] op_sel_hi:[0,1,1] neg_lo:[1,0,0]
    v_cvt_pk_bf16_f32 v161, v110, -v111
    v_pk_mul_f32 v[148:149], v[100:101], v[94:95] op_sel:[0,0] op_sel_hi:[1,0]
    v_pk_mul_f32 v[152:153], v[104:105], v[94:95] op_sel:[0,0] op_sel_hi:[1,0]
    v_cvt_pk_bf16_f32 v160, v138, v139
    v_pk_mul_f32 v[146:147], v[144:145], v[92:93] op_sel:[0,0] op_sel_hi:[1,0]
    ds_write_addtid_b32 v161 offset:37104
    ds_write_addtid_b32 v154 offset:43360
    v_pk_fma_f32 v[114:115], v[100:101], v[94:95], v[148:149] op_sel:[1,1,0] op_sel_hi:[0,1,1] neg_lo:[1,0,0]
    v_pk_fma_f32 v[116:117], v[104:105], v[94:95], v[152:153] op_sel:[1,1,0] op_sel_hi:[0,1,1] neg_lo:[1,0,0]
    v_pk_fma_f32 v[138:139], v[144:145], v[92:93], v[146:147] op_sel:[1,1,0] op_sel_hi:[0,1,1] neg_lo:[1,0,0]
    v_cvt_pk_bf16_f32 v155, v112, -v113
    v_pk_mul_f32 v[148:149], v[108:109], v[94:95] op_sel:[0,0] op_sel_hi:[1,0]
    v_cvt_pk_bf16_f32 v154, v140, v141
    v_pk_mul_f32 v[152:153], v[112:113], v[94:95] op_sel:[0,0] op_sel_hi:[1,0]
    v_pk_mul_f32 v[150:151], v[138:139], v[92:93] op_sel:[0,0] op_sel_hi:[1,0]
    ds_write_addtid_b32 v155 offset:37376
    ds_write_addtid_b32 v156 offset:43632
    v_pk_fma_f32 v[118:119], v[108:109], v[94:95], v[148:149] op_sel:[1,1,0] op_sel_hi:[0,1,1] neg_lo:[1,0,0]
    v_pk_fma_f32 v[120:121], v[112:113], v[94:95], v[152:153] op_sel:[1,1,0] op_sel_hi:[0,1,1] neg_lo:[1,0,0]
    v_pk_fma_f32 v[140:141], v[138:139], v[92:93], v[150:151] op_sel:[1,1,0] op_sel_hi:[0,1,1] neg_lo:[1,0,0]
    v_cvt_pk_bf16_f32 v157, v114, -v115
    v_cvt_pk_bf16_f32 v156, v142, v143
    v_pk_mul_f32 v[148:149], v[116:117], v[94:95] op_sel:[0,0] op_sel_hi:[1,0]
    v_pk_mul_f32 v[152:153], v[120:121], v[94:95] op_sel:[0,0] op_sel_hi:[1,0]
    v_pk_mul_f32 v[146:147], v[140:141], v[92:93] op_sel:[0,0] op_sel_hi:[1,0]
    ds_write_addtid_b32 v157 offset:37648
    ds_write_addtid_b32 v158 offset:43904
    v_pk_fma_f32 v[122:123], v[116:117], v[94:95], v[148:149] op_sel:[1,1,0] op_sel_hi:[0,1,1] neg_lo:[1,0,0]
    v_pk_fma_f32 v[124:125], v[120:121], v[94:95], v[152:153] op_sel:[1,1,0] op_sel_hi:[0,1,1] neg_lo:[1,0,0]
    v_pk_fma_f32 v[142:143], v[140:141], v[92:93], v[146:147] op_sel:[1,1,0] op_sel_hi:[0,1,1] neg_lo:[1,0,0]
    v_cvt_pk_bf16_f32 v159, v116, -v117
    v_cvt_pk_bf16_f32 v158, v144, v145
    v_pk_mul_f32 v[148:149], v[122:123], v[94:95] op_sel:[0,0] op_sel_hi:[1,0]
    v_pk_mul_f32 v[152:153], v[124:125], v[94:95] op_sel:[0,0] op_sel_hi:[1,0]
    v_pk_mul_f32 v[150:151], v[142:143], v[92:93] op_sel:[0,0] op_sel_hi:[1,0]
    ds_write_addtid_b32 v159 offset:37920
    ds_write_addtid_b32 v160 offset:44176
    v_pk_fma_f32 v[126:127], v[122:123], v[94:95], v[148:149] op_sel:[1,1,0] op_sel_hi:[0,1,1] neg_lo:[1,0,0]
    v_pk_fma_f32 v[128:129], v[124:125], v[94:95], v[152:153] op_sel:[1,1,0] op_sel_hi:[0,1,1] neg_lo:[1,0,0]
    v_pk_fma_f32 v[144:145], v[142:143], v[92:93], v[150:151] op_sel:[1,1,0] op_sel_hi:[0,1,1] neg_lo:[1,0,0]
    v_cvt_pk_bf16_f32 v161, v118, -v119
    v_cvt_pk_bf16_f32 v160, v138, v139
    v_pk_mul_f32 v[148:149], v[128:129], v[94:95] op_sel:[0,0] op_sel_hi:[1,0]
    v_pk_mul_f32 v[146:147], v[144:145], v[92:93] op_sel:[0,0] op_sel_hi:[1,0]
    ds_write_addtid_b32 v161 offset:38192
    ds_write_addtid_b32 v154 offset:44448
    v_pk_fma_f32 v[130:131], v[128:129], v[94:95], v[148:149] op_sel:[1,1,0] op_sel_hi:[0,1,1] neg_lo:[1,0,0]
    v_pk_fma_f32 v[138:139], v[144:145], v[92:93], v[146:147] op_sel:[1,1,0] op_sel_hi:[0,1,1] neg_lo:[1,0,0]
    v_cvt_pk_bf16_f32 v155, v120, -v121
    v_cvt_pk_bf16_f32 v154, v140, v141
    v_pk_mul_f32 v[152:153], v[130:131], v[94:95] op_sel:[0,0] op_sel_hi:[1,0]
    v_pk_mul_f32 v[150:151], v[138:139], v[92:93] op_sel:[0,0] op_sel_hi:[1,0]
    ds_write_addtid_b32 v155 offset:38464
    ds_write_addtid_b32 v156 offset:44720
    v_pk_fma_f32 v[132:133], v[130:131], v[94:95], v[152:153] op_sel:[1,1,0] op_sel_hi:[0,1,1] neg_lo:[1,0,0]
    v_pk_fma_f32 v[140:141], v[138:139], v[92:93], v[150:151] op_sel:[1,1,0] op_sel_hi:[0,1,1] neg_lo:[1,0,0]
    v_cvt_pk_bf16_f32 v157, v122, -v123
    v_cvt_pk_bf16_f32 v156, v142, v143
    v_pk_mul_f32 v[148:149], v[132:133], v[94:95] op_sel:[0,0] op_sel_hi:[1,0]
    v_pk_mul_f32 v[146:147], v[140:141], v[92:93] op_sel:[0,0] op_sel_hi:[1,0]
    ds_write_addtid_b32 v157 offset:38736
    ds_write_addtid_b32 v158 offset:44992
    v_pk_fma_f32 v[134:135], v[132:133], v[94:95], v[148:149] op_sel:[1,1,0] op_sel_hi:[0,1,1] neg_lo:[1,0,0]
    v_pk_fma_f32 v[142:143], v[140:141], v[92:93], v[146:147] op_sel:[1,1,0] op_sel_hi:[0,1,1] neg_lo:[1,0,0]
    v_cvt_pk_bf16_f32 v159, v124, -v125
    v_cvt_pk_bf16_f32 v158, v144, v145
    v_pk_mul_f32 v[148:149], v[142:143], v[92:93] op_sel:[0,0] op_sel_hi:[1,0]
    ds_write_addtid_b32 v159 offset:39008
    ds_write_addtid_b32 v160 offset:45264
    v_pk_fma_f32 v[144:145], v[142:143], v[92:93], v[148:149] op_sel:[1,1,0] op_sel_hi:[0,1,1] neg_lo:[1,0,0]
    v_cvt_pk_bf16_f32 v161, v126, -v127
    v_cvt_pk_bf16_f32 v160, v138, v139
    v_pk_mul_f32 v[152:153], v[134:135], v[94:95] op_sel:[0,0] op_sel_hi:[1,0]
    v_pk_mul_f32 v[150:151], v[144:145], v[92:93] op_sel:[0,0] op_sel_hi:[1,0]
    ds_write_addtid_b32 v161 offset:39280
    ds_write_addtid_b32 v154 offset:45536
    v_pk_fma_f32 v[136:137], v[134:135], v[94:95], v[152:153] op_sel:[1,1,0] op_sel_hi:[0,1,1] neg_lo:[1,0,0]
    v_pk_fma_f32 v[138:139], v[144:145], v[92:93], v[150:151] op_sel:[1,1,0] op_sel_hi:[0,1,1] neg_lo:[1,0,0]
    v_cvt_pk_bf16_f32 v155, v128, -v129
    v_cvt_pk_bf16_f32 v154, v140, v141
    v_pk_mul_f32 v[152:153], v[138:139], v[92:93] op_sel:[0,0] op_sel_hi:[1,0]
    ds_write_addtid_b32 v155 offset:39552
    ds_write_addtid_b32 v156 offset:45808
    v_pk_fma_f32 v[140:141], v[138:139], v[92:93], v[152:153] op_sel:[1,1,0] op_sel_hi:[0,1,1] neg_lo:[1,0,0]
    v_cvt_pk_bf16_f32 v157, v130, -v131
    v_cvt_pk_bf16_f32 v156, v142, v143
    v_pk_mul_f32 v[146:147], v[140:141], v[92:93] op_sel:[0,0] op_sel_hi:[1,0]
    ds_write_addtid_b32 v157 offset:39824
    ds_write_addtid_b32 v158 offset:46080
    v_pk_fma_f32 v[142:143], v[140:141], v[92:93], v[146:147] op_sel:[1,1,0] op_sel_hi:[0,1,1] neg_lo:[1,0,0]
    v_cvt_pk_bf16_f32 v157, v144, v145
    v_pk_mul_f32 v[148:149], v[142:143], v[92:93] op_sel:[0,0] op_sel_hi:[1,0]
    v_pk_fma_f32 v[144:145], v[142:143], v[92:93], v[148:149] op_sel:[1,1,0] op_sel_hi:[0,1,1] neg_lo:[1,0,0]
    v_cvt_pk_bf16_f32 v159, v132, -v133
    v_cvt_pk_bf16_f32 v158, v138, v139
    v_pk_mul_f32 v[150:151], v[144:145], v[92:93] op_sel:[0,0] op_sel_hi:[1,0]
    ds_write_addtid_b32 v159 offset:40096
    ds_write_addtid_b32 v160 offset:46352
    v_pk_fma_f32 v[138:139], v[144:145], v[92:93], v[150:151] op_sel:[1,1,0] op_sel_hi:[0,1,1] neg_lo:[1,0,0]
    v_cvt_pk_bf16_f32 v159, v140, v141
    v_pk_mul_f32 v[152:153], v[138:139], v[92:93] op_sel:[0,0] op_sel_hi:[1,0]
    v_pk_fma_f32 v[140:141], v[138:139], v[92:93], v[152:153] op_sel:[1,1,0] op_sel_hi:[0,1,1] neg_lo:[1,0,0]
    v_cvt_pk_bf16_f32 v161, v134, -v135
    v_cvt_pk_bf16_f32 v160, v142, v143
    v_pk_mul_f32 v[146:147], v[140:141], v[92:93] op_sel:[0,0] op_sel_hi:[1,0]
    ds_write_addtid_b32 v161 offset:40368
    ds_write_addtid_b32 v154 offset:46624
    v_pk_fma_f32 v[142:143], v[140:141], v[92:93], v[146:147] op_sel:[1,1,0] op_sel_hi:[0,1,1] neg_lo:[1,0,0]
    v_cvt_pk_bf16_f32 v155, v136, -v137
    v_cvt_pk_bf16_f32 v161, v144, v145
    v_pk_mul_f32 v[148:149], v[142:143], v[92:93] op_sel:[0,0] op_sel_hi:[1,0]
    ds_write_addtid_b32 v155 offset:40640
    ds_write_addtid_b32 v156 offset:46896
    v_pk_fma_f32 v[144:145], v[142:143], v[92:93], v[148:149] op_sel:[1,1,0] op_sel_hi:[0,1,1] neg_lo:[1,0,0]
    ds_write_addtid_b32 v157 offset:47168
    ds_write_addtid_b32 v158 offset:47440
    v_cvt_pk_bf16_f32 v154, v138, v139
    ds_write_addtid_b32 v159 offset:47712
    ds_write_addtid_b32 v160 offset:47984
    v_cvt_pk_bf16_f32 v155, v140, v141
    v_cvt_pk_bf16_f32 v156, v142, v143
    ds_write_addtid_b32 v161 offset:48256
    ds_write_addtid_b32 v154 offset:48528
    v_cvt_pk_bf16_f32 v157, v144, v145
    ds_write_addtid_b32 v155 offset:48800
    ds_write_addtid_b32 v156 offset:49072
    ds_write_addtid_b32 v157 offset:49344
    s_mov_b64 exec, 1
    ds_add_u32 v73, v6 offset:8
    s_mov_b64 exec, -1
L_gb_23:
    ds_read_b32 v7, v73 offset:8
    s_waitcnt lgkmcnt(0)
    v_cmp_gt_u32 vcc, 2, v7
    s_nop 0
    s_cbranch_vccnz L_gb_23
    v_add_u32 v20, s27, v20
    s_mul_i32 s7, s45, 4352
    v_add_u32 v21, s27, v21
    v_add_u32 v68, s7, v20
    ds_read_b128 v[154:157], v68 offset:5712
    ds_read_b128 v[90:93], v20 offset:0
    s_add_u32 s12, s26, 16
    ds_read_b128 v[122:125], v21 offset:4352
    ds_read_b128 v[158:161], v68 offset:5776
    s_lshl_b32 s7, s45, 5
    ds_read_b128 v[94:97], v20 offset:64
    ds_read_b128 v[126:129], v21 offset:4416
    s_add_u32 s7, s7, s12
    ds_read_b128 v[162:165], v68 offset:5840
    ds_read_b128 v[98:101], v20 offset:128
    v_add_u32 v25, s7, v25
    ds_read_b128 v[130:133], v21 offset:4480
    ds_read_b128 v[166:169], v68 offset:5904
    s_lshl_b32 s7, s45, 11
    ds_read_b128 v[102:105], v20 offset:192
    ds_read_b128 v[134:137], v21 offset:4544
    s_waitcnt lgkmcnt(10)
    v_mfma_f32_16x16x32_bf16 v[186:189], v[90:93], v[154:157], 0
    ds_read_b128 v[170:173], v68 offset:20128
    ds_read_b128 v[106:109], v20 offset:14416
    s_waitcnt lgkmcnt(11)
    v_mfma_f32_16x16x32_bf16 v[190:193], v[122:125], v[154:157], 0
    ds_read_b128 v[138:141], v21 offset:18768
    ds_read_b128 v[174:177], v68 offset:20192
    s_waitcnt lgkmcnt(11)
    v_mfma_f32_16x16x32_bf16 v[186:189], v[94:97], v[158:161], v[186:189]
    ds_read_b128 v[110:113], v20 offset:14480
    ds_read_b128 v[142:145], v21 offset:18832
    s_waitcnt lgkmcnt(12)
    v_mfma_f32_16x16x32_bf16 v[190:193], v[126:129], v[158:161], v[190:193]
    ds_read_b128 v[178:181], v68 offset:20256
    ds_read_b128 v[114:117], v20 offset:14544
    s_waitcnt lgkmcnt(12)
    v_mfma_f32_16x16x32_bf16 v[186:189], v[98:101], v[162:165], v[186:189]
    ds_read_b128 v[146:149], v21 offset:18896
    ds_read_b128 v[182:185], v68 offset:20320
    s_waitcnt lgkmcnt(13)
    v_mfma_f32_16x16x32_bf16 v[190:193], v[130:133], v[162:165], v[190:193]
    ds_read_b128 v[118:121], v20 offset:14608
    ds_read_b128 v[150:153], v21 offset:18960
    s_waitcnt lgkmcnt(13)
    v_mfma_f32_16x16x32_bf16 v[186:189], v[102:105], v[166:169], v[186:189]
    s_add_u32 s7, s7, s27
    v_add_u32 v26, s7, v26
    s_waitcnt lgkmcnt(12)
    v_mfma_f32_16x16x32_bf16 v[190:193], v[134:137], v[166:169], v[190:193]
    v_mad_u32_u24 v22, v23, s45, v22
    s_sub_u32 s7, s27, s28
    s_waitcnt lgkmcnt(10)
    v_mfma_f32_16x16x32_bf16 v[186:189], v[106:109], v[170:173], v[186:189]
    v_add_u32 v22, s12, v22
    v_add_u32 v31, s7, v31
    s_waitcnt lgkmcnt(9)
    v_mfma_f32_16x16x32_bf16 v[190:193], v[138:141], v[170:173], v[190:193]
    v_add_u32 v69, v22, v24
    s_sub_u32 s7, s25, s28
    s_waitcnt lgkmcnt(7)
    v_mfma_f32_16x16x32_bf16 v[186:189], v[110:113], v[174:177], v[186:189]
    v_add_u32 v32, s7, v32
    s_lshl_b32 s7, s4, 9
    s_waitcnt lgkmcnt(6)
    v_mfma_f32_16x16x32_bf16 v[190:193], v[142:145], v[174:177], v[190:193]
    s_add_u32 s7, s7, 112928
    v_add_u32 v27, s27, v27
    s_waitcnt lgkmcnt(4)
    v_mfma_f32_16x16x32_bf16 v[186:189], v[114:117], v[178:181], v[186:189]
    v_add_u32 v30, s7, v30
    s_waitcnt lgkmcnt(3)
    v_mfma_f32_16x16x32_bf16 v[190:193], v[146:149], v[178:181], v[190:193]
    s_waitcnt lgkmcnt(1)
    v_mfma_f32_16x16x32_bf16 v[186:189], v[118:121], v[182:185], v[186:189]
    s_waitcnt lgkmcnt(0)
    v_mfma_f32_16x16x32_bf16 v[190:193], v[150:153], v[182:185], v[190:193]
    s_nop 5
    v_cvt_pk_bf16_f32 v194, v186, v187
    v_cvt_pk_bf16_f32 v195, v188, v189
    ds_write_b32 v22, v194
    ds_write_b32 v69, v195
    v_cvt_pk_bf16_f32 v196, v190, v191
    ds_write_b16 v25, v196 offset:1024
    ds_write_b16_d16_hi v25, v196 offset:1280
    buffer_load_dwordx4 v[76:79], v28, s[52:55], s17 offen sc1
    buffer_load_dwordx4 v[80:83], v28, s[52:55], s37 offen sc1
    buffer_load_dword v84, v29, s[52:55], s18 offen sc1
    buffer_load_dword v85, v29, s[52:55], s38 offen sc1
    global_load_dwordx4 v[60:63], v39, s[32:33]
    s_mov_b64 exec, 1
    ds_add_u32 v73, v6 offset:0
    s_mov_b64 exec, -1
L_gb_24:
    ds_read_b32 v7, v73 offset:0
    s_waitcnt lgkmcnt(0)
    v_cmp_gt_u32 vcc, 2, v7
    s_nop 0
    s_cbranch_vccnz L_gb_24
    ds_read_u16 v88, v40
    ds_read_u16 v89, v41
    s_mov_b32 s47, 0x05040100
    ds_read_u16 v90, v42
    ds_read_u16 v91, v43
    v_mov_b32 v140, 0
    ds_read_u16 v92, v44
    ds_read_u16 v93, v45
    v_mov_b32 v141, 0
    ds_read_u16 v94, v46
    ds_read_u16 v95, v47
    v_mov_b32 v142, 0
    ds_read_u16 v96, v48
    ds_read_u16 v97, v49
    v_mov_b32 v143, 0
    ds_read_u16 v98, v50
    ds_read_u16 v99, v51
    s_waitcnt lgkmcnt(10)
    v_perm_b32 v108, v89, v88, s47
    ds_read_u16 v100, v52
    ds_read_u16 v101, v53
    s_waitcnt lgkmcnt(10)
    v_perm_b32 v109, v91, v90, s47
    ds_read_u16 v102, v54
    ds_read_u16 v103, v55
    s_waitcnt lgkmcnt(10)
    v_perm_b32 v110, v93, v92, s47
    ds_read_u16 v104, v56
    ds_read_u16 v105, v57
    s_waitcnt lgkmcnt(10)
    v_perm_b32 v111, v95, v94, s47
    ds_read_u16 v106, v58
    ds_write_b128 v27, v[140:143] offset:4096
    s_waitcnt lgkmcnt(10)
    v_perm_b32 v112, v97, v96, s47
    s_waitcnt lgkmcnt(8)
    v_perm_b32 v113, v99, v98, s47
    s_waitcnt lgkmcnt(6)
    v_perm_b32 v114, v101, v100, s47
    v_perm_b32 v116, v90, v89, s47
    v_perm_b32 v117, v92, v91, s47
    v_perm_b32 v118, v94, v93, s47
    v_perm_b32 v119, v96, v95, s47
    s_waitcnt lgkmcnt(4)
    v_perm_b32 v115, v103, v102, s47
    v_perm_b32 v120, v98, v97, s47
    v_perm_b32 v121, v100, v99, s47
    v_perm_b32 v122, v102, v101, s47
    s_waitcnt lgkmcnt(3)
    v_perm_b32 v123, v104, v103, s47
    ds_write_b128 v26, v[108:111] offset:0
    ds_write_b128 v26, v[112:115] offset:16
    v_perm_b32 v124, v91, v90, s47
    v_perm_b32 v125, v93, v92, s47
    v_perm_b32 v126, v95, v94, s47
    v_perm_b32 v127, v97, v96, s47
    v_perm_b32 v128, v99, v98, s47
    v_perm_b32 v129, v101, v100, s47
    v_perm_b32 v130, v103, v102, s47
    s_waitcnt lgkmcnt(4)
    v_perm_b32 v131, v105, v104, s47
    ds_write_b128 v26, v[116:119] offset:4160
    ds_write_b128 v26, v[120:123] offset:4176
    v_perm_b32 v132, v92, v91, s47
    v_perm_b32 v133, v94, v93, s47
    v_perm_b32 v134, v96, v95, s47
    v_perm_b32 v135, v98, v97, s47
    v_perm_b32 v136, v100, v99, s47
    v_perm_b32 v137, v102, v101, s47
    v_perm_b32 v138, v104, v103, s47
    s_waitcnt lgkmcnt(5)
    v_perm_b32 v139, v106, v105, s47
    ds_write_b128 v26, v[124:127] offset:8320
    ds_write_b128 v26, v[128:131] offset:8336
    ds_write_b128 v26, v[132:135] offset:12480
    ds_write_b128 v26, v[136:139] offset:12496
    s_mov_b32 s48, 65536
    s_waitcnt vmcnt(1)
L_chk_25:
    v_lshl_add_u32 v86, v78, 5, v79
    v_lshl_add_u32 v87, v82, 5, v83
    v_lshl_add_u32 v86, v77, 9, v86
    v_lshl_add_u32 v87, v81, 9, v87
    v_xad_u32 v86, v76, s5, v86
    v_xad_u32 v87, v80, s5, v87
    v_cmp_ne_u32 vcc, v86, v84
    v_cmp_ne_u32 s[10:11], v87, v85
    s_nop 0
    s_or_b64 s[10:11], s[10:11], vcc
    s_and_b64 exec, s[10:11], s[10:11]
    s_cbranch_scc0 L_ok_26
    s_sub_u32 s48, s48, 1
    s_cbranch_scc1 L_ok_26
    buffer_load_dwordx4 v[76:79], v28, s[52:55], s17 offen sc1
    buffer_load_dwordx4 v[80:83], v28, s[52:55], s37 offen sc1
    buffer_load_dword v84, v29, s[52:55], s18 offen sc1
    buffer_load_dword v85, v29, s[52:55], s38 offen sc1
    s_waitcnt vmcnt(0)
    s_branch L_chk_25
L_ok_26:
    s_mov_b64 exec, -1
    ds_write_b128 v30, v[76:79]
    ds_write_b128 v30, v[80:83] offset:2048
    s_mov_b64 exec, 1
    ds_add_u32 v5, v6 offset:32
    s_mov_b64 exec, -1
L_gb_27:
    ds_read_b32 v7, v5 offset:32
    s_waitcnt lgkmcnt(0)
    v_cmp_gt_u32 vcc, 4, v7
    s_nop 0
    s_cbranch_vccnz L_gb_27
    ds_read_b64 v[106:107], v31 offset:3776
    ds_read_b64 v[108:109], v31 offset:3784
    ds_read_b128 v[170:173], v32 offset:192
    ds_read_b64 v[110:111], v31 offset:3264
    ds_read_b64 v[112:113], v31 offset:3272
    ds_read_b128 v[174:177], v32 offset:704
    ds_read_b64 v[114:115], v31 offset:2752
    ds_read_b64 v[116:117], v31 offset:2760
    ds_read_b128 v[178:181], v32 offset:1216
    s_waitcnt lgkmcnt(6)
    v_mfma_f32_16x16x32_bf16 v[74:77], v[106:109], v[170:173], 0
    ds_read_b64 v[118:119], v31 offset:2240
    ds_read_b64 v[120:121], v31 offset:2248
    s_waitcnt lgkmcnt(5)
    v_mfma_f32_16x16x32_bf16 v[78:81], v[106:109], v[174:177], 0
    ds_read_b128 v[182:185], v32 offset:1728
    ds_read_b64 v[122:123], v31 offset:1728
    v_mfma_f32_16x16x32_bf16 v[78:81], v[110:113], v[170:173], v[78:81]
    ds_read_b64 v[124:125], v31 offset:1736
    ds_read_b128 v[186:189], v32 offset:2240
    v_mfma_f32_16x16x32_bf16 v[82:85], v[110:113], v[174:177], 0
    ds_read_b64 v[126:127], v31 offset:1216
    ds_read_b64 v[128:129], v31 offset:1224
    s_waitcnt lgkmcnt(8)
    v_mfma_f32_16x16x32_bf16 v[82:85], v[106:109], v[178:181], v[82:85]
    ds_read_b128 v[190:193], v32 offset:2752
    ds_read_b64 v[130:131], v31 offset:704
    v_mfma_f32_16x16x32_bf16 v[86:89], v[110:113], v[178:181], 0
    ds_read_b64 v[132:133], v31 offset:712
    ds_read_b128 v[194:197], v32 offset:3264
    v_mfma_f32_16x16x32_bf16 v[82:85], v[114:117], v[170:173], v[82:85]
    ds_read_b64 v[134:135], v31 offset:192
    ds_read_b64 v[136:137], v31 offset:200
    v_mfma_f32_16x16x32_bf16 v[86:89], v[114:117], v[174:177], v[86:89]
    ds_read_b128 v[198:201], v32 offset:3776
    ds_read_b64 v[138:139], v31 offset:3712
    v_mfma_f32_16x16x32_bf16 v[90:93], v[114:117], v[178:181], 0
    ds_read_b64 v[140:141], v31 offset:3720
    s_waitcnt lgkmcnt(14)
    v_mfma_f32_16x16x32_bf16 v[86:89], v[106:109], v[182:185], v[86:89]
    ds_read_b128 v[202:205], v32 offset:128
    v_mfma_f32_16x16x32_bf16 v[90:93], v[110:113], v[182:185], v[90:93]
    ds_read_b64 v[142:143], v31 offset:3200
    v_mfma_f32_16x16x32_bf16 v[94:97], v[114:117], v[182:185], 0
    ds_read_b64 v[144:145], v31 offset:3208
    v_mfma_f32_16x16x32_bf16 v[86:89], v[118:121], v[170:173], v[86:89]
    ds_read_b128 v[206:209], v32 offset:640
    v_mfma_f32_16x16x32_bf16 v[90:93], v[118:121], v[174:177], v[90:93]
    ds_read_b64 v[146:147], v31 offset:2688
    v_mfma_f32_16x16x32_bf16 v[94:97], v[118:121], v[178:181], v[94:97]
    ds_read_b64 v[148:149], v31 offset:2696
    v_mfma_f32_16x16x32_bf16 v[98:101], v[118:121], v[182:185], 0
    ds_read_b128 v[210:213], v32 offset:1152
    s_waitcnt lgkmcnt(15)
    v_mfma_f32_16x16x32_bf16 v[90:93], v[106:109], v[186:189], v[90:93]
    ds_read_b64 v[150:151], v31 offset:2176
    v_mfma_f32_16x16x32_bf16 v[94:97], v[110:113], v[186:189], v[94:97]
    ds_read_b64 v[152:153], v31 offset:2184
    v_mfma_f32_16x16x32_bf16 v[98:101], v[114:117], v[186:189], v[98:101]
    ds_read_b128 v[214:217], v32 offset:1664
    v_mfma_f32_16x16x32_bf16 v[102:105], v[118:121], v[186:189], 0
    ds_read_b64 v[154:155], v31 offset:1664
    v_mfma_f32_16x16x32_bf16 v[90:93], v[122:125], v[170:173], v[90:93]
    ds_read_b64 v[156:157], v31 offset:1672
    v_mfma_f32_16x16x32_bf16 v[94:97], v[122:125], v[174:177], v[94:97]
    ds_read_b128 v[218:221], v32 offset:2176
    v_mfma_f32_16x16x32_bf16 v[98:101], v[122:125], v[178:181], v[98:101]
    ds_read_b64 v[158:159], v31 offset:1152
    v_mfma_f32_16x16x32_bf16 v[102:105], v[122:125], v[182:185], v[102:105]
    ds_read_b64 v[160:161], v31 offset:1160
    v_mfma_f32_16x16x32_bf16 v[94:97], v[106:109], v[190:193], v[94:97]
    ds_read_b128 v[222:225], v32 offset:2688
    v_mfma_f32_16x16x32_bf16 v[98:101], v[110:113], v[190:193], v[98:101]
    ds_read_b64 v[162:163], v31 offset:640
    v_mfma_f32_16x16x32_bf16 v[102:105], v[114:117], v[190:193], v[102:105]
    ds_read_b64 v[164:165], v31 offset:648
    v_mfma_f32_16x16x32_bf16 v[94:97], v[126:129], v[170:173], v[94:97]
    ds_read_b128 v[226:229], v32 offset:3200
    v_mfma_f32_16x16x32_bf16 v[98:101], v[126:129], v[174:177], v[98:101]
    ds_read_b64 v[166:167], v31 offset:128
    v_mfma_f32_16x16x32_bf16 v[102:105], v[126:129], v[178:181], v[102:105]
    ds_read_b64 v[168:169], v31 offset:136
    s_waitcnt lgkmcnt(15)
    v_mfma_f32_16x16x32_bf16 v[98:101], v[106:109], v[194:197], v[98:101]
    ds_read_b128 v[230:233], v32 offset:3712
    v_mfma_f32_16x16x32_bf16 v[102:105], v[110:113], v[194:197], v[102:105]
    v_mfma_f32_16x16x32_bf16 v[98:101], v[130:133], v[170:173], v[98:101]
    v_mfma_f32_16x16x32_bf16 v[102:105], v[130:133], v[174:177], v[102:105]
    v_mfma_f32_16x16x32_bf16 v[102:105], v[106:109], v[198:201], v[102:105]
    v_mfma_f32_16x16x32_bf16 v[102:105], v[134:137], v[170:173], v[102:105]
    v_mfma_f32_16x16x32_bf16 v[74:77], v[138:141], v[202:205], v[74:77]
    v_mfma_f32_16x16x32_bf16 v[78:81], v[138:141], v[206:209], v[78:81]
    v_mfma_f32_16x16x32_bf16 v[78:81], v[142:145], v[202:205], v[78:81]
    v_mfma_f32_16x16x32_bf16 v[82:85], v[142:145], v[206:209], v[82:85]
    s_waitcnt lgkmcnt(15)
    v_mfma_f32_16x16x32_bf16 v[82:85], v[138:141], v[210:213], v[82:85]
    ds_read_b64 v[106:107], v31 offset:3648
    v_mfma_f32_16x16x32_bf16 v[86:89], v[142:145], v[210:213], v[86:89]
    ds_read_b64 v[108:109], v31 offset:3656
    v_mfma_f32_16x16x32_bf16 v[82:85], v[146:149], v[202:205], v[82:85]
    ds_read_b128 v[170:173], v32 offset:64
    v_mfma_f32_16x16x32_bf16 v[86:89], v[146:149], v[206:209], v[86:89]
    ds_read_b64 v[110:111], v31 offset:3136
    v_mfma_f32_16x16x32_bf16 v[90:93], v[146:149], v[210:213], v[90:93]
    ds_read_b64 v[112:113], v31 offset:3144
    s_waitcnt lgkmcnt(15)
    v_mfma_f32_16x16x32_bf16 v[86:89], v[138:141], v[214:217], v[86:89]
    ds_read_b128 v[174:177], v32 offset:576
    v_mfma_f32_16x16x32_bf16 v[90:93], v[142:145], v[214:217], v[90:93]
    ds_read_b64 v[114:115], v31 offset:2624
    v_mfma_f32_16x16x32_bf16 v[94:97], v[146:149], v[214:217], v[94:97]
    ds_read_b64 v[116:117], v31 offset:2632
    v_mfma_f32_16x16x32_bf16 v[86:89], v[150:153], v[202:205], v[86:89]
    ds_read_b128 v[178:181], v32 offset:1088
    v_mfma_f32_16x16x32_bf16 v[90:93], v[150:153], v[206:209], v[90:93]
    ds_read_b64 v[118:119], v31 offset:2112
    v_mfma_f32_16x16x32_bf16 v[94:97], v[150:153], v[210:213], v[94:97]
    ds_read_b64 v[120:121], v31 offset:2120
    v_mfma_f32_16x16x32_bf16 v[98:101], v[150:153], v[214:217], v[98:101]
    ds_read_b128 v[182:185], v32 offset:1600
    s_waitcnt lgkmcnt(15)
    v_mfma_f32_16x16x32_bf16 v[90:93], v[138:141], v[218:221], v[90:93]
    ds_read_b64 v[122:123], v31 offset:1600
    v_mfma_f32_16x16x32_bf16 v[94:97], v[142:145], v[218:221], v[94:97]
    ds_read_b64 v[124:125], v31 offset:1608
    v_mfma_f32_16x16x32_bf16 v[98:101], v[146:149], v[218:221], v[98:101]
    ds_read_b128 v[186:189], v32 offset:2112
    v_mfma_f32_16x16x32_bf16 v[102:105], v[150:153], v[218:221], v[102:105]
    ds_read_b64 v[126:127], v31 offset:1088
    v_mfma_f32_16x16x32_bf16 v[90:93], v[154:157], v[202:205], v[90:93]
    ds_read_b64 v[128:129], v31 offset:1096
    v_mfma_f32_16x16x32_bf16 v[94:97], v[154:157], v[206:209], v[94:97]
    ds_read_b128 v[190:193], v32 offset:2624
    v_mfma_f32_16x16x32_bf16 v[98:101], v[154:157], v[210:213], v[98:101]
    ds_read_b64 v[130:131], v31 offset:576
    v_mfma_f32_16x16x32_bf16 v[102:105], v[154:157], v[214:217], v[102:105]
    ds_read_b64 v[132:133], v31 offset:584
    v_mfma_f32_16x16x32_bf16 v[94:97], v[138:141], v[222:225], v[94:97]
    ds_read_b128 v[194:197], v32 offset:3136
    v_mfma_f32_16x16x32_bf16 v[98:101], v[142:145], v[222:225], v[98:101]
    ds_read_b64 v[134:135], v31 offset:64
    v_mfma_f32_16x16x32_bf16 v[102:105], v[146:149], v[222:225], v[102:105]
    ds_read_b64 v[136:137], v31 offset:72
    v_mfma_f32_16x16x32_bf16 v[94:97], v[158:161], v[202:205], v[94:97]
    ds_read_b128 v[198:201], v32 offset:3648
    v_mfma_f32_16x16x32_bf16 v[98:101], v[158:161], v[206:209], v[98:101]
    v_mfma_f32_16x16x32_bf16 v[102:105], v[158:161], v[210:213], v[102:105]
    v_mfma_f32_16x16x32_bf16 v[98:101], v[138:141], v[226:229], v[98:101]
    v_mfma_f32_16x16x32_bf16 v[102:105], v[142:145], v[226:229], v[102:105]
    v_mfma_f32_16x16x32_bf16 v[98:101], v[162:165], v[202:205], v[98:101]
    v_mfma_f32_16x16x32_bf16 v[102:105], v[162:165], v[206:209], v[102:105]
    s_waitcnt lgkmcnt(15)
    v_mfma_f32_16x16x32_bf16 v[102:105], v[138:141], v[230:233], v[102:105]
    v_mfma_f32_16x16x32_bf16 v[102:105], v[166:169], v[202:205], v[102:105]
    v_mfma_f32_16x16x32_bf16 v[74:77], v[106:109], v[170:173], v[74:77]
    v_mfma_f32_16x16x32_bf16 v[78:81], v[106:109], v[174:177], v[78:81]
    v_mfma_f32_16x16x32_bf16 v[78:81], v[110:113], v[170:173], v[78:81]
    v_mfma_f32_16x16x32_bf16 v[82:85], v[110:113], v[174:177], v[82:85]
    v_mfma_f32_16x16x32_bf16 v[82:85], v[106:109], v[178:181], v[82:85]
    ds_read_b64 v[138:139], v31 offset:3584
    v_mfma_f32_16x16x32_bf16 v[86:89], v[110:113], v[178:181], v[86:89]
    ds_read_b64 v[140:141], v31 offset:3592
    v_mfma_f32_16x16x32_bf16 v[82:85], v[114:117], v[170:173], v[82:85]
    ds_read_b128 v[202:205], v32 offset:0
    v_mfma_f32_16x16x32_bf16 v[86:89], v[114:117], v[174:177], v[86:89]
    ds_read_b64 v[142:143], v31 offset:3072
    v_mfma_f32_16x16x32_bf16 v[90:93], v[114:117], v[178:181], v[90:93]
    ds_read_b64 v[144:145], v31 offset:3080
    s_waitcnt lgkmcnt(15)
    v_mfma_f32_16x16x32_bf16 v[86:89], v[106:109], v[182:185], v[86:89]
    ds_read_b128 v[206:209], v32 offset:512
    v_mfma_f32_16x16x32_bf16 v[90:93], v[110:113], v[182:185], v[90:93]
    ds_read_b64 v[146:147], v31 offset:2560
    v_mfma_f32_16x16x32_bf16 v[94:97], v[114:117], v[182:185], v[94:97]
    ds_read_b64 v[148:149], v31 offset:2568
    v_mfma_f32_16x16x32_bf16 v[86:89], v[118:121], v[170:173], v[86:89]
    ds_read_b128 v[210:213], v32 offset:1024
    v_mfma_f32_16x16x32_bf16 v[90:93], v[118:121], v[174:177], v[90:93]
    ds_read_b64 v[150:151], v31 offset:2048
    v_mfma_f32_16x16x32_bf16 v[94:97], v[118:121], v[178:181], v[94:97]
    ds_read_b64 v[152:153], v31 offset:2056
    v_mfma_f32_16x16x32_bf16 v[98:101], v[118:121], v[182:185], v[98:101]
    ds_read_b128 v[214:217], v32 offset:1536
    s_waitcnt lgkmcnt(15)
    v_mfma_f32_16x16x32_bf16 v[90:93], v[106:109], v[186:189], v[90:93]
    ds_read_b64 v[154:155], v31 offset:1536
    v_mfma_f32_16x16x32_bf16 v[94:97], v[110:113], v[186:189], v[94:97]
    ds_read_b64 v[156:157], v31 offset:1544
    v_mfma_f32_16x16x32_bf16 v[98:101], v[114:117], v[186:189], v[98:101]
    ds_read_b128 v[218:221], v32 offset:2048
    v_mfma_f32_16x16x32_bf16 v[102:105], v[118:121], v[186:189], v[102:105]
    ds_read_b64 v[158:159], v31 offset:1024
    v_mfma_f32_16x16x32_bf16 v[90:93], v[122:125], v[170:173], v[90:93]
    ds_read_b64 v[160:161], v31 offset:1032
    v_mfma_f32_16x16x32_bf16 v[94:97], v[122:125], v[174:177], v[94:97]
    ds_read_b128 v[222:225], v32 offset:2560
    v_mfma_f32_16x16x32_bf16 v[98:101], v[122:125], v[178:181], v[98:101]
    ds_read_b64 v[162:163], v31 offset:512
    v_mfma_f32_16x16x32_bf16 v[102:105], v[122:125], v[182:185], v[102:105]
    ds_read_b64 v[164:165], v31 offset:520
    v_mfma_f32_16x16x32_bf16 v[94:97], v[106:109], v[190:193], v[94:97]
    ds_read_b128 v[226:229], v32 offset:3072
    v_mfma_f32_16x16x32_bf16 v[98:101], v[110:113], v[190:193], v[98:101]
    ds_read_b64 v[166:167], v31 offset:0
    v_mfma_f32_16x16x32_bf16 v[102:105], v[114:117], v[190:193], v[102:105]
    ds_read_b64 v[168:169], v31 offset:8
    v_mfma_f32_16x16x32_bf16 v[94:97], v[126:129], v[170:173], v[94:97]
    ds_read_b128 v[230:233], v32 offset:3584
    v_mfma_f32_16x16x32_bf16 v[98:101], v[126:129], v[174:177], v[98:101]
    v_mfma_f32_16x16x32_bf16 v[102:105], v[126:129], v[178:181], v[102:105]
    v_mfma_f32_16x16x32_bf16 v[98:101], v[106:109], v[194:197], v[98:101]
    v_mfma_f32_16x16x32_bf16 v[102:105], v[110:113], v[194:197], v[102:105]
    v_mfma_f32_16x16x32_bf16 v[98:101], v[130:133], v[170:173], v[98:101]
    v_mfma_f32_16x16x32_bf16 v[102:105], v[130:133], v[174:177], v[102:105]
    s_waitcnt lgkmcnt(15)
    v_mfma_f32_16x16x32_bf16 v[102:105], v[106:109], v[198:201], v[102:105]
    v_mfma_f32_16x16x32_bf16 v[102:105], v[134:137], v[170:173], v[102:105]
    v_mfma_f32_16x16x32_bf16 v[74:77], v[138:141], v[202:205], v[74:77]
    v_mfma_f32_16x16x32_bf16 v[78:81], v[138:141], v[206:209], v[78:81]
    v_mfma_f32_16x16x32_bf16 v[78:81], v[142:145], v[202:205], v[78:81]
    v_mfma_f32_16x16x32_bf16 v[82:85], v[142:145], v[206:209], v[82:85]
    v_mfma_f32_16x16x32_bf16 v[82:85], v[138:141], v[210:213], v[82:85]
    v_mfma_f32_16x16x32_bf16 v[86:89], v[142:145], v[210:213], v[86:89]
    v_mfma_f32_16x16x32_bf16 v[82:85], v[146:149], v[202:205], v[82:85]
    v_mfma_f32_16x16x32_bf16 v[86:89], v[146:149], v[206:209], v[86:89]
    v_mfma_f32_16x16x32_bf16 v[90:93], v[146:149], v[210:213], v[90:93]
    s_lshl_b32 s7, s45, 12
    s_add_u32 s12, s27, s7
    v_add_u32 v70, s12, v8
    s_xor_b32 s7, s7, 4096
    s_add_u32 s12, s27, s7
    v_add_u32 v71, s12, v8
    s_waitcnt lgkmcnt(12)
    v_mfma_f32_16x16x32_bf16 v[86:89], v[138:141], v[214:217], v[86:89]
    v_mfma_f32_16x16x32_bf16 v[90:93], v[142:145], v[214:217], v[90:93]
    v_mfma_f32_16x16x32_bf16 v[94:97], v[146:149], v[214:217], v[94:97]
    v_mfma_f32_16x16x32_bf16 v[86:89], v[150:153], v[202:205], v[86:89]
    v_mfma_f32_16x16x32_bf16 v[90:93], v[150:153], v[206:209], v[90:93]
    v_mfma_f32_16x16x32_bf16 v[94:97], v[150:153], v[210:213], v[94:97]
    v_mfma_f32_16x16x32_bf16 v[98:101], v[150:153], v[214:217], v[98:101]
    s_waitcnt lgkmcnt(9)
    v_mfma_f32_16x16x32_bf16 v[90:93], v[138:141], v[218:221], v[90:93]
    v_mfma_f32_16x16x32_bf16 v[94:97], v[142:145], v[218:221], v[94:97]
    v_mfma_f32_16x16x32_bf16 v[98:101], v[146:149], v[218:221], v[98:101]
    v_mfma_f32_16x16x32_bf16 v[102:105], v[150:153], v[218:221], v[102:105]
    v_mfma_f32_16x16x32_bf16 v[90:93], v[154:157], v[202:205], v[90:93]
    v_mfma_f32_16x16x32_bf16 v[94:97], v[154:157], v[206:209], v[94:97]
    v_mfma_f32_16x16x32_bf16 v[98:101], v[154:157], v[210:213], v[98:101]
    v_mfma_f32_16x16x32_bf16 v[102:105], v[154:157], v[214:217], v[102:105]
    s_waitcnt lgkmcnt(6)
    v_mfma_f32_16x16x32_bf16 v[94:97], v[138:141], v[222:225], v[94:97]
    v_mfma_f32_16x16x32_bf16 v[98:101], v[142:145], v[222:225], v[98:101]
    v_mfma_f32_16x16x32_bf16 v[102:105], v[146:149], v[222:225], v[102:105]
    v_mfma_f32_16x16x32_bf16 v[94:97], v[158:161], v[202:205], v[94:97]
    v_mfma_f32_16x16x32_bf16 v[98:101], v[158:161], v[206:209], v[98:101]
    v_mfma_f32_16x16x32_bf16 v[102:105], v[158:161], v[210:213], v[102:105]
    s_waitcnt lgkmcnt(3)
    v_mfma_f32_16x16x32_bf16 v[98:101], v[138:141], v[226:229], v[98:101]
    v_mfma_f32_16x16x32_bf16 v[102:105], v[142:145], v[226:229], v[102:105]
    v_mfma_f32_16x16x32_bf16 v[98:101], v[162:165], v[202:205], v[98:101]
    v_mfma_f32_16x16x32_bf16 v[102:105], v[162:165], v[206:209], v[102:105]
    s_waitcnt lgkmcnt(0)
    v_mfma_f32_16x16x32_bf16 v[102:105], v[138:141], v[230:233], v[102:105]
    v_mfma_f32_16x16x32_bf16 v[102:105], v[166:169], v[202:205], v[102:105]
    s_cmp_eq_u32 s45, 1
    s_cbranch_scc1 L_rodd_28
    ds_write_b128 v70, v[90:93] offset:16640
    ds_write_b128 v70, v[94:97] offset:17664
    ds_write_b128 v70, v[98:101] offset:18688
    s_nop 2
    ds_write_b128 v70, v[102:105] offset:19712
    s_branch L_rjoin_29
L_rodd_28:
    ds_write_b128 v70, v[74:77] offset:16640
    ds_write_b128 v70, v[78:81] offset:17664
    ds_write_b128 v70, v[82:85] offset:18688
    ds_write_b128 v70, v[86:89] offset:19712
L_rjoin_29:
    s_mov_b64 exec, 1
    ds_add_u32 v73, v6 offset:4
    s_mov_b64 exec, -1
L_gb_30:
    ds_read_b32 v7, v73 offset:4
    s_waitcnt lgkmcnt(0)
    v_cmp_gt_u32 vcc, 2, v7
    s_nop 0
    s_cbranch_vccnz L_gb_30
    ds_read_b128 v[106:109], v71 offset:16640
    ds_read_b128 v[110:113], v71 offset:17664
    ds_read_b128 v[114:117], v71 offset:18688
    ds_read_b128 v[118:121], v71 offset:19712
    s_cmp_eq_u32 s45, 1
    s_cbranch_scc1 L_sodd_31
    s_waitcnt lgkmcnt(3)
    v_add_f32 v106, v106, v74
    v_add_f32 v107, v107, v75
    v_add_f32 v108, v108, v76
    v_add_f32 v109, v109, v77
    s_waitcnt lgkmcnt(2)
    v_add_f32 v110, v110, v78
    v_add_f32 v111, v111, v79
    v_add_f32 v112, v112, v80
    v_add_f32 v113, v113, v81
    s_waitcnt lgkmcnt(1)
    v_add_f32 v114, v114, v82
    v_add_f32 v115, v115, v83
    v_add_f32 v116, v116, v84
    v_add_f32 v117, v117, v85
    s_waitcnt lgkmcnt(0)
    v_add_f32 v118, v118, v86
    v_add_f32 v119, v119, v87
    v_add_f32 v120, v120, v88
    v_add_f32 v121, v121, v89
    s_branch L_sjoin_32
L_sodd_31:
    s_waitcnt lgkmcnt(3)
    v_add_f32 v106, v106, v90
    v_add_f32 v107, v107, v91
    v_add_f32 v108, v108, v92
    v_add_f32 v109, v109, v93
    s_waitcnt lgkmcnt(2)
    v_add_f32 v110, v110, v94
    v_add_f32 v111, v111, v95
    v_add_f32 v112, v112, v96
    v_add_f32 v113, v113, v97
    s_waitcnt lgkmcnt(1)
    v_add_f32 v114, v114, v98
    v_add_f32 v115, v115, v99
    v_add_f32 v116, v116, v100
    v_add_f32 v117, v117, v101
    s_waitcnt lgkmcnt(0)
    v_add_f32 v118, v118, v102
    v_add_f32 v119, v119, v103
    v_add_f32 v120, v120, v104
    v_add_f32 v121, v121, v105
L_sjoin_32:
    s_waitcnt lgkmcnt(3)
    v_cvt_pk_bf16_f32 v122, v106, v107
    v_cvt_pk_bf16_f32 v123, v108, v109
    s_waitcnt lgkmcnt(2)
    v_cvt_pk_bf16_f32 v124, v110, v111
    v_cvt_pk_bf16_f32 v125, v112, v113
    s_waitcnt lgkmcnt(1)
    v_cvt_pk_bf16_f32 v126, v114, v115
    v_cvt_pk_bf16_f32 v127, v116, v117
    s_waitcnt lgkmcnt(0)
    v_cvt_pk_bf16_f32 v128, v118, v119
    v_cvt_pk_bf16_f32 v129, v120, v121
    v_permlane16_swap_b32 v122, v124
    v_permlane16_swap_b32 v123, v125
    v_permlane16_swap_b32 v126, v128
    v_permlane16_swap_b32 v127, v129
    v_lshl_add_u32 v130, v124, 5, v125
    v_lshl_add_u32 v131, v128, 5, v129
    v_lshl_add_u32 v130, v123, 9, v130
    v_lshl_add_u32 v131, v127, 9, v131
    v_xad_u32 v130, v122, s5, v130
    v_xad_u32 v131, v126, s5, v131
    buffer_store_dwordx4 v[122:125], v33, s[52:55], s19 offen offset:0 sc1
    buffer_store_dwordx4 v[126:129], v33, s[52:55], s19 offen offset:1024 sc1
    buffer_store_dword v130, v34, s[52:55], s35 offen offset:0 sc1
    buffer_store_dword v131, v34, s[52:55], s35 offen offset:512 sc1
    s_lshl_b32 s7, s45, 6
    s_or_b32 s7, s7, s29
    v_xor_b32 v37, s7, v37
    v_xor_b32 v72, 32, v37
    ds_read_b128 v[92:95], v37 offset:128
    ds_read_b128 v[96:99], v72 offset:1152
    s_lshl_b32 s7, s4, 10
    s_waitcnt vmcnt(4)
    v_lshlrev_b32 v100, 16, v60
    v_and_b32 v101, 0xffff0000, v60
    v_lshlrev_b32 v102, 16, v61
    v_and_b32 v103, 0xffff0000, v61
    v_lshlrev_b32 v104, 16, v62
    v_and_b32 v105, 0xffff0000, v62
    v_lshlrev_b32 v106, 16, v63
    v_and_b32 v107, 0xffff0000, v63
    s_lshl_b32 s12, s4, 5
    s_or_b32 s7, s7, s12
    v_xor_b32 v36, s7, v36
    s_waitcnt lgkmcnt(1)
    v_lshlrev_b32 v108, 16, v92
    v_and_b32 v109, 0xffff0000, v92
    v_lshlrev_b32 v110, 16, v93
    v_and_b32 v111, 0xffff0000, v93
    v_lshlrev_b32 v112, 16, v94
    v_and_b32 v113, 0xffff0000, v94
    v_lshlrev_b32 v114, 16, v95
    v_and_b32 v115, 0xffff0000, v95
    s_waitcnt lgkmcnt(0)
    v_lshlrev_b32 v116, 16, v96
    v_and_b32 v117, 0xffff0000, v96
    v_lshlrev_b32 v118, 16, v97
    v_and_b32 v119, 0xffff0000, v97
    v_lshlrev_b32 v120, 16, v98
    v_and_b32 v121, 0xffff0000, v98
    v_lshlrev_b32 v122, 16, v99
    v_and_b32 v123, 0xffff0000, v99
    v_mul_f32 v108, v108, v100
    v_mul_f32 v109, v109, v101
    v_mul_f32 v110, v110, v102
    v_mul_f32 v111, v111, v103
    v_mul_f32 v112, v112, v104
    v_mul_f32 v113, v113, v105
    v_mul_f32 v114, v114, v106
    v_mul_f32 v115, v115, v107
    v_mul_f32 v116, v116, v100
    v_mul_f32 v117, v117, v101
    v_mul_f32 v118, v118, v102
    v_mul_f32 v119, v119, v103
    v_mul_f32 v120, v120, v104
    v_mul_f32 v121, v121, v105
    v_mul_f32 v122, v122, v106
    v_mul_f32 v123, v123, v107
    v_cvt_pk_bf16_f32 v92, v108, v109
    v_cvt_pk_bf16_f32 v93, v110, v111
    v_cvt_pk_bf16_f32 v94, v112, v113
    v_cvt_pk_bf16_f32 v95, v114, v115
    v_cvt_pk_bf16_f32 v96, v116, v117
    v_cvt_pk_bf16_f32 v97, v118, v119
    v_cvt_pk_bf16_f32 v98, v120, v121
    v_cvt_pk_bf16_f32 v99, v122, v123
    v_lshlrev_b32 v74, 16, v92
    v_and_b32 v75, 0xffff0000, v92
    v_lshlrev_b32 v76, 16, v93
    v_and_b32 v77, 0xffff0000, v93
    v_lshlrev_b32 v78, 16, v94
    v_and_b32 v79, 0xffff0000, v94
    v_lshlrev_b32 v80, 16, v95
    v_and_b32 v81, 0xffff0000, v95
    v_lshlrev_b32 v82, 16, v96
    v_and_b32 v83, 0xffff0000, v96
    v_lshlrev_b32 v84, 16, v97
    v_and_b32 v85, 0xffff0000, v97
    v_lshlrev_b32 v86, 16, v98
    v_and_b32 v87, 0xffff0000, v98
    v_lshlrev_b32 v88, 16, v99
    v_and_b32 v89, 0xffff0000, v99
    s_waitcnt vmcnt(0)
    buffer_load_dwordx4 v[124:127], v35, s[52:55], s20 offen sc1
    buffer_load_dwordx4 v[128:131], v35, s[52:55], s21 offen sc1
    buffer_load_dword v132, v29, s[52:55], s22 offen sc1
    buffer_load_dword v133, v29, s[52:55], s36 offen sc1
    s_mov_b32 s48, 65536
    s_waitcnt vmcnt(0)
L_chk_33:
    v_lshl_add_u32 v134, v126, 5, v127
    v_lshl_add_u32 v135, v130, 5, v131
    v_lshl_add_u32 v134, v125, 9, v134
    v_lshl_add_u32 v135, v129, 9, v135
    v_xad_u32 v134, v124, s5, v134
    v_xad_u32 v135, v128, s5, v135
    v_cmp_ne_u32 vcc, v134, v132
    v_cmp_ne_u32 s[10:11], v135, v133
    s_nop 0
    s_or_b64 s[10:11], s[10:11], vcc
    s_and_b64 exec, s[10:11], s[10:11]
    s_cbranch_scc0 L_ok_34
    s_sub_u32 s48, s48, 1
    s_cbranch_scc1 L_ok_34
    buffer_load_dwordx4 v[124:127], v35, s[52:55], s20 offen sc1
    buffer_load_dwordx4 v[128:131], v35, s[52:55], s21 offen sc1
    buffer_load_dword v132, v29, s[52:55], s22 offen sc1
    buffer_load_dword v133, v29, s[52:55], s36 offen sc1
    s_waitcnt vmcnt(0)
    s_branch L_chk_33
L_ok_34:
    s_mov_b64 exec, -1
    ds_write_b128 v36, v[124:127] offset:8320
    ds_write_b128 v36, v[128:131] offset:12416
    s_mov_b64 exec, 1
    ds_add_u32 v5, v6 offset:48
    s_mov_b64 exec, -1
L_gb_35:
    ds_read_b32 v7, v5 offset:48
    s_waitcnt lgkmcnt(0)
    v_cmp_gt_u32 vcc, 4, v7
    s_nop 0
    s_cbranch_vccnz L_gb_35
    ds_read_b64_tr_b16 v[92:93], v64 offset:8320
    ds_read_b64_tr_b16 v[94:95], v64 offset:8832
    ds_read_b64_tr_b16 v[96:97], v65 offset:8320
    ds_read_b64_tr_b16 v[98:99], v65 offset:8832
    s_waitcnt lgkmcnt(3)
    v_lshlrev_b32 v108, 16, v92
    v_and_b32 v109, 0xffff0000, v92
    v_lshlrev_b32 v110, 16, v93
    v_and_b32 v111, 0xffff0000, v93
    s_waitcnt lgkmcnt(2)
    v_lshlrev_b32 v112, 16, v94
    v_and_b32 v113, 0xffff0000, v94
    v_lshlrev_b32 v114, 16, v95
    v_and_b32 v115, 0xffff0000, v95
    s_waitcnt lgkmcnt(1)
    v_lshlrev_b32 v116, 16, v96
    v_and_b32 v117, 0xffff0000, v96
    v_lshlrev_b32 v118, 16, v97
    v_and_b32 v119, 0xffff0000, v97
    s_waitcnt lgkmcnt(0)
    v_lshlrev_b32 v120, 16, v98
    v_and_b32 v121, 0xffff0000, v98
    v_lshlrev_b32 v122, 16, v99
    v_and_b32 v123, 0xffff0000, v99
    v_add_f32 v108, v108, v74
    v_add_f32 v109, v109, v75
    v_add_f32 v110, v110, v76
    v_add_f32 v111, v111, v77
    v_add_f32 v112, v112, v78
    v_add_f32 v113, v113, v79
    v_add_f32 v114, v114, v80
    v_add_f32 v115, v115, v81
    v_add_f32 v116, v116, v82
    v_add_f32 v117, v117, v83
    v_add_f32 v118, v118, v84
    v_add_f32 v119, v119, v85
    v_add_f32 v120, v120, v86
    v_add_f32 v121, v121, v87
    v_add_f32 v122, v122, v88
    v_add_f32 v123, v123, v89
    v_cvt_pk_bf16_f32 v124, v108, v109
    v_cvt_pk_bf16_f32 v125, v110, v111
    v_cvt_pk_bf16_f32 v126, v112, v113
    v_cvt_pk_bf16_f32 v127, v114, v115
    v_cvt_pk_bf16_f32 v128, v116, v117
    v_cvt_pk_bf16_f32 v129, v118, v119
    v_cvt_pk_bf16_f32 v130, v120, v121
    v_cvt_pk_bf16_f32 v131, v122, v123
    buffer_store_dwordx4 v[124:127], v38, s[56:59], s23 offen nt
    buffer_store_dwordx4 v[128:131], v38, s[56:59], s24 offen nt
L_end:
    s_endpgm
.p2align 8
.type TABLE,@object
TABLE:
.quad 0x80003f8080003f80,0x80003f8080003f80,0xbf353f3580003f80,0xbf35bf35bf80248d,0xbf80248d80003f80,0x3f80a554a50dbf80,0xbf35bf3580003f80,0xbf353f353f80a554
.quad 0xa50dbf8080003f80,0xa5d4bf80258d3f80,0x3f35bf3580003f80,0x3f353f35bf8025b0,0x3f80a55480003f80,0xbf80261fa5d4bf80,0x3f353f3580003f80,0x3f35bf353f80a5f7
.quad 0x80003f8080003f80,0x80003f8080003f80,0xbf353f3580003f80,0xbf35bf35bf80248d,0xbf80248d80003f80,0x3f80a554a50dbf80,0xbf35bf3580003f80,0xbf353f353f80a554
.quad 0xa50dbf8080003f80,0xa5d4bf80258d3f80,0x3f35bf3580003f80,0x3f353f35bf8025b0,0x3f80a55480003f80,0xbf80261fa5d4bf80,0x3f353f3580003f80,0x3f35bf353f80a5f7
.quad 0x80003f8080003f80,0x80003f8080003f80,0xbf353f3580003f80,0xbf35bf35bf80248d,0xbf80248d80003f80,0x3f80a554a50dbf80,0xbf35bf3580003f80,0xbf353f353f80a554
.quad 0xa50dbf8080003f80,0xa5d4bf80258d3f80,0x3f35bf3580003f80,0x3f353f35bf8025b0,0x3f80a55480003f80,0xbf80261fa5d4bf80,0x3f353f3580003f80,0x3f35bf353f80a5f7
.quad 0xbf353f35bf353f35,0xbf353f35bf353f35,0xbf80248dbf353f35,0xa50dbf80bf35bf35,0xbf35bf35bf353f35,0x3f353f353f35bf35,0xa50dbf80bf353f35,0xbf8025b03f353f35
.quad 0x3f35bf35bf353f35,0x3f35bf35bf353f35,0x3f80a554bf353f35,0x260d3f80bf35bf35,0x3f353f35bf353f35,0xbf35bf353f35bf35,0x258d3f80bf353f35,0x3f80a7313f353f35
.quad 0x80003f8080003f80,0x80003f8080003f80,0xbf353f3580003f80,0xbf35bf35bf80248d,0xbf80248d80003f80,0x3f80a554a50dbf80,0xbf35bf3580003f80,0xbf353f353f80a554
.quad 0xa50dbf8080003f80,0xa5d4bf80258d3f80,0x3f35bf3580003f80,0x3f353f35bf8025b0,0x3f80a55480003f80,0xbf80261fa5d4bf80,0x3f353f3580003f80,0x3f35bf353f80a5f7
.quad 0xbf80248dbf80248d,0xbf80248dbf80248d,0xbf35bf35bf80248d,0x3f35bf35a50dbf80,0xa50dbf80bf80248d,0x258d3f803f80a554,0x3f35bf35bf80248d,0xbf35bf35258d3f80
.quad 0x3f80a554bf80248d,0x3f80a5f7bf8025b0,0x3f353f35bf80248d,0xbf353f35a5d4bf80,0x258d3f80bf80248d,0xa630bf803f80a5f7,0xbf353f35bf80248d,0x3f353f35260d3f80
.quad 0x80003f8080003f80,0x80003f8080003f80,0xbf353f3580003f80,0xbf35bf35bf80248d,0xbf80248d80003f80,0x3f80a554a50dbf80,0xbf35bf3580003f80,0xbf353f353f80a554
.quad 0xa50dbf8080003f80,0xa5d4bf80258d3f80,0x3f35bf3580003f80,0x3f353f35bf8025b0,0x3f80a55480003f80,0xbf80261fa5d4bf80,0x3f353f3580003f80,0x3f35bf353f80a5f7
.quad 0xbf35bf35bf35bf35,0xbf35bf35bf35bf35,0xa50dbf80bf35bf35,0x3f80a5543f35bf35,0x3f35bf35bf35bf35,0xbf353f353f353f35,0x3f80a554bf35bf35,0xa5d4bf80bf353f35
.quad 0x3f353f35bf35bf35,0x3f353f35bf35bf35,0x258d3f80bf35bf35,0xbf80261f3f35bf35,0xbf353f35bf35bf35,0x3f35bf353f353f35,0xbf8025b0bf35bf35,0x26543f80bf353f35
.quad 0x3f8000003f800000,0x3f8000003f800000,0x3f353f353f800000,0xbf353f35248d3f80,0x248d3f803f800000,0xa554bf80bf80250d,0xbf353f353f800000,0x3f353f35a554bf80
.quad 0xbf80250d3f800000,0xbf8025d43f80a58d,0xbf35bf353f800000,0x3f35bf3525b03f80,0xa554bf803f800000,0x261f3f80bf8025d4,0x3f35bf353f800000,0xbf35bf35a5f7bf80
.quad 0x3f8000003f800000,0x3f8000003f800000,0x3f353f353f800000,0xbf353f35248d3f80,0x248d3f803f800000,0xa554bf80bf80250d,0xbf353f353f800000,0x3f353f35a554bf80
.quad 0xbf80250d3f800000,0xbf8025d43f80a58d,0xbf35bf353f800000,0x3f35bf3525b03f80,0xa554bf803f800000,0x261f3f80bf8025d4,0x3f35bf353f800000,0xbf35bf35a5f7bf80
.quad 0x3f8000003f800000,0x3f8000003f800000,0x3f353f353f800000,0xbf353f35248d3f80,0x248d3f803f800000,0xa554bf80bf80250d,0xbf353f353f800000,0x3f353f35a554bf80
.quad 0xbf80250d3f800000,0xbf8025d43f80a58d,0xbf35bf353f800000,0x3f35bf3525b03f80,0xa554bf803f800000,0x261f3f80bf8025d4,0x3f35bf353f800000,0xbf35bf35a5f7bf80
.quad 0x3f353f353f353f35,0x3f353f353f353f35,0x248d3f803f353f35,0xbf80250dbf353f35,0xbf353f353f353f35,0x3f35bf35bf35bf35,0xbf80250d3f353f35,0x25b03f803f35bf35
.quad 0xbf35bf353f353f35,0xbf35bf353f353f35,0xa554bf803f353f35,0x3f80a60dbf353f35,0x3f35bf353f353f35,0xbf353f35bf35bf35,0x3f80a58d3f353f35,0xa731bf803f35bf35
.quad 0x3f8000003f800000,0x3f8000003f800000,0x3f353f353f800000,0xbf353f35248d3f80,0x248d3f803f800000,0xa554bf80bf80250d,0xbf353f353f800000,0x3f353f35a554bf80
.quad 0xbf80250d3f800000,0xbf8025d43f80a58d,0xbf35bf353f800000,0x3f35bf3525b03f80,0xa554bf803f800000,0x261f3f80bf8025d4,0x3f35bf353f800000,0xbf35bf35a5f7bf80
.quad 0x248d3f80248d3f80,0x248d3f80248d3f80,0xbf353f35248d3f80,0xbf35bf35bf80250d,0xbf80250d248d3f80,0x3f80a58da554bf80,0xbf35bf35248d3f80,0xbf353f353f80a58d
.quad 0xa554bf80248d3f80,0xa5f7bf8025b03f80,0x3f35bf35248d3f80,0x3f353f35bf8025d4,0x3f80a58d248d3f80,0xbf802630a5f7bf80,0x3f353f35248d3f80,0x3f35bf353f80a60d
.quad 0x3f8000003f800000,0x3f8000003f800000,0x3f353f353f800000,0xbf353f35248d3f80,0x248d3f803f800000,0xa554bf80bf80250d,0xbf353f353f800000,0x3f353f35a554bf80
.quad 0xbf80250d3f800000,0xbf8025d43f80a58d,0xbf35bf353f800000,0x3f35bf3525b03f80,0xa554bf803f800000,0x261f3f80bf8025d4,0x3f35bf353f800000,0xbf35bf35a5f7bf80
.quad 0xbf353f35bf353f35,0xbf353f35bf353f35,0xbf80250dbf353f35,0xa554bf80bf35bf35,0xbf35bf35bf353f35,0x3f353f353f35bf35,0xa554bf80bf353f35,0xbf8025d43f353f35
.quad 0x3f35bf35bf353f35,0x3f35bf35bf353f35,0x3f80a58dbf353f35,0x261f3f80bf35bf35,0x3f353f35bf353f35,0xbf35bf353f35bf35,0x25b03f80bf353f35,0x3f80a6543f353f35
.quad 0xbf800000bf80,0xbf800000bf80,0x3f35bf350000bf80,0x3f353f353f80a48d,0x3f80a48d0000bf80,0xbf802554250d3f80,0x3f353f350000bf80,0x3f35bf35bf802554
.quad 0x250d3f800000bf80,0x25d43f80a58dbf80,0xbf353f350000bf80,0xbf35bf353f80a5b0,0xbf8025540000bf80,0x3f80a61f25d43f80,0xbf35bf350000bf80,0xbf353f35bf8025f7
.quad 0xbf800000bf80,0xbf800000bf80,0x3f35bf350000bf80,0x3f353f353f80a48d,0x3f80a48d0000bf80,0xbf802554250d3f80,0x3f353f350000bf80,0x3f35bf35bf802554
.quad 0x250d3f800000bf80,0x25d43f80a58dbf80,0xbf353f350000bf80,0xbf35bf353f80a5b0,0xbf8025540000bf80,0x3f80a61f25d43f80,0xbf35bf350000bf80,0xbf353f35bf8025f7
.quad 0xbf800000bf80,0xbf800000bf80,0x3f35bf350000bf80,0x3f353f353f80a48d,0x3f80a48d0000bf80,0xbf802554250d3f80,0x3f353f350000bf80,0x3f35bf35bf802554
.quad 0x250d3f800000bf80,0x25d43f80a58dbf80,0xbf353f350000bf80,0xbf35bf353f80a5b0,0xbf8025540000bf80,0x3f80a61f25d43f80,0xbf35bf350000bf80,0xbf353f35bf8025f7
.quad 0x3f35bf353f35bf35,0x3f35bf353f35bf35,0x3f80a48d3f35bf35,0x250d3f803f353f35,0x3f353f353f35bf35,0xbf35bf35bf353f35,0x250d3f803f35bf35,0x3f80a5b0bf35bf35
.quad 0xbf353f353f35bf35,0xbf353f353f35bf35,0xbf8025543f35bf35,0xa60dbf803f353f35,0xbf35bf353f35bf35,0x3f353f35bf353f35,0xa58dbf803f35bf35,0xbf802731bf35bf35
.quad 0xbf800000bf80,0xbf800000bf80,0x3f35bf350000bf80,0x3f353f353f80a48d,0x3f80a48d0000bf80,0xbf802554250d3f80,0x3f353f350000bf80,0x3f35bf35bf802554
.quad 0x250d3f800000bf80,0x25d43f80a58dbf80,0xbf353f350000bf80,0xbf35bf353f80a5b0,0xbf8025540000bf80,0x3f80a61f25d43f80,0xbf35bf350000bf80,0xbf353f35bf8025f7
.quad 0x3f80a48d3f80a48d,0x3f80a48d3f80a48d,0x3f353f353f80a48d,0xbf353f35250d3f80,0x250d3f803f80a48d,0xa58dbf80bf802554,0xbf353f353f80a48d,0x3f353f35a58dbf80
.quad 0xbf8025543f80a48d,0xbf8025f73f80a5b0,0xbf35bf353f80a48d,0x3f35bf3525d43f80,0xa58dbf803f80a48d,0x26303f80bf8025f7,0x3f35bf353f80a48d,0xbf35bf35a60dbf80
.quad 0xbf800000bf80,0xbf800000bf80,0x3f35bf350000bf80,0x3f353f353f80a48d,0x3f80a48d0000bf80,0xbf802554250d3f80,0x3f353f350000bf80,0x3f35bf35bf802554
.quad 0x250d3f800000bf80,0x25d43f80a58dbf80,0xbf353f350000bf80,0xbf35bf353f80a5b0,0xbf8025540000bf80,0x3f80a61f25d43f80,0xbf35bf350000bf80,0xbf353f35bf8025f7
.quad 0x3f353f353f353f35,0x3f353f353f353f35,0x250d3f803f353f35,0xbf802554bf353f35,0xbf353f353f353f35,0x3f35bf35bf35bf35,0xbf8025543f353f35,0x25d43f803f35bf35
.quad 0xbf35bf353f353f35,0xbf35bf353f353f35,0xa58dbf803f353f35,0x3f80a61fbf353f35,0x3f35bf353f353f35,0xbf353f35bf35bf35,0x3f80a5b03f353f35,0xa654bf803f35bf35
.quad 0xbf808000bf808000,0xbf808000bf808000,0xbf35bf35bf808000,0x3f35bf35a48dbf80,0xa48dbf80bf808000,0x25543f803f80a50d,0x3f35bf35bf808000,0xbf35bf3525543f80
.quad 0x3f80a50dbf808000,0x3f80a5d4bf80258d,0x3f353f35bf808000,0xbf353f35a5b0bf80,0x25543f80bf808000,0xa61fbf803f80a5d4,0xbf353f35bf808000,0x3f353f3525f73f80
.quad 0xbf808000bf808000,0xbf808000bf808000,0xbf35bf35bf808000,0x3f35bf35a48dbf80,0xa48dbf80bf808000,0x25543f803f80a50d,0x3f35bf35bf808000,0xbf35bf3525543f80
.quad 0x3f80a50dbf808000,0x3f80a5d4bf80258d,0x3f353f35bf808000,0xbf353f35a5b0bf80,0x25543f80bf808000,0xa61fbf803f80a5d4,0xbf353f35bf808000,0x3f353f3525f73f80
.quad 0xbf808000bf808000,0xbf808000bf808000,0xbf35bf35bf808000,0x3f35bf35a48dbf80,0xa48dbf80bf808000,0x25543f803f80a50d,0x3f35bf35bf808000,0xbf35bf3525543f80
.quad 0x3f80a50dbf808000,0x3f80a5d4bf80258d,0x3f353f35bf808000,0xbf353f35a5b0bf80,0x25543f80bf808000,0xa61fbf803f80a5d4,0xbf353f35bf808000,0x3f353f3525f73f80
.quad 0xbf35bf35bf35bf35,0xbf35bf35bf35bf35,0xa48dbf80bf35bf35,0x3f80a50d3f35bf35,0x3f35bf35bf35bf35,0xbf353f353f353f35,0x3f80a50dbf35bf35,0xa5b0bf80bf353f35
.quad 0x3f353f35bf35bf35,0x3f353f35bf35bf35,0x25543f80bf35bf35,0xbf80260d3f35bf35,0xbf353f35bf35bf35,0x3f35bf353f353f35,0xbf80258dbf35bf35,0x27313f80bf353f35
.quad 0xbf808000bf808000,0xbf808000bf808000,0xbf35bf35bf808000,0x3f35bf35a48dbf80,0xa48dbf80bf808000,0x25543f803f80a50d,0x3f35bf35bf808000,0xbf35bf3525543f80
.quad 0x3f80a50dbf808000,0x3f80a5d4bf80258d,0x3f353f35bf808000,0xbf353f35a5b0bf80,0x25543f80bf808000,0xa61fbf803f80a5d4,0xbf353f35bf808000,0x3f353f3525f73f80
.quad 0xa48dbf80a48dbf80,0xa48dbf80a48dbf80,0x3f35bf35a48dbf80,0x3f353f353f80a50d,0x3f80a50da48dbf80,0xbf80258d25543f80,0x3f353f35a48dbf80,0x3f35bf35bf80258d
.quad 0x25543f80a48dbf80,0x25f73f80a5b0bf80,0xbf353f35a48dbf80,0xbf35bf353f80a5d4,0xbf80258da48dbf80,0x3f80a63025f73f80,0xbf35bf35a48dbf80,0xbf353f35bf80260d
.quad 0xbf808000bf808000,0xbf808000bf808000,0xbf35bf35bf808000,0x3f35bf35a48dbf80,0xa48dbf80bf808000,0x25543f803f80a50d,0x3f35bf35bf808000,0xbf35bf3525543f80
.quad 0x3f80a50dbf808000,0x3f80a5d4bf80258d,0x3f353f35bf808000,0xbf353f35a5b0bf80,0x25543f80bf808000,0xa61fbf803f80a5d4,0xbf353f35bf808000,0x3f353f3525f73f80
.quad 0x3f35bf353f35bf35,0x3f35bf353f35bf35,0x3f80a50d3f35bf35,0x25543f803f353f35,0x3f353f353f35bf35,0xbf35bf35bf353f35,0x25543f803f35bf35,0x3f80a5d4bf35bf35
.quad 0xbf353f353f35bf35,0xbf353f353f35bf35,0xbf80258d3f35bf35,0xa61fbf803f353f35,0xbf35bf353f35bf35,0x3f353f35bf353f35,0xa5b0bf803f35bf35,0xbf802654bf35bf35
.quad 0x80003f8080003f80,0x80003f8080003f80,0xbf800000bf80,0xbf800000bf80,0x80003f8080003f80,0x80003f8080003f80,0xbf800000bf80,0xbf800000bf80
.quad 0x80003f8080003f80,0x80003f8080003f80,0xbf800000bf80,0xbf800000bf80,0x80003f8080003f80,0x80003f8080003f80,0xbf800000bf80,0xbf800000bf80
.quad 0xbf353f3580003f80,0xbf35bf35bf80248d,0x3f35bf350000bf80,0x3f353f353f80a48d,0xbf353f3580003f80,0xbf35bf35bf80248d,0x3f35bf350000bf80,0x3f353f353f80a48d
.quad 0xbf353f3580003f80,0xbf35bf35bf80248d,0x3f35bf350000bf80,0x3f353f353f80a48d,0xbf353f3580003f80,0xbf35bf35bf80248d,0x3f35bf350000bf80,0x3f353f353f80a48d
.quad 0x80003f8080003f80,0x80003f8080003f80,0xbf800000bf80,0xbf800000bf80,0x80003f8080003f80,0x80003f8080003f80,0xbf800000bf80,0xbf800000bf80
.quad 0x80003f8080003f80,0x80003f8080003f80,0xbf800000bf80,0xbf800000bf80,0x80003f8080003f80,0x80003f8080003f80,0xbf800000bf80,0xbf800000bf80
.quad 0x3f35bf35a50dbf80,0x3f353f353f80a554,0xbf353f35250d3f80,0xbf35bf35bf802554,0x3f35bf35a50dbf80,0x3f353f353f80a554,0xbf353f35250d3f80,0xbf35bf35bf802554
.quad 0x3f35bf35a50dbf80,0x3f353f353f80a554,0xbf353f35250d3f80,0xbf35bf35bf802554,0x3f35bf35a50dbf80,0x3f353f353f80a554,0xbf353f35250d3f80,0xbf35bf35bf802554
.quad 0x8000000080000000,0x8000000080000000,0x8000000080000000,0x8000000080000000,0x8000000080000000,0x8000000080000000,0x8000000080000000,0x8000000080000000
.quad 0x8000000080000000,0x8000000080000000,0x8000000080000000,0x8000000080000000,0x8000000080000000,0x8000000080000000,0x8000000080000000,0x8000000080000000
.quad 0x8000000000000000,0x8000800080000000,0x8000000000000000,0x8000800080000000,0x8000000000000000,0x8000800080000000,0x8000000000000000,0x8000800080000000
.quad 0x8000000000000000,0x8000800080000000,0x8000000000000000,0x8000800080000000,0x8000000000000000,0x8000800080000000,0x8000000000000000,0x8000800080000000
.quad 0x8000000080000000,0x8000000080000000,0x8000000080000000,0x8000000080000000,0x8000000080000000,0x8000000080000000,0x8000000080000000,0x8000000080000000
.quad 0x8000000080000000,0x8000000080000000,0x8000000080000000,0x8000000080000000,0x8000000080000000,0x8000000080000000,0x8000000080000000,0x8000000080000000
.quad 0x800080008000,0x8000,0x800080008000,0x8000,0x800080008000,0x8000,0x800080008000,0x8000
.quad 0x800080008000,0x8000,0x800080008000,0x8000,0x800080008000,0x8000,0x800080008000,0x8000
.quad 0xbf80248d80003f80,0x3f80a554a50dbf80,0x3f80a48d0000bf80,0xbf802554250d3f80,0xbf80248d80003f80,0x3f80a554a50dbf80,0x3f80a48d0000bf80,0xbf802554250d3f80
.quad 0xbf80248d80003f80,0x3f80a554a50dbf80,0x3f80a48d0000bf80,0xbf802554250d3f80,0xbf80248d80003f80,0x3f80a554a50dbf80,0x3f80a48d0000bf80,0xbf802554250d3f80
.quad 0xbf35bf3580003f80,0xbf353f353f80a554,0x3f353f350000bf80,0x3f35bf35bf802554,0xbf35bf3580003f80,0xbf353f353f80a554,0x3f353f350000bf80,0x3f35bf35bf802554
.quad 0xbf35bf3580003f80,0xbf353f353f80a554,0x3f353f350000bf80,0x3f35bf35bf802554,0xbf35bf3580003f80,0xbf353f353f80a554,0x3f353f350000bf80,0x3f35bf35bf802554
.quad 0xbf8025b0258d3f80,0x3f80a5f7a5d4bf80,0x3f80a5b0a58dbf80,0xbf8025f725d43f80,0xbf8025b0258d3f80,0x3f80a5f7a5d4bf80,0x3f80a5b0a58dbf80,0xbf8025f725d43f80
.quad 0xbf8025b0258d3f80,0x3f80a5f7a5d4bf80,0x3f80a5b0a58dbf80,0xbf8025f725d43f80,0xbf8025b0258d3f80,0x3f80a5f7a5d4bf80,0x3f80a5b0a58dbf80,0xbf8025f725d43f80
.quad 0x3f353f35a5d4bf80,0x3f35bf35bf80261f,0xbf35bf3525d43f80,0xbf353f353f80a61f,0x3f353f35a5d4bf80,0x3f35bf35bf80261f,0xbf35bf3525d43f80,0xbf353f353f80a61f
.quad 0x3f353f35a5d4bf80,0x3f35bf35bf80261f,0xbf35bf3525d43f80,0xbf353f353f80a61f,0x3f353f35a5d4bf80,0x3f35bf35bf80261f,0xbf35bf3525d43f80,0xbf353f353f80a61f
.quad 0x8000000000000000,0x800080008000,0x8000000000000000,0x800080008000,0x8000000000000000,0x800080008000,0x8000000000000000,0x800080008000
.quad 0x8000000000000000,0x800080008000,0x8000000000000000,0x800080008000,0x8000000000000000,0x800080008000,0x8000000000000000,0x800080008000
.quad 0x8000800000000000,0x8000000000008000,0x8000800000000000,0x8000000000008000,0x8000800000000000,0x8000000000008000,0x8000800000000000,0x8000000000008000
.quad 0x8000800000000000,0x8000000000008000,0x8000800000000000,0x8000000000008000,0x8000800000000000,0x8000000000008000,0x8000800000000000,0x8000000000008000
.quad 0x8000800000000000,0x800080008000,0x8000800000000000,0x800080008000,0x8000800000000000,0x800080008000,0x8000800000000000,0x800080008000
.quad 0x8000800000000000,0x800080008000,0x8000800000000000,0x800080008000,0x8000800000000000,0x800080008000,0x8000800000000000,0x800080008000
.quad 0x80008000,0x800080008000,0x80008000,0x800080008000,0x80008000,0x800080008000,0x80008000,0x800080008000
.quad 0x80008000,0x800080008000,0x80008000,0x800080008000,0x80008000,0x800080008000,0x80008000,0x800080008000
.quad 0xa50dbf8080003f80,0xa5d4bf80258d3f80,0x250d3f800000bf80,0x25d43f80a58dbf80,0xa50dbf8080003f80,0xa5d4bf80258d3f80,0x250d3f800000bf80,0x25d43f80a58dbf80
.quad 0xa50dbf8080003f80,0xa5d4bf80258d3f80,0x250d3f800000bf80,0x25d43f80a58dbf80,0xa50dbf8080003f80,0xa5d4bf80258d3f80,0x250d3f800000bf80,0x25d43f80a58dbf80
.quad 0x3f35bf3580003f80,0x3f353f35bf8025b0,0xbf353f350000bf80,0xbf35bf353f80a5b0,0x3f35bf3580003f80,0x3f353f35bf8025b0,0xbf353f350000bf80,0xbf35bf353f80a5b0
.quad 0x3f35bf3580003f80,0x3f353f35bf8025b0,0xbf353f350000bf80,0xbf35bf353f80a5b0,0x3f35bf3580003f80,0x3f353f35bf8025b0,0xbf353f350000bf80,0xbf35bf353f80a5b0
.quad 0xa630bf80260d3f80,0xa677bf8026543f80,0x26303f80a60dbf80,0x26773f80a654bf80,0xa630bf80260d3f80,0xa677bf8026543f80,0x26303f80a60dbf80,0x26773f80a654bf80
.quad 0xa630bf80260d3f80,0xa677bf8026543f80,0x26303f80a60dbf80,0x26773f80a654bf80,0xa630bf80260d3f80,0xa677bf8026543f80,0x26303f80a60dbf80,0x26773f80a654bf80
.quad 0xbf353f35a630bf80,0xbf35bf353f80a742,0x3f35bf3526303f80,0x3f353f35bf802742,0xbf353f35a630bf80,0xbf35bf353f80a742,0x3f35bf3526303f80,0x3f353f35bf802742
.quad 0xbf353f35a630bf80,0xbf35bf353f80a742,0x3f35bf3526303f80,0x3f353f35bf802742,0xbf353f35a630bf80,0xbf35bf353f80a742,0x3f35bf3526303f80,0x3f353f35bf802742
.quad 0x8000800000000000,0x8000800000000000,0x8000800000000000,0x8000800000000000,0x8000800000000000,0x8000800000000000,0x8000800000000000,0x8000800000000000
.quad 0x8000800000000000,0x8000800000000000,0x8000800000000000,0x8000800000000000,0x8000800000000000,0x8000800000000000,0x8000800000000000,0x8000800000000000
.quad 0x800000000000,0x80008000,0x800000000000,0x80008000,0x800000000000,0x80008000,0x800000000000,0x80008000
.quad 0x800000000000,0x80008000,0x800000000000,0x80008000,0x800000000000,0x80008000,0x800000000000,0x80008000
.quad 0x800000000000,0x8000800000000000,0x800000000000,0x8000800000000000,0x800000000000,0x8000800000000000,0x800000000000,0x8000800000000000
.quad 0x800000000000,0x8000800000000000,0x800000000000,0x8000800000000000,0x800000000000,0x8000800000000000,0x800000000000,0x8000800000000000
.quad 0x8000000080008000,0x8000800000008000,0x8000000080008000,0x8000800000008000,0x8000000080008000,0x8000800000008000,0x8000000080008000,0x8000800000008000
.quad 0x8000000080008000,0x8000800000008000,0x8000000080008000,0x8000800000008000,0x8000000080008000,0x8000800000008000,0x8000000080008000,0x8000800000008000
.quad 0x3f80a55480003f80,0xbf80261fa5d4bf80,0xbf8025540000bf80,0x3f80a61f25d43f80,0x3f80a55480003f80,0xbf80261fa5d4bf80,0xbf8025540000bf80,0x3f80a61f25d43f80
.quad 0x3f80a55480003f80,0xbf80261fa5d4bf80,0xbf8025540000bf80,0x3f80a61f25d43f80,0x3f80a55480003f80,0xbf80261fa5d4bf80,0xbf8025540000bf80,0x3f80a61f25d43f80
.quad 0x3f353f3580003f80,0x3f35bf353f80a5f7,0xbf35bf350000bf80,0xbf353f35bf8025f7,0x3f353f3580003f80,0x3f35bf353f80a5f7,0xbf35bf350000bf80,0xbf353f35bf8025f7
.quad 0x3f353f3580003f80,0x3f35bf353f80a5f7,0xbf35bf350000bf80,0xbf353f35bf8025f7,0x3f353f3580003f80,0x3f35bf353f80a5f7,0xbf35bf350000bf80,0xbf353f35bf8025f7
.quad 0x3f80a74226543f80,0xbf80a60da69fbf80,0xbf802742a654bf80,0x3f80260d269f3f80,0x3f80a74226543f80,0xbf80a60da69fbf80,0xbf802742a654bf80,0x3f80260d269f3f80
.quad 0x3f80a74226543f80,0xbf80a60da69fbf80,0xbf802742a654bf80,0x3f80260d269f3f80,0x3f80a74226543f80,0xbf80a60da69fbf80,0xbf802742a654bf80,0x3f80260d269f3f80
.quad 0xbf35bf35a677bf80,0xbf353f35bf80a60d,0x3f353f3526773f80,0x3f35bf353f80260d,0xbf35bf35a677bf80,0xbf353f35bf80a60d,0x3f353f3526773f80,0x3f35bf353f80260d
.quad 0xbf35bf35a677bf80,0xbf353f35bf80a60d,0x3f353f3526773f80,0x3f35bf353f80260d,0xbf35bf35a677bf80,0xbf353f35bf80a60d,0x3f353f3526773f80,0x3f35bf353f80260d
.quad 0x800000000000,0x8000000080008000,0x800000000000,0x8000000080008000,0x800000000000,0x8000000080008000,0x800000000000,0x8000000080008000
.quad 0x800000000000,0x8000000080008000,0x800000000000,0x8000000080008000,0x800000000000,0x8000000080008000,0x800000000000,0x8000000080008000
.quad 0x0,0x800000008000,0x0,0x800000008000,0x0,0x800000008000,0x0,0x800000008000
.quad 0x0,0x800000008000,0x0,0x800000008000,0x0,0x800000008000,0x0,0x800000008000
.quad 0x800000000000,0x8000000000008000,0x800000000000,0x8000000000008000,0x800000000000,0x8000000000008000,0x800000000000,0x8000000000008000
.quad 0x800000000000,0x8000000000008000,0x800000000000,0x8000000000008000,0x800000000000,0x8000000000008000,0x800000000000,0x8000000000008000
.quad 0x8000800000008000,0x8000000080000000,0x8000800000008000,0x8000000080000000,0x8000800000008000,0x8000000080000000,0x8000800000008000,0x8000000080000000
.quad 0x8000800000008000,0x8000000080000000,0x8000800000008000,0x8000000080000000,0x8000800000008000,0x8000000080000000,0x8000800000008000,0x8000000080000000
.quad 0x3f7d3f7f3f803f80,0x3f183f223f2c3f35,0x3f673f753f7d3f80,0xbf71bf62bf4ebf35,0x3f3e3f623f783f80,0xbd49be95bf04bf35,0x3f043f463f713f80,0x3f783f7f3f673f35
.quad 0x3e793f223f673f80,0xbf04bdc93eac3f35,0xbd493ef13f5c3f80,0xbf2cbf75bf78bf35,0xbeac3e953f4e3f80,0x3f673ef1be16bf35,0xbf183dc93f3e3f80,0x3e163f463f803f35
.quad 0xbf4ebdc93f2c3f80,0xbf7dbf46bd493f35,0xbf71be953f183f80,0x3edbbef1bf7dbf35,0xbf80bef13f043f80,0x3f3e3f753e79bf35,0xbf78bf223edb3f80,0xbf5c3dc93f713f35
.quad 0xbf5cbf463eac3f80,0xbe79bf7fbedb3f35,0xbf2cbf623e793f80,0x3f803e95bf5cbf35,0xbedbbf753e163f80,0xbeac3f623f18bf35,0xbe16bf7f3d493f80,0xbf4ebf223f3e3f35
.quad 0x3f713f753f783f7b,0x3edb3ef13f043f0e,0x3f043f223f3e3f55,0xbf78bf7fbf80bf7b,0xbe163dc93eac3f0e,0x3f4e3f223edb3e48,0xbf3ebef1be163e48,0xbd493e953f183f55
.quad 0xbf80bf62bf18be48,0xbf3ebf75bf7dbf55,0xbf4ebf7fbf67bf0e,0x3f7d3f463eacbe48,0xbe79bf46bf80bf55,0xbf043dc93f2c3f7b,0x3edbbe95bf5cbf7b,0xbeacbf62bf78bf0e
.quad 0x3f673e95bf04bf7b,0x3f713f623e79bf0e,0x3f783f46bd49bf55,0xbf5cbdc93f3e3f7b,0x3f183f7f3edbbf0e,0x3e16bf46bf71be48,0xbd493f623f4ebe48,0x3f2c3f753e16bf55
.quad 0xbf2c3ef13f7d3e48,0xbf80be953f4e3f55,0xbf7dbdc93f713f0e,0x3f18bf22bf673e48,0xbf5cbf223f2c3f55,0x3e793f7f3d49bf7b,0xbeacbf753e793f7b,0xbf67bef13f5c3f0e
.quad 0x3f5c3f623f673f6d,0x3e793e953eac3ec4,0xbd493dc93e793ec4,0xbf2cbf46bf5cbf6d,0xbf67bf46bf18bec4,0x3f713f7f3f7d3f6d,0xbf4ebf75bf80bf6d,0xbf7dbf62bf2cbec4
.quad 0x3e16be95bf2cbf6d,0x3f4e3ef13d49bec4,0x3f713f223e16bec4,0xbedb3dc93f183f6d,0x3f3e3f7f3f5c3ec4,0xbd49bf22bf78bf6d,0xbe793ef13f713f6d,0x3f043f753f673ec4
.quad 0xbf78bef13eac3f6d,0xbf5cbf75bedb3ec4,0xbf2cbf7fbf043ec4,0x3f803f22be79bf6d,0x3eacbf22bf7dbec4,0xbf67bdc93f4e3f6d,0x3f7d3e95bf3ebf6d,0x3f18bef1bf80bec4
.quad 0x3f183f753d49bf6d,0xbe163f623f3ebec4,0xbedb3f463f4ebec4,0xbeacbf7fbe163f6d,0xbf80bdc93f783ec4,0x3f3e3f46bf04bf6d,0xbf04bf623edb3f6d,0xbf78be953f713ec4
.quad 0x3f3e3f463f4e3f55,0x3d493dc93e163e48,0xbf18bef1beacbe48,0xbe16be95bedbbf0e,0xbf5cbf75bf80bf7b,0x3e793ef13f2c3f55,0x3edb3dc9be79bf0e,0xbeacbf22bf5cbf7b
.quad 0x3f713f7f3f5c3f0e,0x3edb3f463f783f7b,0xbe793e953f3e3f7b,0xbf04bf62bf80bf55,0xbf7dbf62bedb3e48,0x3f183f753f713f0e,0x3d49bf22bf7dbf55,0xbf2cbf7fbf4ebe48
.quad 0x3f803f22be16bf55,0x3f3e3f7f3f18be48,0x3e163f623f673e48,0xbf4ebf75beac3f0e,0xbf78be953f2c3f7b,0x3f5c3f623d49bf55,0xbeacbf7fbf043f0e,0xbf67bf463e793f7b
.quad 0x3f67bdc9bf78bf0e,0x3f713f22bf04bf7b,0x3f043f75bd49bf7b,0xbf78bef13f3e3f55,0xbf4e3ef13f71be48,0x3f7d3e95bf67bf0e,0xbf2cbf463f183f55,0xbf80bdc93f7d3e48
.quad 0x3e16bf7fbd493f80,0x3f4ebf22bf3e3f35,0x3edbbf75be163f80,0x3eac3f62bf18bf35,0x3f2cbf62be793f80,0xbf803e953f5cbf35,0x3f5cbf46beac3f80,0x3e79bf7f3edb3f35
.quad 0x3f78bf22bedb3f80,0x3f5c3dc9bf713f35,0x3f80bef1bf043f80,0xbf3e3f75be79bf35,0x3f71be95bf183f80,0xbedbbef13f7dbf35,0x3f4ebdc9bf2c3f80,0x3f7dbf463d493f35
.quad 0x3f183dc9bf3e3f80,0xbe163f46bf803f35,0x3eac3e95bf4e3f80,0xbf673ef13e16bf35,0x3d493ef1bf5c3f80,0x3f2cbf753f78bf35,0xbe793f22bf673f80,0x3f04bdc9beac3f35
.quad 0xbf043f46bf713f80,0xbf783f7fbf673f35,0xbf3e3f62bf783f80,0x3d49be953f04bf35,0xbf673f75bf7d3f80,0x3f71bf623f4ebf35,0xbf7d3f7fbf803f80,0xbf183f22bf2c3f35
.quad 0x3eacbf75be793f7b,0x3f67bef1bf5c3f0e,0x3f5cbf22bf2c3f55,0xbe793f7fbd49bf7b,0x3f7dbdc9bf713f0e,0xbf18bf223f673e48,0x3f2c3ef1bf7d3e48,0x3f80be95bf4e3f55
.quad 0x3d493f62bf4ebe48,0xbf2c3f75be16bf55,0xbf183f7fbedbbf0e,0xbe16bf463f71be48,0xbf783f463d49bf55,0x3f5cbdc9bf3e3f7b,0xbf673e953f04bf7b,0xbf713f62be79bf0e
.quad 0xbedbbe953f5cbf7b,0x3eacbf623f78bf0e,0x3e79bf463f80bf55,0x3f043dc9bf2c3f7b,0x3f4ebf7f3f67bf0e,0xbf7d3f46beacbe48,0x3f80bf623f18be48,0x3f3ebf753f7dbf55
.quad 0x3f3ebef13e163e48,0x3d493e95bf183f55,0x3e163dc9beac3f0e,0xbf4e3f22bedb3e48,0xbf043f22bf3e3f55,0x3f78bf7f3f80bf7b,0xbf713f75bf783f7b,0xbedb3ef1bf043f0e
.quad 0x3f04bf62bedb3f6d,0x3f78be95bf713ec4,0x3f80bdc9bf783ec4,0xbf3e3f463f04bf6d,0x3edb3f46bf4ebec4,0x3eacbf7f3e163f6d,0xbf183f75bd49bf6d,0x3e163f62bf3ebec4
.quad 0xbf7d3e953f3ebf6d,0xbf18bef13f80bec4,0xbeacbf223f7dbec4,0x3f67bdc9bf4e3f6d,0x3f2cbf7f3f043ec4,0xbf803f223e79bf6d,0x3f78bef1beac3f6d,0x3f5cbf753edb3ec4
.quad 0x3e793ef1bf713f6d,0xbf043f75bf673ec4,0xbf3e3f7fbf5c3ec4,0x3d49bf223f78bf6d,0xbf713f22be16bec4,0x3edb3dc9bf183f6d,0xbe16be953f2cbf6d,0xbf4e3ef1bd49bec4
.quad 0x3f4ebf753f80bf6d,0x3f7dbf623f2cbec4,0x3f67bf463f18bec4,0xbf713f7fbf7d3f6d,0x3d493dc9be793ec4,0x3f2cbf463f5cbf6d,0xbf5c3f62bf673f6d,0xbe793e95beac3ec4
.quad 0x3f2cbf46bf183f55,0x3f80bdc9bf7d3e48,0x3f4e3ef1bf71be48,0xbf7d3e953f67bf0e,0xbf043f753d49bf7b,0x3f78bef1bf3e3f55,0xbf67bdc93f78bf0e,0xbf713f223f04bf7b
.quad 0x3eacbf7f3f043f0e,0x3f67bf46be793f7b,0x3f78be95bf2c3f7b,0xbf5c3f62bd49bf55,0xbe163f62bf673e48,0x3f4ebf753eac3f0e,0xbf803f223e16bf55,0xbf3e3f7fbf18be48
.quad 0xbd49bf223f7dbf55,0x3f2cbf7f3f4ebe48,0x3f7dbf623edb3e48,0xbf183f75bf713f0e,0x3e793e95bf3e3f7b,0x3f04bf623f80bf55,0xbf713f7fbf5c3f0e,0xbedb3f46bf783f7b
.quad 0xbedb3dc93e79bf0e,0x3eacbf223f5cbf7b,0x3f5cbf753f80bf7b,0xbe793ef1bf2c3f55,0x3f18bef13eacbe48,0x3e16be953edbbf0e,0xbf3e3f46bf4e3f55,0xbd493dc9be163e48
.quad 0xbe16bdc9bd49248d,0xbf4ebf46bf3ebf35,0x3edb3e953e16a554,0x3eac3ef13f183f35,0xbf2cbef1be7925b0,0x3f803f753f5c3f35,0x3f5c3f223eaca5f7,0x3e79bdc9bedbbf35
.quad 0xbf78bf46bedb261f,0xbf5cbf7fbf71bf35,0x3f803f623f04a731,0xbf3ebe953e793f35,0xbf71bf75bf18a68d,0x3edb3f623f7d3f35,0x3f4e3f7f3f2ca742,0x3f7d3f22bd49bf35
.quad 0xbf18bf7fbf3ea654,0x3e16bf22bf80bf35,0x3eac3f753f4ea754,0xbf67bf62be163f35,0xbd49bf62bf5ca60d,0xbf2c3e953f783f35,0xbe793f463f67a765,0x3f043f7f3eacbf35
.quad 0x3f04bf22bf71a58e,0x3f783dc9bf67bf35,0xbf3e3ef13f78a777,0x3d49bf75bf043f35,0x3f67be95bf7da137,0xbf71bef13f4e3f35,0xbf7d3dc93f80a784,0xbf183f463f2cbf35
.quad 0xbeacbe95be79be48,0xbf67bf62bf5cbf55,0x3f5c3f463f2c3f0e,0xbe79bdc93d493e48,0xbf7dbf7fbf71bf55,0x3f183f463f673f7b,0x3f2c3f623f7d3f7b,0x3f803f753f4e3f0e
.quad 0xbd49bef1bf4ebf7b,0x3f2c3e95be16bf0e,0xbf18bdc93edb3f55,0xbe16bf22bf71bf7b,0x3f783f223d49bf0e,0xbf5cbf7fbf3ebe48,0xbf67bf75bf043e48,0xbf71bef13e793f55
.quad 0x3edb3f753f5c3e48,0xbeac3ef13f783f55,0x3e79bf22bf80bf0e,0x3f043f7f3f2cbe48,0xbf4e3dc93f673f55,0x3f7d3f22beacbf7b,0x3f803ef1bf18bf7b,0x3f3ebe95bf7dbf0e
.quad 0xbf3ebf623e163f7b,0xbd49bf75bf183f0e,0x3e163f7f3eacbf55,0xbf4ebf463edb3f7b,0x3f04bf46bf3e3f0e,0xbf783dc93f803e48,0xbf713e953f78be48,0xbedb3f623f04bf55
.quad 0xbf04bef1bedbbec4,0xbf78bf75bf71bf6d,0x3f803f7f3f783f6d,0xbf3ebf22bf04bec4,0xbedbbf22bf4ebf6d,0xbeacbdc93e163ec4,0xbf18be953d493ec4,0x3e163ef13f3e3f6d
.quad 0x3f7d3f753f3e3ec4,0x3f183f623f803f6d,0xbeacbf46bf7dbf6d,0x3f673f7f3f4e3ec4,0xbf2cbdc93f043f6d,0x3f803f463e79bec4,0x3f783f623eacbec4,0x3f5c3e95bedbbf6d
.quad 0xbe79bf62bf71bec4,0x3f04be95bf67bf6d,0xbf3e3dc93f5c3f6d,0x3d49bf46bf78bec4,0x3f713f46be16bf6d,0xbedbbf7fbf183ec4,0xbe16bf75bf2c3ec4,0xbf4ebf623d493f6d
.quad 0xbf4e3e953f803ec4,0xbf7dbef13f2c3f6d,0x3f673f22bf18bf6d,0xbf713dc93f7d3ec4,0xbd49bf7fbe793f6d,0xbf2c3f223f5cbec4,0xbf5c3ef13f67bec4,0xbe793f753eacbf6d
.quad 0xbf2cbf22bf18bf0e,0xbf80bf7fbf7dbf7b,0x3f4e3f623f713f7b,0xbf7dbf75bf67bf55,0x3f043e953d49be48,0xbf78bf62bf3ebf0e,0xbf67bf7fbf78bf55,0xbf71bf46bf04be48
.quad 0xbeac3dc93f043f55,0xbf67bf22be793e48,0x3f783f753f2c3e48,0xbf5cbef13d493f0e,0x3e16bef1bf67bf7b,0xbf4ebe953eac3f55,0xbf80bf46be163f0e,0xbf3ebdc93f183f7b
.quad 0x3d493f463f7d3f0e,0xbf2c3dc93f4e3f7b,0x3f7d3ef1bedbbf7b,0xbf183e953f713f55,0xbe79bf75bf3e3e48,0xbf043ef13f803f0e,0xbf71bdc93f5c3f55,0xbedb3f223f783e48
.quad 0x3edb3f7f3e79bf55,0xbeac3f463f5cbe48,0x3f5cbe95bf80be48,0xbe793f623f2cbf0e,0xbf18bf623eac3f7b,0xbe163f753edbbf55,0xbf3e3f223f4ebf0e,0xbd493f7f3e16bf7b
.quad 0x3f7d3dc9bf80258d,0x3f183f46bf2cbf35,0xbf67be953f7da78d,0x3f71bef1bf4e3f35,0x3f3e3ef1bf78260d,0xbd49bf753f043f35,0xbf04bf223f71a796,0xbf783dc93f67bf35
.quad 0x3e793f46bf67280d,0xbf043f7fbeacbf35,0x3d49bf623f5ca79f,0x3f2c3e95bf783f35,0xbeac3f75bf4e268d,0x3f67bf623e163f35,0x3f18bf7f3f3e2731,0xbe16bf223f80bf35
.quad 0xbf4e3f7fbf2c2816,0xbf7d3f223d49bf35,0x3f71bf753f18a7b1,0xbedb3f62bf7d3f35,0xbf803f62bf0426d4,0x3f3ebe95be793f35,0x3f78bf463edb270d,0x3f5cbf7f3f71bf35
.quad 0xbf5c3f22beac281f,0xbe79bdc93edbbf35,0x3f2cbef13e79a7c2,0xbf803f75bf5c3f35,0xbedb3e95be16270d,0xbeac3ef1bf183f35,0x3e16bdc93d4926d4,0x3f4ebf463f3ebf35
.quad 0x3f713e95bf78be48,0x3edb3f62bf04bf55,0xbf04bf463f3e3f0e,0x3f783dc9bf803e48,0xbe163f7fbeacbf55,0x3f4ebf46bedb3f7b,0x3f3ebf62be163f7b,0x3d49bf753f183f0e
.quad 0xbf803ef13f18bf7b,0xbf3ebe953f7dbf0e,0x3f4e3dc9bf673f55,0xbf7d3f223eacbf7b,0xbe79bf223f80bf0e,0xbf043f7fbf2cbe48,0xbedb3f75bf5c3e48,0x3eac3ef1bf783f55
.quad 0x3f67bf753f043e48,0x3f71bef1be793f55,0xbf783f22bd49bf0e,0x3f5cbf7f3f3ebe48,0x3f18bdc9bedb3f55,0x3e16bf223f71bf7b,0x3d49bef13f4ebf7b,0xbf2c3e953e16bf0e
.quad 0xbf2c3f62bf7d3f7b,0xbf803f75bf4e3f0e,0x3f7dbf7f3f71bf55,0xbf183f46bf673f7b,0xbf5c3f46bf2c3f0e,0x3e79bdc9bd493e48,0x3eacbe953e79be48,0x3f67bf623f5cbf55
.quad 0x3f5c3ef1bf67bec4,0x3e793f75beacbf6d,0x3d49bf7f3e793f6d,0x3f2c3f22bf5cbec4,0xbf673f223f18bf6d,0x3f713dc9bf7d3ec4,0x3f4e3e95bf803ec4,0x3f7dbef1bf2c3f6d
.quad 0x3e16bf753f2c3ec4,0x3f4ebf62bd493f6d,0xbf713f463e16bf6d,0x3edbbf7f3f183ec4,0x3f3e3dc9bf5c3f6d,0xbd49bf463f78bec4,0x3e79bf623f71bec4,0xbf04be953f67bf6d
.quad 0xbf783f62beacbec4,0xbf5c3e953edbbf6d,0x3f2cbdc9bf043f6d,0xbf803f46be79bec4,0x3eacbf463f7dbf6d,0xbf673f7fbf4e3ec4,0xbf7d3f75bf3e3ec4,0xbf183f62bf803f6d
.quad 0x3f18be95bd493ec4,0xbe163ef1bf3e3f6d,0x3edbbf223f4ebf6d,0x3eacbdc9be163ec4,0xbf803f7fbf783f6d,0x3f3ebf223f04bec4,0x3f04bef13edbbec4,0x3f78bf753f71bf6d
.quad 0x3f3e3f22bf4ebf0e,0x3d493f7fbe16bf7b,0x3f18bf62beac3f7b,0x3e163f75bedbbf55,0xbf5cbe953f80be48,0x3e793f62bf2cbf0e,0xbedb3f7fbe79bf55,0x3eac3f46bf5cbe48
.quad 0x3f71bdc9bf5c3f55,0x3edb3f22bf783e48,0x3e79bf753f3e3e48,0x3f043ef1bf803f0e,0xbf7d3ef13edbbf7b,0x3f183e95bf713f55,0xbd493f46bf7d3f0e,0x3f2c3dc9bf4e3f7b
.quad 0x3f80bf463e163f0e,0x3f3ebdc9bf183f7b,0xbe16bef13f67bf7b,0x3f4ebe95beac3f55,0xbf783f75bf2c3e48,0x3f5cbef1bd493f0e,0x3eac3dc9bf043f55,0x3f67bf223e793e48
.quad 0x3f67bf7f3f78bf55,0x3f71bf463f04be48,0xbf043e95bd49be48,0x3f78bf623f3ebf0e,0xbf4e3f62bf713f7b,0x3f7dbf753f67bf55,0x3f2cbf223f18bf0e,0x3f80bf7f3f7dbf7b
.quad 0x3e163dc93d490000,0x3f4e3f463f3e3f35,0x3edb3e953e160000,0x3eac3ef13f183f35,0x3f2c3ef13e790000,0xbf80bf75bf5cbf35,0x3f5c3f223eac0000,0x3e79bdc9bedbbf35
.quad 0x3f783f463edb0000,0x3f5c3f7f3f713f35,0x3f803f623f040000,0xbf3ebe953e793f35,0x3f713f753f180000,0xbedbbf62bf7dbf35,0x3f4e3f7f3f2c0000,0x3f7d3f22bd49bf35
.quad 0x3f183f7f3f3e0000,0xbe163f223f803f35,0x3eac3f753f4e0000,0xbf67bf62be163f35,0x3d493f623f5c0000,0x3f2cbe95bf78bf35,0xbe793f463f670000,0x3f043f7f3eacbf35
.quad 0xbf043f223f710000,0xbf78bdc93f673f35,0xbf3e3ef13f780000,0x3d49bf75bf043f35,0xbf673e953f7d0000,0x3f713ef1bf4ebf35,0xbf7d3dc93f800000,0xbf183f463f2cbf35
.quad 0x3eac3e953e793e48,0x3f673f623f5c3f55,0x3f5c3f463f2c3f0e,0xbe79bdc93d493e48,0x3f7d3f7f3f713f55,0xbf18bf46bf67bf7b,0x3f2c3f623f7d3f7b,0x3f803f753f4e3f0e
.quad 0x3d493ef13f4e3f7b,0xbf2cbe953e163f0e,0xbf18bdc93edb3f55,0xbe16bf22bf71bf7b,0xbf78bf22bd493f0e,0x3f5c3f7f3f3e3e48,0xbf67bf75bf043e48,0xbf71bef13e793f55
.quad 0xbedbbf75bf5cbe48,0x3eacbef1bf78bf55,0x3e79bf22bf80bf0e,0x3f043f7f3f2cbe48,0x3f4ebdc9bf67bf55,0xbf7dbf223eac3f7b,0x3f803ef1bf18bf7b,0x3f3ebe95bf7dbf0e
.quad 0x3f3e3f62be16bf7b,0x3d493f753f18bf0e,0x3e163f7f3eacbf55,0xbf4ebf463edb3f7b,0xbf043f463f3ebf0e,0x3f78bdc9bf80be48,0xbf713e953f78be48,0xbedb3f623f04bf55
.quad 0x3f043ef13edb3ec4,0x3f783f753f713f6d,0x3f803f7f3f783f6d,0xbf3ebf22bf04bec4,0x3edb3f223f4e3f6d,0x3eac3dc9be16bec4,0xbf18be953d493ec4,0x3e163ef13f3e3f6d
.quad 0xbf7dbf75bf3ebec4,0xbf18bf62bf80bf6d,0xbeacbf46bf7dbf6d,0x3f673f7f3f4e3ec4,0x3f2c3dc9bf04bf6d,0xbf80bf46be793ec4,0x3f783f623eacbec4,0x3f5c3e95bedbbf6d
.quad 0x3e793f623f713ec4,0xbf043e953f673f6d,0xbf3e3dc93f5c3f6d,0x3d49bf46bf78bec4,0xbf71bf463e163f6d,0x3edb3f7f3f18bec4,0xbe16bf75bf2c3ec4,0xbf4ebf623d493f6d
.quad 0x3f4ebe95bf80bec4,0x3f7d3ef1bf2cbf6d,0x3f673f22bf18bf6d,0xbf713dc93f7d3ec4,0x3d493f7f3e79bf6d,0x3f2cbf22bf5c3ec4,0xbf5c3ef13f67bec4,0xbe793f753eacbf6d
.quad 0x3f2c3f223f183f0e,0x3f803f7f3f7d3f7b,0x3f4e3f623f713f7b,0xbf7dbf75bf67bf55,0xbf04be95bd493e48,0x3f783f623f3e3f0e,0xbf67bf7fbf78bf55,0xbf71bf46bf04be48
.quad 0x3eacbdc9bf04bf55,0x3f673f223e79be48,0x3f783f753f2c3e48,0xbf5cbef13d493f0e,0xbe163ef13f673f7b,0x3f4e3e95beacbf55,0xbf80bf46be163f0e,0xbf3ebdc93f183f7b
.quad 0xbd49bf46bf7dbf0e,0x3f2cbdc9bf4ebf7b,0x3f7d3ef1bedbbf7b,0xbf183e953f713f55,0x3e793f753f3ebe48,0x3f04bef1bf80bf0e,0xbf71bdc93f5c3f55,0xbedb3f223f783e48
.quad 0xbedbbf7fbe793f55,0x3eacbf46bf5c3e48,0x3f5cbe95bf80be48,0xbe793f623f2cbf0e,0x3f183f62beacbf7b,0x3e16bf75bedb3f55,0xbf3e3f223f4ebf0e,0xbd493f7f3e16bf7b
.quad 0xbf7dbdc93f800000,0xbf18bf463f2c3f35,0xbf67be953f7d0000,0x3f71bef1bf4e3f35,0xbf3ebef13f780000,0x3d493f75bf04bf35,0xbf04bf223f710000,0xbf783dc93f67bf35
.quad 0xbe79bf463f670000,0x3f04bf7f3eac3f35,0x3d49bf623f5c0000,0x3f2c3e95bf783f35,0x3eacbf753f4e0000,0xbf673f62be16bf35,0x3f18bf7f3f3e0000,0xbe16bf223f80bf35
.quad 0x3f4ebf7f3f2c0000,0x3f7dbf22bd493f35,0x3f71bf753f180000,0xbedb3f62bf7d3f35,0x3f80bf623f040000,0xbf3e3e953e79bf35,0x3f78bf463edb0000,0x3f5cbf7f3f71bf35
.quad 0x3f5cbf223eac0000,0x3e793dc9bedb3f35,0x3f2cbef13e790000,0xbf803f75bf5c3f35,0x3edbbe953e160000,0x3eacbef13f18bf35,0x3e16bdc93d490000,0x3f4ebf463f3ebf35
.quad 0xbf71be953f783e48,0xbedbbf623f043f55,0xbf04bf463f3e3f0e,0x3f783dc9bf803e48,0x3e16bf7f3eac3f55,0xbf4e3f463edbbf7b,0x3f3ebf62be163f7b,0x3d49bf753f183f0e
.quad 0x3f80bef1bf183f7b,0x3f3e3e95bf7d3f0e,0x3f4e3dc9bf673f55,0xbf7d3f223eacbf7b,0x3e793f22bf803f0e,0x3f04bf7f3f2c3e48,0xbedb3f75bf5c3e48,0x3eac3ef1bf783f55
.quad 0xbf673f75bf04be48,0xbf713ef13e79bf55,0xbf783f22bd49bf0e,0x3f5cbf7f3f3ebe48,0xbf183dc93edbbf55,0xbe163f22bf713f7b,0x3d49bef13f4ebf7b,0xbf2c3e953e16bf0e
.quad 0x3f2cbf623f7dbf7b,0x3f80bf753f4ebf0e,0x3f7dbf7f3f71bf55,0xbf183f46bf673f7b,0x3f5cbf463f2cbf0e,0xbe793dc93d49be48,0x3eacbe953e79be48,0x3f67bf623f5cbf55
.quad 0xbf5cbef13f673ec4,0xbe79bf753eac3f6d,0x3d49bf7f3e793f6d,0x3f2c3f22bf5cbec4,0x3f67bf22bf183f6d,0xbf71bdc93f7dbec4,0x3f4e3e95bf803ec4,0x3f7dbef1bf2c3f6d
.quad 0xbe163f75bf2cbec4,0xbf4e3f623d49bf6d,0xbf713f463e16bf6d,0x3edbbf7f3f183ec4,0xbf3ebdc93f5cbf6d,0x3d493f46bf783ec4,0x3e79bf623f71bec4,0xbf04be953f67bf6d
.quad 0x3f78bf623eac3ec4,0x3f5cbe95bedb3f6d,0x3f2cbdc9bf043f6d,0xbf803f46be79bec4,0xbeac3f46bf7d3f6d,0x3f67bf7f3f4ebec4,0xbf7d3f75bf3e3ec4,0xbf183f62bf803f6d
.quad 0xbf183e953d49bec4,0x3e16bef13f3ebf6d,0x3edbbf223f4ebf6d,0x3eacbdc9be163ec4,0x3f80bf7f3f78bf6d,0xbf3e3f22bf043ec4,0x3f04bef13edbbec4,0x3f78bf753f71bf6d
.quad 0xbf3ebf223f4e3f0e,0xbd49bf7f3e163f7b,0x3f18bf62beac3f7b,0x3e163f75bedbbf55,0x3f5c3e95bf803e48,0xbe79bf623f2c3f0e,0xbedb3f7fbe79bf55,0x3eac3f46bf5cbe48
.quad 0xbf713dc93f5cbf55,0xbedbbf223f78be48,0x3e79bf753f3e3e48,0x3f043ef1bf803f0e,0x3f7dbef1bedb3f7b,0xbf18be953f71bf55,0xbd493f46bf7d3f0e,0x3f2c3dc9bf4e3f7b
.quad 0xbf803f46be16bf0e,0xbf3e3dc93f18bf7b,0xbe16bef13f67bf7b,0x3f4ebe95beac3f55,0x3f78bf753f2cbe48,0xbf5c3ef13d49bf0e,0x3eac3dc9bf043f55,0x3f67bf223e793e48
.quad 0xbf673f7fbf783f55,0xbf713f46bf043e48,0xbf043e95bd49be48,0x3f78bf623f3ebf0e,0x3f4ebf623f71bf7b,0xbf7d3f75bf673f55,0x3f2cbf223f18bf0e,0x3f80bf7f3f7dbf7b
.quad 0x3f7d3f7f3f803f80,0x3f183f223f2c3f35,0xbf67bf75bf7dbf80,0x3f713f623f4e3f35,0x3f3e3f623f783f80,0xbd49be95bf04bf35,0xbf04bf46bf71bf80,0xbf78bf7fbf67bf35
.quad 0x3e793f223f673f80,0xbf04bdc93eac3f35,0x3d49bef1bf5cbf80,0x3f2c3f753f783f35,0xbeac3e953f4e3f80,0x3f673ef1be16bf35,0x3f18bdc9bf3ebf80,0xbe16bf46bf80bf35
.quad 0xbf4ebdc93f2c3f80,0xbf7dbf46bd493f35,0x3f713e95bf18bf80,0xbedb3ef13f7d3f35,0xbf80bef13f043f80,0x3f3e3f753e79bf35,0x3f783f22bedbbf80,0x3f5cbdc9bf71bf35
.quad 0xbf5cbf463eac3f80,0xbe79bf7fbedb3f35,0x3f2c3f62be79bf80,0xbf80be953f5c3f35,0xbedbbf753e163f80,0xbeac3f623f18bf35,0x3e163f7fbd49bf80,0x3f4e3f22bf3ebf35
.quad 0x3f713f753f783f7b,0x3edb3ef13f043f0e,0xbf04bf22bf3ebf55,0x3f783f7f3f803f7b,0xbe163dc93eac3f0e,0x3f4e3f223edb3e48,0x3f3e3ef13e16be48,0x3d49be95bf18bf55
.quad 0xbf80bf62bf18be48,0xbf3ebf75bf7dbf55,0x3f4e3f7f3f673f0e,0xbf7dbf46beac3e48,0xbe79bf46bf80bf55,0xbf043dc93f2c3f7b,0xbedb3e953f5c3f7b,0x3eac3f623f783f0e
.quad 0x3f673e95bf04bf7b,0x3f713f623e79bf0e,0xbf78bf463d493f55,0x3f5c3dc9bf3ebf7b,0x3f183f7f3edbbf0e,0x3e16bf46bf71be48,0x3d49bf62bf4e3e48,0xbf2cbf75be163f55
.quad 0xbf2c3ef13f7d3e48,0xbf80be953f4e3f55,0x3f7d3dc9bf71bf0e,0xbf183f223f67be48,0xbf5cbf223f2c3f55,0x3e793f7f3d49bf7b,0x3eac3f75be79bf7b,0x3f673ef1bf5cbf0e
.quad 0x3f5c3f623f673f6d,0x3e793e953eac3ec4,0x3d49bdc9be79bec4,0x3f2c3f463f5c3f6d,0xbf67bf46bf18bec4,0x3f713f7f3f7d3f6d,0x3f4e3f753f803f6d,0x3f7d3f623f2c3ec4
.quad 0x3e16be95bf2cbf6d,0x3f4e3ef13d49bec4,0xbf71bf22be163ec4,0x3edbbdc9bf18bf6d,0x3f3e3f7f3f5c3ec4,0xbd49bf22bf78bf6d,0x3e79bef1bf71bf6d,0xbf04bf75bf67bec4
.quad 0xbf78bef13eac3f6d,0xbf5cbf75bedb3ec4,0x3f2c3f7f3f04bec4,0xbf80bf223e793f6d,0x3eacbf22bf7dbec4,0xbf67bdc93f4e3f6d,0xbf7dbe953f3e3f6d,0xbf183ef13f803ec4
.quad 0x3f183f753d49bf6d,0xbe163f623f3ebec4,0x3edbbf46bf4e3ec4,0x3eac3f7f3e16bf6d,0xbf80bdc93f783ec4,0x3f3e3f46bf04bf6d,0x3f043f62bedbbf6d,0x3f783e95bf71bec4
.quad 0x3f3e3f463f4e3f55,0x3d493dc93e163e48,0x3f183ef13eac3e48,0x3e163e953edb3f0e,0xbf5cbf75bf80bf7b,0x3e793ef13f2c3f55,0xbedbbdc93e793f0e,0x3eac3f223f5c3f7b
.quad 0x3f713f7f3f5c3f0e,0x3edb3f463f783f7b,0x3e79be95bf3ebf7b,0x3f043f623f803f55,0xbf7dbf62bedb3e48,0x3f183f753f713f0e,0xbd493f223f7d3f55,0x3f2c3f7f3f4e3e48
.quad 0x3f803f22be16bf55,0x3f3e3f7f3f18be48,0xbe16bf62bf67be48,0x3f4e3f753eacbf0e,0xbf78be953f2c3f7b,0x3f5c3f623d49bf55,0x3eac3f7f3f04bf0e,0x3f673f46be79bf7b
.quad 0x3f67bdc9bf78bf0e,0x3f713f22bf04bf7b,0xbf04bf753d493f7b,0x3f783ef1bf3ebf55,0xbf4e3ef13f71be48,0x3f7d3e95bf67bf0e,0x3f2c3f46bf18bf55,0x3f803dc9bf7dbe48
.quad 0x3e16bf7fbd493f80,0x3f4ebf22bf3e3f35,0xbedb3f753e16bf80,0xbeacbf623f183f35,0x3f2cbf62be793f80,0xbf803e953f5cbf35,0xbf5c3f463eacbf80,0xbe793f7fbedbbf35
.quad 0x3f78bf22bedb3f80,0x3f5c3dc9bf713f35,0xbf803ef13f04bf80,0x3f3ebf753e793f35,0x3f71be95bf183f80,0xbedbbef13f7dbf35,0xbf4e3dc93f2cbf80,0xbf7d3f46bd49bf35
.quad 0x3f183dc9bf3e3f80,0xbe163f46bf803f35,0xbeacbe953f4ebf80,0x3f67bef1be163f35,0x3d493ef1bf5c3f80,0x3f2cbf753f78bf35,0x3e79bf223f67bf80,0xbf043dc93eacbf35
.quad 0xbf043f46bf713f80,0xbf783f7fbf673f35,0x3f3ebf623f78bf80,0xbd493e95bf043f35,0xbf673f75bf7d3f80,0x3f71bf623f4ebf35,0x3f7dbf7f3f80bf80,0x3f18bf223f2cbf35
.quad 0x3eacbf75be793f7b,0x3f67bef1bf5c3f0e,0xbf5c3f223f2cbf55,0x3e79bf7f3d493f7b,0x3f7dbdc9bf713f0e,0xbf18bf223f673e48,0xbf2cbef13f7dbe48,0xbf803e953f4ebf55
.quad 0x3d493f62bf4ebe48,0xbf2c3f75be16bf55,0x3f18bf7f3edb3f0e,0x3e163f46bf713e48,0xbf783f463d49bf55,0x3f5cbdc9bf3e3f7b,0x3f67be95bf043f7b,0x3f71bf623e793f0e
.quad 0xbedbbe953f5cbf7b,0x3eacbf623f78bf0e,0xbe793f46bf803f55,0xbf04bdc93f2cbf7b,0x3f4ebf7f3f67bf0e,0xbf7d3f46beacbe48,0xbf803f62bf183e48,0xbf3e3f75bf7d3f55
.quad 0x3f3ebef13e163e48,0x3d493e95bf183f55,0xbe16bdc93eacbf0e,0x3f4ebf223edbbe48,0xbf043f22bf3e3f55,0x3f78bf7f3f80bf7b,0x3f71bf753f78bf7b,0x3edbbef13f04bf0e
.quad 0x3f04bf62bedb3f6d,0x3f78be95bf713ec4,0xbf803dc93f78bec4,0x3f3ebf46bf043f6d,0x3edb3f46bf4ebec4,0x3eacbf7f3e163f6d,0x3f18bf753d493f6d,0xbe16bf623f3e3ec4
.quad 0xbf7d3e953f3ebf6d,0xbf18bef13f80bec4,0x3eac3f22bf7d3ec4,0xbf673dc93f4ebf6d,0x3f2cbf7f3f043ec4,0xbf803f223e79bf6d,0xbf783ef13eacbf6d,0xbf5c3f75bedbbec4
.quad 0x3e793ef1bf713f6d,0xbf043f75bf673ec4,0x3f3ebf7f3f5cbec4,0xbd493f22bf783f6d,0xbf713f22be16bec4,0x3edb3dc9bf183f6d,0x3e163e95bf2c3f6d,0x3f4ebef13d493ec4
.quad 0x3f4ebf753f80bf6d,0x3f7dbf623f2cbec4,0xbf673f46bf183ec4,0x3f71bf7f3f7dbf6d,0x3d493dc9be793ec4,0x3f2cbf463f5cbf6d,0x3f5cbf623f67bf6d,0x3e79be953eacbec4
.quad 0x3f2cbf46bf183f55,0x3f80bdc9bf7d3e48,0xbf4ebef13f713e48,0x3f7dbe95bf673f0e,0xbf043f753d49bf7b,0x3f78bef1bf3e3f55,0x3f673dc9bf783f0e,0x3f71bf22bf043f7b
.quad 0x3eacbf7f3f043f0e,0x3f67bf46be793f7b,0xbf783e953f2cbf7b,0x3f5cbf623d493f55,0xbe163f62bf673e48,0x3f4ebf753eac3f0e,0x3f80bf22be163f55,0x3f3ebf7f3f183e48
.quad 0xbd49bf223f7dbf55,0x3f2cbf7f3f4ebe48,0xbf7d3f62bedbbe48,0x3f18bf753f71bf0e,0x3e793e95bf3e3f7b,0x3f04bf623f80bf55,0x3f71bf7f3f5cbf0e,0x3edbbf463f78bf7b
.quad 0xbedb3dc93e79bf0e,0x3eacbf223f5cbf7b,0xbf5c3f75bf803f7b,0x3e79bef13f2cbf55,0x3f18bef13eacbe48,0x3e16be953edbbf0e,0x3f3ebf463f4ebf55,0x3d49bdc93e16be48
.quad 0x3f7fb10f3f800000,0x3f7d3aac3f7ec46d,0x3f7fd3973f800000,0x3f7e70b03f7f4e6d,0x3f7fec433f800000,0x3f7f4e6d3f7fb10f,0x3f7ffb113f800000,0x3f7fd3973f7fec43
.quad 0x3f8000003f800000,0x3f8000003f800000,0x3f7ffb113f800000,0x3f7fd3973f7fec43,0x3f7fec433f800000,0x3f7f4e6d3f7fb10f,0x3f7fd3973f800000,0x3f7e70b03f7f4e6d
.quad 0x3f7fb10f3f800000,0x3f7d3aac3f7ec46d,0x3f7fd3973f800000,0x3f7e70b03f7f4e6d,0x3f7fec433f800000,0x3f7f4e6d3f7fb10f,0x3f7ffb113f800000,0x3f7fd3973f7fec43
.quad 0x3f8000003f800000,0x3f8000003f800000,0x3f7ffb113f800000,0x3f7fd3973f7fec43,0x3f7fec433f800000,0x3f7f4e6d3f7fb10f,0x3f7fd3973f800000,0x3f7e70b03f7f4e6d
.quad 0x3f7853f83f7b14be,0x3f7109083f74fa0b,0x3f7baccd3f7d3aac,0x3f778bc53f79c79d,0x3f7e13243f7ec46d,0x3f7c3b283f7d3aac,0x3f7f84ab3f7fb10f,0x3f7f0e583f7f4e6d
.quad 0x3f8000003f800000,0x3f8000003f800000,0x3f7f84ab3f7fb10f,0x3f7f0e583f7f4e6d,0x3f7e13243f7ec46d,0x3f7c3b283f7d3aac,0x3f7baccd3f7d3aac,0x3f778bc53f79c79d
.quad 0x3f7853f83f7b14be,0x3f7109083f74fa0b,0x3f7baccd3f7d3aac,0x3f778bc53f79c79d,0x3f7e13243f7ec46d,0x3f7c3b283f7d3aac,0x3f7f84ab3f7fb10f,0x3f7f0e583f7f4e6d
.quad 0x3f8000003f800000,0x3f8000003f800000,0x3f7f84ab3f7fb10f,0x3f7f0e583f7f4e6d,0x3f7e13243f7ec46d,0x3f7c3b283f7d3aac,0x3f7baccd3f7d3aac,0x3f778bc53f79c79d
.quad 0x3f676bd83f6c835e,0x3f5b941a3f61c598,0x3f7213523f74fa0b,0x3f6b4b0c3f6ed89e,0x3f79c79d3f7b14be,0x3f76ba073f7853f8,0x3f7e70b03f7ec46d,0x3f7dabcc3f7e1324
.quad 0x3f8000003f800000,0x3f8000003f800000,0x3f7e70b03f7ec46d,0x3f7dabcc3f7e1324,0x3f79c79d3f7b14be,0x3f76ba073f7853f8,0x3f7213523f74fa0b,0x3f6b4b0c3f6ed89e
.quad 0x3f676bd83f6c835e,0x3f5b941a3f61c598,0x3f7213523f74fa0b,0x3f6b4b0c3f6ed89e,0x3f79c79d3f7b14be,0x3f76ba073f7853f8,0x3f7e70b03f7ec46d,0x3f7dabcc3f7e1324
.quad 0x3f8000003f800000,0x3f8000003f800000,0x3f7e70b03f7ec46d,0x3f7dabcc3f7e1324,0x3f79c79d3f7b14be,0x3f76ba073f7853f8,0x3f7213523f74fa0b,0x3f6b4b0c3f6ed89e
.quad 0x3f4d9f023f54db31,0x3f3daef93f45e403,0x3f633c5a3f676bd8,0x3f59f26a3f5ebe05,0x3f7314473f74fa0b,0x3f6ed89e3f710908,0x3f7cbfc93f7d3aac,0x3f7baccd3f7c3b28
.quad 0x3f8000003f800000,0x3f8000003f800000,0x3f7cbfc93f7d3aac,0x3f7baccd3f7c3b28,0x3f7314473f74fa0b,0x3f6ed89e3f710908,0x3f633c5a3f676bd8,0x3f59f26a3f5ebe05
.quad 0x3f4d9f023f54db31,0x3f3daef93f45e403,0x3f633c5a3f676bd8,0x3f59f26a3f5ebe05,0x3f7314473f74fa0b,0x3f6ed89e3f710908,0x3f7cbfc93f7d3aac,0x3f7baccd3f7c3b28
.quad 0x3f8000003f800000,0x3f8000003f800000,0x3f7cbfc93f7d3aac,0x3f7baccd3f7c3b28,0x3f7314473f74fa0b,0x3f6ed89e3f710908,0x3f633c5a3f676bd8,0x3f59f26a3f5ebe05
.quad 0x3f2beb4a3f3504f3,0x3f187fc03f226799,0x3f4f7a1f3f54db31,0x3f43e2003f49d112,0x3f6a09a73f6c835e,0x3f64aa593f676bd8,0x3f7a73023f7b14be,0x3f7912983f79c79d
.quad 0x3f8000003f800000,0x3f8000003f800000,0x3f7a73023f7b14be,0x3f7912983f79c79d,0x3f6a09a73f6c835e,0x3f64aa593f676bd8,0x3f4f7a1f3f54db31,0x3f43e2003f49d112
.quad 0x3f2beb4a3f3504f3,0x3f187fc03f226799,0x3f4f7a1f3f54db31,0x3f43e2003f49d112,0x3f6a09a73f6c835e,0x3f64aa593f676bd8,0x3f7a73023f7b14be,0x3f7912983f79c79d
.quad 0x3f8000003f800000,0x3f8000003f800000,0x3f7a73023f7b14be,0x3f7912983f79c79d,0x3f6a09a73f6c835e,0x3f64aa593f676bd8,0x3f4f7a1f3f54db31,0x3f43e2003f49d112
.quad 0x3f039c3d3f0e39da,0x3edae8803ef15aea,0x3f373a233f3daef9,0x3f2994153f3085bb,0x3f5ebe053f61c598,0x3f5848533f5b941a,0x3f778bc53f7853f8,0x3f75dec63f76ba07
.quad 0x3f8000003f800000,0x3f8000003f800000,0x3f778bc53f7853f8,0x3f75dec63f76ba07,0x3f5ebe053f61c598,0x3f5848533f5b941a,0x3f373a233f3daef9,0x3f2994153f3085bb
.quad 0x3f039c3d3f0e39da,0x3edae8803ef15aea,0x3f373a233f3daef9,0x3f2994153f3085bb,0x3f5ebe053f61c598,0x3f5848533f5b941a,0x3f778bc53f7853f8,0x3f75dec63f76ba07
.quad 0x3f8000003f800000,0x3f8000003f800000,0x3f778bc53f7853f8,0x3f75dec63f76ba07,0x3f5ebe053f61c598,0x3f5848533f5b941a,0x3f373a233f3daef9,0x3f2994153f3085bb
.quad 0x3eac7cd43ec3ef15,0x3e78cfcc3e94a031,0x3f1b02c63f226799,0x3f0b9a6b3f13682a,0x3f514d3d3f54db31,0x3f49d1123f4d9f02,0x3f740bdd3f74fa0b,0x3f7213523f731447
.quad 0x3f8000003f800000,0x3f8000003f800000,0x3f740bdd3f74fa0b,0x3f7213523f731447,0x3f514d3d3f54db31,0x3f49d1123f4d9f02,0x3f1b02c63f226799,0x3f0b9a6b3f13682a
.quad 0x3eac7cd43ec3ef15,0x3e78cfcc3e94a031,0x3f1b02c63f226799,0x3f0b9a6b3f13682a,0x3f514d3d3f54db31,0x3f49d1123f4d9f02,0x3f740bdd3f74fa0b,0x3f7213523f731447
.quad 0x3f8000003f800000,0x3f8000003f800000,0x3f740bdd3f74fa0b,0x3f7213523f731447,0x3f514d3d3f54db31,0x3f49d1123f4d9f02,0x3f1b02c63f226799,0x3f0b9a6b3f13682a
.quad 0x3e1640833e47c5c2,0x3d48fb303dc8bd36,0x3ef6e0cb3f039c3d,0x3ed536413ee63375,0x3f41d8703f45e403,0x3f3968423f3daef9,0x3f6ff5733f710908,0x3f6db2933f6ed89e
.quad 0x3f8000003f800000,0x3f8000003f800000,0x3f6ff5733f710908,0x3f6db2933f6ed89e,0x3f41d8703f45e403,0x3f3968423f3daef9,0x3ef6e0cb3f039c3d,0x3ed536413ee63375
.quad 0x3e1640833e47c5c2,0x3d48fb303dc8bd36,0x3ef6e0cb3f039c3d,0x3ed536413ee63375,0x3f41d8703f45e403,0x3f3968423f3daef9,0x3f6ff5733f710908,0x3f6db2933f6ed89e
.quad 0x3f8000003f800000,0x3f8000003f800000,0x3f6ff5733f710908,0x3f6db2933f6ed89e,0x3f41d8703f45e403,0x3f3968423f3daef9,0x3ef6e0cb3f039c3d,0x3ed536413ee63375
.quad 0xbd48fb30248d3132,0xbe164083bdc8bd36,0x3eb263ef3ec3ef15,0x3e8e9a223ea09ae5,0x3f3085bb3f3504f3,0x3f2736563f2beb4a,0x3f6b4b0c3f6c835e,0x3f68bf3c3f6a09a7
.quad 0x3f8000003f800000,0x3f8000003f800000,0x3f6b4b0c3f6c835e,0x3f68bf3c3f6a09a7,0x3f3085bb3f3504f3,0x3f2736563f2beb4a,0x3eb263ef3ec3ef15,0x3e8e9a223ea09ae5
.quad 0xbd48fb30248d3132,0xbe164083bdc8bd36,0x3eb263ef3ec3ef15,0x3e8e9a223ea09ae5,0x3f3085bb3f3504f3,0x3f2736563f2beb4a,0x3f6b4b0c3f6c835e,0x3f68bf3c3f6a09a7
.quad 0x3f8000003f800000,0x3f8000003f800000,0x3f6b4b0c3f6c835e,0x3f68bf3c3f6a09a7,0x3f3085bb3f3504f3,0x3f2736563f2beb4a,0x3eb263ef3ec3ef15,0x3e8e9a223ea09ae5
.quad 0xbe78cfccbe47c5c2,0xbeac7cd4be94a031,0x3e5415013e78cfcc,0x3e09cf863e2f10a2,0x3f1d7fd13f226799,0x3f13682a3f187fc0,0x3f660f883f676bd8,0x3f633c5a3f64aa59
.quad 0x3f8000003f800000,0x3f8000003f800000,0x3f660f883f676bd8,0x3f633c5a3f64aa59,0x3f1d7fd13f226799,0x3f13682a3f187fc0,0x3e5415013e78cfcc,0x3e09cf863e2f10a2
.quad 0xbe78cfccbe47c5c2,0xbeac7cd4be94a031,0x3e5415013e78cfcc,0x3e09cf863e2f10a2,0x3f1d7fd13f226799,0x3f13682a3f187fc0,0x3f660f883f676bd8,0x3f633c5a3f64aa59
.quad 0x3f8000003f800000,0x3f8000003f800000,0x3f660f883f676bd8,0x3f633c5a3f64aa59,0x3f1d7fd13f226799,0x3f13682a3f187fc0,0x3e5415013e78cfcc,0x3e09cf863e2f10a2
.quad 0xbedae880bec3ef15,0xbf039c3dbef15aea,0x3d7b2b743dc8bd36,0xbc490e903cc90ab0,0x3f08f59b3f0e39da,0x3efc5d273f039c3d,0x3f6046213f61c598,0x3f5d2d533f5ebe05
.quad 0x3f8000003f800000,0x3f8000003f800000,0x3f6046213f61c598,0x3f5d2d533f5ebe05,0x3f08f59b3f0e39da,0x3efc5d273f039c3d,0x3d7b2b743dc8bd36,0xbc490e903cc90ab0
.quad 0xbedae880bec3ef15,0xbf039c3dbef15aea,0x3d7b2b743dc8bd36,0xbc490e903cc90ab0,0x3f08f59b3f0e39da,0x3efc5d273f039c3d,0x3f6046213f61c598,0x3f5d2d533f5ebe05
.quad 0x3f8000003f800000,0x3f8000003f800000,0x3f6046213f61c598,0x3f5d2d533f5ebe05,0x3f08f59b3f0e39da,0x3efc5d273f039c3d,0x3d7b2b743dc8bd36,0xbc490e903cc90ab0
.quad 0xbf187fc0bf0e39da,0xbf2beb4abf226799,0xbdafb680bd48fb30,0xbe22abb6bdfab273,0x3ee633753ef15aea,0x3ecf7bca3edae880,0x3f59f26a3f5b941a,0x3f5695e53f584853
.quad 0x3f8000003f800000,0x3f8000003f800000,0x3f59f26a3f5b941a,0x3f5695e53f584853,0x3ee633753ef15aea,0x3ecf7bca3edae880,0xbdafb680bd48fb30,0xbe22abb6bdfab273
.quad 0xbf187fc0bf0e39da,0xbf2beb4abf226799,0xbdafb680bd48fb30,0xbe22abb6bdfab273,0x3ee633753ef15aea,0x3ecf7bca3edae880,0x3f59f26a3f5b941a,0x3f5695e53f584853
.quad 0x3f8000003f800000,0x3f8000003f800000,0x3f59f26a3f5b941a,0x3f5695e53f584853,0x3ee633753ef15aea,0x3ecf7bca3edae880,0xbdafb680bd48fb30,0xbe22abb6bdfab273
.quad 0xbf3daef9bf3504f3,0xbf4d9f02bf45e403,0xbe6c9a7fbe47c5c2,0xbe9aa086be888e93,0x3eb8442a3ec3ef15,0x3ea09ae53eac7cd4,0x3f5318493f54db31,0x3f4f7a1f3f514d3d
.quad 0x3f8000003f800000,0x3f8000003f800000,0x3f5318493f54db31,0x3f4f7a1f3f514d3d,0x3eb8442a3ec3ef15,0x3ea09ae53eac7cd4,0xbe6c9a7fbe47c5c2,0xbe9aa086be888e93
.quad 0xbf3daef9bf3504f3,0xbf4d9f02bf45e403,0xbe6c9a7fbe47c5c2,0xbe9aa086be888e93,0x3eb8442a3ec3ef15,0x3ea09ae53eac7cd4,0x3f5318493f54db31,0x3f4f7a1f3f514d3d
.quad 0x3f8000003f800000,0x3f8000003f800000,0x3f5318493f54db31,0x3f4f7a1f3f514d3d,0x3eb8442a3ec3ef15,0x3ea09ae53eac7cd4,0xbe6c9a7fbe47c5c2,0xbe9aa086be888e93
.quad 0xbf5b941abf54db31,0xbf676bd8bf61c598,0xbebe1d4abeac7cd4,0xbee0924fbecf7bca,0x3e888e933e94a031,0x3e605c133e78cfcc,0x3f4bbbf83f4d9f02,0x3f47de653f49d112
.quad 0x3f8000003f800000,0x3f8000003f800000,0x3f4bbbf83f4d9f02,0x3f47de653f49d112,0x3e888e933e94a031,0x3e605c133e78cfcc,0xbebe1d4abeac7cd4,0xbee0924fbecf7bca
.quad 0xbf5b941abf54db31,0xbf676bd8bf61c598,0xbebe1d4abeac7cd4,0xbee0924fbecf7bca,0x3e888e933e94a031,0x3e605c133e78cfcc,0x3f4bbbf83f4d9f02,0x3f47de653f49d112
.quad 0x3f8000003f800000,0x3f8000003f800000,0x3f4bbbf83f4d9f02,0x3f47de653f49d112,0x3e888e933e94a031,0x3e605c133e78cfcc,0xbebe1d4abeac7cd4,0xbee0924fbecf7bca
.quad 0xbf710908bf6c835e,0xbf7853f8bf74fa0b,0xbf00e7e4bef15aea,0xbf10d3cdbf08f59b,0x3e2f10a23e47c5c2,0x3dfab2733e164083,0x3f43e2003f45e403,0x3f3fc7673f41d870
.quad 0x3f8000003f800000,0x3f8000003f800000,0x3f43e2003f45e403,0x3f3fc7673f41d870,0x3e2f10a23e47c5c2,0x3dfab2733e164083,0xbf00e7e4bef15aea,0xbf10d3cdbf08f59b
.quad 0xbf710908bf6c835e,0xbf7853f8bf74fa0b,0xbf00e7e4bef15aea,0xbf10d3cdbf08f59b,0x3e2f10a23e47c5c2,0x3dfab2733e164083,0x3f43e2003f45e403,0x3f3fc7673f41d870
.quad 0x3f8000003f800000,0x3f8000003f800000,0x3f43e2003f45e403,0x3f3fc7673f41d870,0x3e2f10a23e47c5c2,0x3dfab2733e164083,0xbf00e7e4bef15aea,0xbf10d3cdbf08f59b
.quad 0xbf7d3aacbf7b14be,0xbf7fb10fbf7ec46d,0xbf1ff6cbbf187fc0,0xbf2e3bdebf273656,0x3d96a9053dc8bd36,0x3cc90ab03d48fb30,0x3f3b8f3b3f3daef9,0x3f373a233f396842
.quad 0x3f8000003f800000,0x3f8000003f800000,0x3f3b8f3b3f3daef9,0x3f373a233f396842,0x3d96a9053dc8bd36,0x3cc90ab03d48fb30,0xbf1ff6cbbf187fc0,0xbf2e3bdebf273656
.quad 0xbf7d3aacbf7b14be,0xbf7fb10fbf7ec46d,0xbf1ff6cbbf187fc0,0xbf2e3bdebf273656,0x3d96a9053dc8bd36,0x3cc90ab03d48fb30,0x3f3b8f3b3f3daef9,0x3f373a233f396842
.quad 0x3f8000003f800000,0x3f8000003f800000,0x3f3b8f3b3f3daef9,0x3f373a233f396842,0x3d96a9053dc8bd36,0x3cc90ab03d48fb30,0xbf1ff6cbbf187fc0,0xbf2e3bdebf273656
.quad 0xbd48fb3000000000,0xbe164083bdc8bd36,0xbd16c32c00000000,0xbde1bc2ebd96a905,0xbcc90ab000000000,0xbd96a905bd48fb30,0xbc490e9000000000,0xbd16c32cbcc90ab0
.quad 0x0,0x0,0x3c490e9000000000,0x3d16c32c3cc90ab0,0x3cc90ab000000000,0x3d96a9053d48fb30,0x3d16c32c00000000,0x3de1bc2e3d96a905
.quad 0xbd48fb3000000000,0xbe164083bdc8bd36,0xbd16c32c00000000,0xbde1bc2ebd96a905,0xbcc90ab000000000,0xbd96a905bd48fb30,0xbc490e9000000000,0xbd16c32cbcc90ab0
.quad 0x0,0x0,0x3c490e9000000000,0x3d16c32c3cc90ab0,0x3cc90ab000000000,0x3d96a9053d48fb30,0x3d16c32c00000000,0x3de1bc2e3d96a905
.quad 0xbe78cfccbe47c5c2,0xbeac7cd4be94a031,0xbe3b6ecfbe164083,0xbe827dc0be605c13,0xbdfab273bdc8bd36,0xbe2f10a2be164083,0xbd7b2b74bd48fb30,0xbdafb680bd96a905
.quad 0x0,0x0,0x3d7b2b743d48fb30,0x3dafb6803d96a905,0x3dfab2733dc8bd36,0x3e2f10a23e164083,0x3e3b6ecf3e164083,0x3e827dc03e605c13
.quad 0xbe78cfccbe47c5c2,0xbeac7cd4be94a031,0xbe3b6ecfbe164083,0xbe827dc0be605c13,0xbdfab273bdc8bd36,0xbe2f10a2be164083,0xbd7b2b74bd48fb30,0xbdafb680bd96a905
.quad 0x0,0x0,0x3d7b2b743d48fb30,0x3dafb6803d96a905,0x3dfab2733dc8bd36,0x3e2f10a23e164083,0x3e3b6ecf3e164083,0x3e827dc03e605c13
.quad 0xbedae880bec3ef15,0xbf039c3dbef15aea,0xbea68f12be94a031,0xbec9b953beb8442a,0xbe605c13be47c5c2,0xbe888e93be78cfcc,0xbde1bc2ebdc8bd36,0xbe09cf86bdfab273
.quad 0x0,0x0,0x3de1bc2e3dc8bd36,0x3e09cf863dfab273,0x3e605c133e47c5c2,0x3e888e933e78cfcc,0x3ea68f123e94a031,0x3ec9b9533eb8442a
.quad 0xbedae880bec3ef15,0xbf039c3dbef15aea,0xbea68f12be94a031,0xbec9b953beb8442a,0xbe605c13be47c5c2,0xbe888e93be78cfcc,0xbde1bc2ebdc8bd36,0xbe09cf86bdfab273
.quad 0x0,0x0,0x3de1bc2e3dc8bd36,0x3e09cf863dfab273,0x3e605c133e47c5c2,0x3e888e933e78cfcc,0x3ea68f123e94a031,0x3ec9b9533eb8442a
.quad 0xbf187fc0bf0e39da,0xbf2beb4abf226799,0xbeebcbbbbedae880,0xbf064b82befc5d27,0xbea09ae5be94a031,0xbeb8442abeac7cd4,0xbe22abb6be164083,0xbe3b6ecfbe2f10a2
.quad 0x0,0x0,0x3e22abb63e164083,0x3e3b6ecf3e2f10a2,0x3ea09ae53e94a031,0x3eb8442a3eac7cd4,0x3eebcbbb3edae880,0x3f064b823efc5d27
.quad 0xbf187fc0bf0e39da,0xbf2beb4abf226799,0xbeebcbbbbedae880,0xbf064b82befc5d27,0xbea09ae5be94a031,0xbeb8442abeac7cd4,0xbe22abb6be164083,0xbe3b6ecfbe2f10a2
.quad 0x0,0x0,0x3e22abb63e164083,0x3e3b6ecf3e2f10a2,0x3ea09ae53e94a031,0x3eb8442a3eac7cd4,0x3eebcbbb3edae880,0x3f064b823efc5d27
.quad 0xbf3daef9bf3504f3,0xbf4d9f02bf45e403,0xbf15f6d9bf0e39da,0xbf24d225bf1d7fd1,0xbecf7bcabec3ef15,0xbee63375bedae880,0xbe541501be47c5c2,0xbe6c9a7fbe605c13
.quad 0x0,0x0,0x3e5415013e47c5c2,0x3e6c9a7f3e605c13,0x3ecf7bca3ec3ef15,0x3ee633753edae880,0x3f15f6d93f0e39da,0x3f24d2253f1d7fd1
.quad 0xbf3daef9bf3504f3,0xbf4d9f02bf45e403,0xbf15f6d9bf0e39da,0xbf24d225bf1d7fd1,0xbecf7bcabec3ef15,0xbee63375bedae880,0xbe541501be47c5c2,0xbe6c9a7fbe605c13
.quad 0x0,0x0,0x3e5415013e47c5c2,0x3e6c9a7f3e605c13,0x3ecf7bca3ec3ef15,0x3ee633753edae880,0x3f15f6d93f0e39da,0x3f24d2253f1d7fd1
.quad 0xbf5b941abf54db31,0xbf676bd8bf61c598,0xbf32c8c9bf2beb4a,0xbf3fc767bf396842,0xbefc5d27bef15aea,0xbf08f59bbf039c3d,0xbe827dc0be78cfcc,0xbe8e9a22be888e93
.quad 0x0,0x0,0x3e827dc03e78cfcc,0x3e8e9a223e888e93,0x3efc5d273ef15aea,0x3f08f59b3f039c3d,0x3f32c8c93f2beb4a,0x3f3fc7673f396842
.quad 0xbf5b941abf54db31,0xbf676bd8bf61c598,0xbf32c8c9bf2beb4a,0xbf3fc767bf396842,0xbefc5d27bef15aea,0xbf08f59bbf039c3d,0xbe827dc0be78cfcc,0xbe8e9a22be888e93
.quad 0x0,0x0,0x3e827dc03e78cfcc,0x3e8e9a223e888e93,0x3efc5d273ef15aea,0x3f08f59b3f039c3d,0x3f32c8c93f2beb4a,0x3f3fc7673f396842
.quad 0xbf710908bf6c835e,0xbf7853f8bf74fa0b,0xbf4bbbf8bf45e403,0xbf5695e5bf514d3d,0xbf13682abf0e39da,0xbf1d7fd1bf187fc0,0xbe9aa086be94a031,0xbea68f12bea09ae5
.quad 0x0,0x0,0x3e9aa0863e94a031,0x3ea68f123ea09ae5,0x3f13682a3f0e39da,0x3f1d7fd13f187fc0,0x3f4bbbf83f45e403,0x3f5695e53f514d3d
.quad 0xbf710908bf6c835e,0xbf7853f8bf74fa0b,0xbf4bbbf8bf45e403,0xbf5695e5bf514d3d,0xbf13682abf0e39da,0xbf1d7fd1bf187fc0,0xbe9aa086be94a031,0xbea68f12bea09ae5
.quad 0x0,0x0,0x3e9aa0863e94a031,0x3ea68f123ea09ae5,0x3f13682a3f0e39da,0x3f1d7fd13f187fc0,0x3f4bbbf83f45e403,0x3f5695e53f514d3d
.quad 0xbf7d3aacbf7b14be,0xbf7fb10fbf7ec46d,0xbf604621bf5b941a,0xbf68bf3cbf64aa59,0xbf273656bf226799,0xbf3085bbbf2beb4a,0xbeb263efbeac7cd4,0xbebe1d4abeb8442a
.quad 0x0,0x0,0x3eb263ef3eac7cd4,0x3ebe1d4a3eb8442a,0x3f2736563f226799,0x3f3085bb3f2beb4a,0x3f6046213f5b941a,0x3f68bf3c3f64aa59
.quad 0xbf7d3aacbf7b14be,0xbf7fb10fbf7ec46d,0xbf604621bf5b941a,0xbf68bf3cbf64aa59,0xbf273656bf226799,0xbf3085bbbf2beb4a,0xbeb263efbeac7cd4,0xbebe1d4abeb8442a
.quad 0x0,0x0,0x3eb263ef3eac7cd4,0x3ebe1d4a3eb8442a,0x3f2736563f226799,0x3f3085bb3f2beb4a,0x3f6046213f5b941a,0x3f68bf3c3f64aa59
.quad 0xbf7fb10fbf800000,0xbf7d3aacbf7ec46d,0xbf6ff573bf6c835e,0xbf75dec6bf731447,0xbf396842bf3504f3,0xbf41d870bf3daef9,0xbec9b953bec3ef15,0xbed53641becf7bca
.quad 0x0,0x0,0x3ec9b9533ec3ef15,0x3ed536413ecf7bca,0x3f3968423f3504f3,0x3f41d8703f3daef9,0x3f6ff5733f6c835e,0x3f75dec63f731447
.quad 0xbf7fb10fbf800000,0xbf7d3aacbf7ec46d,0xbf6ff573bf6c835e,0xbf75dec6bf731447,0xbf396842bf3504f3,0xbf41d870bf3daef9,0xbec9b953bec3ef15,0xbed53641becf7bca
.quad 0x0,0x0,0x3ec9b9533ec3ef15,0x3ed536413ecf7bca,0x3f3968423f3504f3,0x3f41d8703f3daef9,0x3f6ff5733f6c835e,0x3f75dec63f731447
.quad 0xbf7853f8bf7b14be,0xbf710908bf74fa0b,0xbf7a7302bf7853f8,0xbf7dabccbf7c3b28,0xbf49d112bf45e403,0xbf514d3dbf4d9f02,0xbee0924fbedae880,0xbeebcbbbbee63375
.quad 0x0,0x0,0x3ee0924f3edae880,0x3eebcbbb3ee63375,0x3f49d1123f45e403,0x3f514d3d3f4d9f02,0x3f7a73023f7853f8,0x3f7dabcc3f7c3b28
.quad 0xbf7853f8bf7b14be,0xbf710908bf74fa0b,0xbf7a7302bf7853f8,0xbf7dabccbf7c3b28,0xbf49d112bf45e403,0xbf514d3dbf4d9f02,0xbee0924fbedae880,0xbeebcbbbbee63375
.quad 0x0,0x0,0x3ee0924f3edae880,0x3eebcbbb3ee63375,0x3f49d1123f45e403,0x3f514d3d3f4d9f02,0x3f7a73023f7853f8,0x3f7dabcc3f7c3b28
.quad 0xbf676bd8bf6c835e,0xbf5b941abf61c598,0xbf7f84abbf7ec46d,0xbf7ffb11bf7fec43,0xbf584853bf54db31,0xbf5ebe05bf5b941a,0xbef6e0cbbef15aea,0xbf00e7e4befc5d27
.quad 0x0,0x0,0x3ef6e0cb3ef15aea,0x3f00e7e43efc5d27,0x3f5848533f54db31,0x3f5ebe053f5b941a,0x3f7f84ab3f7ec46d,0x3f7ffb113f7fec43
.quad 0xbf676bd8bf6c835e,0xbf5b941abf61c598,0xbf7f84abbf7ec46d,0xbf7ffb11bf7fec43,0xbf584853bf54db31,0xbf5ebe05bf5b941a,0xbef6e0cbbef15aea,0xbf00e7e4befc5d27
.quad 0x0,0x0,0x3ef6e0cb3ef15aea,0x3f00e7e43efc5d27,0x3f5848533f54db31,0x3f5ebe053f5b941a,0x3f7f84ab3f7ec46d,0x3f7ffb113f7fec43
.quad 0xbf4d9f02bf54db31,0xbf3daef9bf45e403,0xbf7f0e58bf7fb10f,0xbf7cbfc9bf7e1324,0xbf64aa59bf61c598,0xbf6a09a7bf676bd8,0xbf064b82bf039c3d,0xbf0b9a6bbf08f59b
.quad 0x0,0x0,0x3f064b823f039c3d,0x3f0b9a6b3f08f59b,0x3f64aa593f61c598,0x3f6a09a73f676bd8,0x3f7f0e583f7fb10f,0x3f7cbfc93f7e1324
.quad 0xbf4d9f02bf54db31,0xbf3daef9bf45e403,0xbf7f0e58bf7fb10f,0xbf7cbfc9bf7e1324,0xbf64aa59bf61c598,0xbf6a09a7bf676bd8,0xbf064b82bf039c3d,0xbf0b9a6bbf08f59b
.quad 0x0,0x0,0x3f064b823f039c3d,0x3f0b9a6b3f08f59b,0x3f64aa593f61c598,0x3f6a09a73f676bd8,0x3f7f0e583f7fb10f,0x3f7cbfc93f7e1324
.quad 0xbf2beb4abf3504f3,0xbf187fc0bf226799,0xbf791298bf7b14be,0xbf740bddbf76ba07,0xbf6ed89ebf6c835e,0xbf731447bf710908,0xbf10d3cdbf0e39da,0xbf15f6d9bf13682a
.quad 0x0,0x0,0x3f10d3cd3f0e39da,0x3f15f6d93f13682a,0x3f6ed89e3f6c835e,0x3f7314473f710908,0x3f7912983f7b14be,0x3f740bdd3f76ba07
.quad 0xbf2beb4abf3504f3,0xbf187fc0bf226799,0xbf791298bf7b14be,0xbf740bddbf76ba07,0xbf6ed89ebf6c835e,0xbf731447bf710908,0xbf10d3cdbf0e39da,0xbf15f6d9bf13682a
.quad 0x0,0x0,0x3f10d3cd3f0e39da,0x3f15f6d93f13682a,0x3f6ed89e3f6c835e,0x3f7314473f710908,0x3f7912983f7b14be,0x3f740bdd3f76ba07
.quad 0xbf039c3dbf0e39da,0xbedae880bef15aea,0xbf6db293bf710908,0xbf660f88bf6a09a7,0xbf76ba07bf74fa0b,0xbf79c79dbf7853f8,0xbf1b02c6bf187fc0,0xbf1ff6cbbf1d7fd1
.quad 0x0,0x0,0x3f1b02c63f187fc0,0x3f1ff6cb3f1d7fd1,0x3f76ba073f74fa0b,0x3f79c79d3f7853f8,0x3f6db2933f710908,0x3f660f883f6a09a7
.quad 0xbf039c3dbf0e39da,0xbedae880bef15aea,0xbf6db293bf710908,0xbf660f88bf6a09a7,0xbf76ba07bf74fa0b,0xbf79c79dbf7853f8,0xbf1b02c6bf187fc0,0xbf1ff6cbbf1d7fd1
.quad 0x0,0x0,0x3f1b02c63f187fc0,0x3f1ff6cb3f1d7fd1,0x3f76ba073f74fa0b,0x3f79c79d3f7853f8,0x3f6db2933f710908,0x3f660f883f6a09a7
.quad 0xbeac7cd4bec3ef15,0xbe78cfccbe94a031,0xbf5d2d53bf61c598,0xbf531849bf584853,0xbf7c3b28bf7b14be,0xbf7e1324bf7d3aac,0xbf24d225bf226799,0xbf299415bf273656
.quad 0x0,0x0,0x3f24d2253f226799,0x3f2994153f273656,0x3f7c3b283f7b14be,0x3f7e13243f7d3aac,0x3f5d2d533f61c598,0x3f5318493f584853
.quad 0xbeac7cd4bec3ef15,0xbe78cfccbe94a031,0xbf5d2d53bf61c598,0xbf531849bf584853,0xbf7c3b28bf7b14be,0xbf7e1324bf7d3aac,0xbf24d225bf226799,0xbf299415bf273656
.quad 0x0,0x0,0x3f24d2253f226799,0x3f2994153f273656,0x3f7c3b283f7b14be,0x3f7e13243f7d3aac,0x3f5d2d533f61c598,0x3f5318493f584853
.quad 0xbe164083be47c5c2,0xbd48fb30bdc8bd36,0xbf47de65bf4d9f02,0xbf3b8f3bbf41d870,0xbf7f4e6dbf7ec46d,0xbf7fec43bf7fb10f,0xbf2e3bdebf2beb4a,0xbf32c8c9bf3085bb
.quad 0x0,0x0,0x3f2e3bde3f2beb4a,0x3f32c8c93f3085bb,0x3f7f4e6d3f7ec46d,0x3f7fec433f7fb10f,0x3f47de653f4d9f02,0x3f3b8f3b3f41d870
.quad 0xbe164083be47c5c2,0xbd48fb30bdc8bd36,0xbf47de65bf4d9f02,0xbf3b8f3bbf41d870,0xbf7f4e6dbf7ec46d,0xbf7fec43bf7fb10f,0xbf2e3bdebf2beb4a,0xbf32c8c9bf3085bb
.quad 0x0,0x0,0x3f2e3bde3f2beb4a,0x3f32c8c93f3085bb,0x3f7f4e6d3f7ec46d,0x3f7fec433f7fb10f,0x3f47de653f4d9f02,0x3f3b8f3b3f41d870
.quad 0x3f8000003f80,0x3f8000003f80,0x3ec43f6d00003f80,0x3f6d3ec43f353f35,0x3f353f3500003f80,0x3f35bf353f80248d,0x3f6d3ec400003f80,0xbec4bf6d3f35bf35
.quad 0x3f80248d00003f80,0xbf80a554250dbf80,0x3f6dbec400003f80,0xbec43f6dbf35bf35,0x3f35bf3500003f80,0x3f353f35bf80a554,0x3ec4bf6d00003f80,0x3f6dbec4bf353f35
.quad 0x250dbf8000003f80,0x25d4bf80a58d3f80,0xbec4bf6d00003f80,0xbf6dbec43f353f35,0xbf35bf3500003f80,0xbf353f353f8025b0,0xbf6dbec400003f80,0x3ec43f6d3f35bf35
.quad 0xbf80a55400003f80,0x3f80261f25d4bf80,0xbf6d3ec400003f80,0x3ec4bf6dbf35bf35,0xbf353f3500003f80,0xbf35bf35bf80a5f7,0xbec43f6d00003f80,0xbf6d3ec4bf353f35
.quad 0x3f8000003f80,0x3f8000003f80,0x3f6dbec43f80248d,0x3ec4bf6d3f35bf35,0xbf35bf35250dbf80,0xbf353f35bf80a554,0xbec43f6dbf80a554,0x3f6dbec43f353f35
.quad 0x3f8025b0a58d3f80,0xbf80a5f725d4bf80,0xbec4bf6d3f8025b0,0x3f6d3ec4bf353f35,0xbf353f3525d4bf80,0xbf35bf353f80261f,0x3f6d3ec4bf80a5f7,0x3ec43f6dbf35bf35
.quad 0x2630bf80a60d3f80,0x2677bf80a6543f80,0xbf6d3ec43f80261f,0xbec43f6d3f35bf35,0x3f353f352630bf80,0x3f35bf35bf80a742,0x3ec4bf6dbf80a731,0xbf6d3ec43f353f35
.quad 0xbf80a742a6543f80,0x3f80a60d269fbf80,0x3ec43f6d3f80a68d,0xbf6dbec4bf353f35,0x3f35bf352677bf80,0x3f353f353f80a60d,0xbf6dbec4bf80a742,0xbec4bf6dbf35bf35
.quad 0x3f8000003f80,0x3f8000003f80,0xbec4bf6d250dbf80,0xbf6dbec4bf35bf35,0x3f353f35a58d3f80,0x3f35bf353f8025b0,0xbf6dbec425d4bf80,0x3ec43f6dbf353f35
.quad 0x3f80261fa60d3f80,0xbf80a7312630bf80,0xbf6d3ec42630bf80,0x3ec4bf6d3f353f35,0x3f35bf35a6543f80,0x3f353f35bf80a742,0xbec43f6d2677bf80,0xbf6d3ec43f35bf35
.quad 0x269fbf80a68d3f80,0x27b1bf80a6b03f80,0x3ec43f6d269fbf80,0x3f6d3ec4bf35bf35,0xbf35bf35a6b03f80,0xbf353f353f80a58e,0x3f6d3ec427b1bf80,0xbec4bf6dbf353f35
.quad 0xbf80a777a6d43f80,0x3f80258d27c2bf80,0x3f6dbec4a70dbf80,0xbec43f6d3f353f35,0xbf353f35a6f73f80,0xbf35bf35bf80a78d,0x3ec4bf6d27c2bf80,0x3f6dbec43f35bf35
.quad 0x3f8000003f80,0x3f8000003f80,0xbf6d3ec4bf80a554,0xbec43f6dbf353f35,0xbf35bf3525d4bf80,0xbf353f35bf80a5f7,0x3ec4bf6d3f80261f,0xbf6d3ec4bf35bf35
.quad 0x3f80a68da6543f80,0xbf80a7422677bf80,0x3ec43f6dbf80a742,0xbf6dbec43f35bf35,0xbf353f35269fbf80,0xbf35bf353f80a60d,0xbf6dbec43f80a60d,0xbec4bf6d3f353f35
.quad 0xa70dbf80a6d43f80,0x27c2bf80a6f73f80,0x3f6dbec4bf80a777,0x3ec4bf6dbf353f35,0x3f353f3527c2bf80,0x3f35bf35bf80a78d,0xbec43f6d3f80258d,0x3f6dbec4bf35bf35
.quad 0xbf80a796a71f3f80,0x3f80268da68dbf80,0xbec4bf6dbf80a796,0x3f6d3ec43f35bf35,0x3f35bf35a68dbf80,0x3f353f353f802816,0x3f6d3ec43f80268d,0x3ec43f6d3f353f35
.quad 0x3f8080003f808000,0x3f8080003f808000,0x3f6dbec43f808000,0x3ec4bf6d3f35bf35,0x3f35bf353f808000,0xbf35bf35248dbf80,0x3ec4bf6d3f808000,0xbf6d3ec4bf35bf35
.quad 0x248dbf803f808000,0xa5543f80bf80a50d,0xbec4bf6d3f808000,0x3f6d3ec4bf353f35,0xbf35bf353f808000,0x3f35bf35a5543f80,0xbf6dbec43f808000,0xbec4bf6d3f353f35
.quad 0xbf80a50d3f808000,0xbf80a5d43f80258d,0xbf6d3ec43f808000,0xbec43f6d3f35bf35,0xbf353f353f808000,0x3f353f3525b0bf80,0xbec43f6d3f808000,0x3f6dbec4bf35bf35
.quad 0xa5543f803f808000,0x261fbf80bf80a5d4,0x3ec43f6d3f808000,0xbf6dbec4bf353f35,0x3f353f353f808000,0xbf353f35a5f73f80,0x3f6d3ec43f808000,0x3ec43f6d3f353f35
.quad 0x3f8080003f808000,0x3f8080003f808000,0xbec4bf6d248dbf80,0xbf6dbec4bf35bf35,0xbf353f35bf80a50d,0x3f353f35a5543f80,0x3f6d3ec4a5543f80,0xbec4bf6d3f35bf35
.quad 0x25b0bf803f80258d,0xa5f73f80bf80a5d4,0xbf6d3ec425b0bf80,0x3ec4bf6d3f353f35,0x3f353f35bf80a5d4,0xbf353f35261fbf80,0x3ec4bf6da5f73f80,0x3f6dbec4bf353f35
.quad 0xbf80a6303f80260d,0xbf80a6773f802654,0x3ec43f6d261fbf80,0x3f6d3ec4bf35bf35,0x3f35bf35bf80a630,0xbf35bf35a7423f80,0xbf6dbec4a7313f80,0x3ec43f6d3f35bf35
.quad 0xa7423f803f802654,0xa60dbf80bf80a69f,0x3f6dbec4a68dbf80,0xbec43f6d3f353f35,0xbf35bf35bf80a677,0x3f35bf35a60dbf80,0xbec43f6da7423f80,0xbf6d3ec4bf353f35
.quad 0x3f8080003f808000,0x3f8080003f808000,0xbf6d3ec4bf80a50d,0xbec43f6dbf353f35,0x3f35bf353f80258d,0xbf35bf3525b0bf80,0xbec43f6dbf80a5d4,0x3f6dbec43f353f35
.quad 0x261fbf803f80260d,0xa7313f80bf80a630,0x3ec43f6dbf80a630,0xbf6dbec43f35bf35,0xbf35bf353f802654,0x3f35bf35a7423f80,0x3f6d3ec4bf80a677,0x3ec43f6dbf35bf35
.quad 0xbf80a69f3f80268d,0xbf80a7b13f8026b0,0x3f6dbec4bf80a69f,0x3ec4bf6dbf353f35,0xbf353f353f8026b0,0x3f353f35a58ebf80,0x3ec4bf6dbf80a7b1,0xbf6d3ec43f353f35
.quad 0xa7773f803f8026d4,0x258dbf80bf80a7c2,0xbec4bf6dbf80270d,0x3f6d3ec43f35bf35,0x3f353f353f8026f7,0xbf353f35a78d3f80,0xbf6dbec4bf80a7c2,0xbec4bf6dbf35bf35
.quad 0x3f8080003f808000,0x3f8080003f808000,0x3ec43f6da5543f80,0x3f6d3ec43f353f35,0xbf353f35bf80a5d4,0x3f353f35a5f73f80,0xbf6dbec4261fbf80,0x3ec43f6dbf353f35
.quad 0xa68dbf803f802654,0xa7423f80bf80a677,0x3f6dbec4a7423f80,0xbec43f6dbf35bf35,0x3f353f35bf80a69f,0xbf353f35a60dbf80,0xbec43f6da60dbf80,0xbf6d3ec43f35bf35
.quad 0xbf80270d3f8026d4,0xbf80a7c23f8026f7,0xbec4bf6da7773f80,0xbf6dbec43f353f35,0x3f35bf35bf80a7c2,0xbf35bf35a78d3f80,0x3f6d3ec4258dbf80,0xbec4bf6dbf353f35
.quad 0xa7963f803f80271f,0x268dbf80bf80268d,0xbf6d3ec4a7963f80,0x3ec4bf6dbf35bf35,0xbf35bf35bf80268d,0x3f35bf352816bf80,0x3ec4bf6d268dbf80,0x3f6dbec43f35bf35
.quad 0x80003f8080003f80,0x80003f8080003f80,0xbec43f6d80003f80,0xbf6d3ec4bf353f35,0xbf353f3580003f80,0xbf35bf35bf80248d,0xbf6d3ec480003f80,0x3ec4bf6dbf35bf35
.quad 0xbf80248d80003f80,0x3f80a554a50dbf80,0xbf6dbec480003f80,0x3ec43f6d3f35bf35,0xbf35bf3580003f80,0xbf353f353f80a554,0xbec4bf6d80003f80,0xbf6dbec43f353f35
.quad 0xa50dbf8080003f80,0xa5d4bf80258d3f80,0x3ec4bf6d80003f80,0x3f6dbec4bf353f35,0x3f35bf3580003f80,0x3f353f35bf8025b0,0x3f6dbec480003f80,0xbec43f6dbf35bf35
.quad 0x3f80a55480003f80,0xbf80261fa5d4bf80,0x3f6d3ec480003f80,0xbec4bf6d3f35bf35,0x3f353f3580003f80,0x3f35bf353f80a5f7,0x3ec43f6d80003f80,0x3f6d3ec43f353f35
.quad 0x80003f8080003f80,0x80003f8080003f80,0xbf6dbec4bf80248d,0xbec4bf6dbf35bf35,0x3f35bf35a50dbf80,0x3f353f353f80a554,0x3ec43f6d3f80a554,0xbf6dbec4bf353f35
.quad 0xbf8025b0258d3f80,0x3f80a5f7a5d4bf80,0x3ec4bf6dbf8025b0,0xbf6d3ec43f353f35,0x3f353f35a5d4bf80,0x3f35bf35bf80261f,0xbf6d3ec43f80a5f7,0xbec43f6d3f35bf35
.quad 0xa630bf80260d3f80,0xa677bf8026543f80,0x3f6d3ec4bf80261f,0x3ec43f6dbf35bf35,0xbf353f35a630bf80,0xbf35bf353f80a742,0xbec4bf6d3f80a731,0x3f6d3ec4bf353f35
.quad 0x3f80a74226543f80,0xbf80a60da69fbf80,0xbec43f6dbf80a68d,0x3f6dbec43f353f35,0xbf35bf35a677bf80,0xbf353f35bf80a60d,0x3f6dbec43f80a742,0x3ec4bf6d3f35bf35
.quad 0x80003f8080003f80,0x80003f8080003f80,0x3ec4bf6da50dbf80,0x3f6dbec43f35bf35,0xbf353f35258d3f80,0xbf35bf35bf8025b0,0x3f6dbec4a5d4bf80,0xbec43f6d3f353f35
.quad 0xbf80261f260d3f80,0x3f80a731a630bf80,0x3f6d3ec4a630bf80,0xbec4bf6dbf353f35,0xbf35bf3526543f80,0xbf353f353f80a742,0x3ec43f6da677bf80,0x3f6d3ec4bf35bf35
.quad 0xa69fbf80268d3f80,0xa7b1bf8026b03f80,0xbec43f6da69fbf80,0xbf6d3ec43f35bf35,0x3f35bf3526b03f80,0x3f353f35bf80a58e,0xbf6d3ec4a7b1bf80,0x3ec4bf6d3f353f35
.quad 0x3f80a77726d43f80,0xbf80258da7c2bf80,0xbf6dbec4270dbf80,0x3ec43f6dbf353f35,0x3f353f3526f73f80,0x3f35bf353f80a78d,0xbec4bf6da7c2bf80,0xbf6dbec4bf35bf35
.quad 0x80003f8080003f80,0x80003f8080003f80,0x3f6d3ec43f80a554,0x3ec43f6d3f353f35,0x3f35bf35a5d4bf80,0x3f353f353f80a5f7,0xbec4bf6dbf80261f,0x3f6d3ec43f35bf35
.quad 0xbf80a68d26543f80,0x3f80a742a677bf80,0xbec43f6d3f80a742,0x3f6dbec4bf35bf35,0x3f353f35a69fbf80,0x3f35bf35bf80a60d,0x3f6dbec4bf80a60d,0x3ec4bf6dbf353f35
.quad 0x270dbf8026d43f80,0xa7c2bf8026f73f80,0xbf6dbec43f80a777,0xbec4bf6d3f353f35,0xbf353f35a7c2bf80,0xbf35bf353f80a78d,0x3ec43f6dbf80258d,0xbf6dbec43f35bf35
.quad 0x3f80a796271f3f80,0xbf80268d268dbf80,0x3ec4bf6d3f80a796,0xbf6d3ec4bf35bf35,0xbf35bf35268dbf80,0xbf353f35bf802816,0xbf6d3ec4bf80268d,0xbec43f6dbf353f35
.quad 0x3f8000003f800000,0x3f8000003f800000,0x3f6d3ec43f800000,0x3ec43f6d3f353f35,0x3f353f353f800000,0xbf353f35248d3f80,0x3ec43f6d3f800000,0xbf6dbec4bf353f35
.quad 0x248d3f803f800000,0xa554bf80bf80250d,0xbec43f6d3f800000,0x3f6dbec4bf35bf35,0xbf353f353f800000,0x3f353f35a554bf80,0xbf6d3ec43f800000,0xbec43f6d3f35bf35
.quad 0xbf80250d3f800000,0xbf8025d43f80a58d,0xbf6dbec43f800000,0xbec4bf6d3f353f35,0xbf35bf353f800000,0x3f35bf3525b03f80,0xbec4bf6d3f800000,0x3f6d3ec4bf353f35
.quad 0xa554bf803f800000,0x261f3f80bf8025d4,0x3ec4bf6d3f800000,0xbf6d3ec4bf35bf35,0x3f35bf353f800000,0xbf35bf35a5f7bf80,0x3f6dbec43f800000,0x3ec4bf6d3f35bf35
.quad 0x3f8000003f800000,0x3f8000003f800000,0xbec43f6d248d3f80,0xbf6d3ec4bf353f35,0xbf35bf35bf80250d,0x3f35bf35a554bf80,0x3f6dbec4a554bf80,0xbec43f6d3f353f35
.quad 0x25b03f803f80a58d,0xa5f7bf80bf8025d4,0xbf6dbec425b03f80,0x3ec43f6d3f35bf35,0x3f35bf35bf8025d4,0xbf35bf35261f3f80,0x3ec43f6da5f7bf80,0x3f6d3ec4bf35bf35
.quad 0xbf8026303f80a60d,0xbf8026773f80a654,0x3ec4bf6d261f3f80,0x3f6dbec4bf353f35,0x3f353f35bf802630,0xbf353f35a742bf80,0xbf6d3ec4a731bf80,0x3ec4bf6d3f353f35
.quad 0xa742bf803f80a654,0xa60d3f80bf80269f,0x3f6d3ec4a68d3f80,0xbec4bf6d3f35bf35,0xbf353f35bf802677,0x3f353f35a60d3f80,0xbec4bf6da742bf80,0xbf6dbec4bf35bf35
.quad 0x3f8000003f800000,0x3f8000003f800000,0xbf6dbec4bf80250d,0xbec4bf6dbf35bf35,0x3f353f353f80a58d,0xbf353f3525b03f80,0xbec4bf6dbf8025d4,0x3f6d3ec43f35bf35
.quad 0x261f3f803f80a60d,0xa731bf80bf802630,0x3ec4bf6dbf802630,0xbf6d3ec43f353f35,0xbf353f353f80a654,0x3f353f35a742bf80,0x3f6dbec4bf802677,0x3ec4bf6dbf353f35
.quad 0xbf80269f3f80a68d,0xbf8027b13f80a6b0,0x3f6d3ec4bf80269f,0x3ec43f6dbf35bf35,0xbf35bf353f80a6b0,0x3f35bf35a58e3f80,0x3ec43f6dbf8027b1,0xbf6dbec43f35bf35
.quad 0xa777bf803f80a6d4,0x258d3f80bf8027c2,0xbec43f6dbf80a70d,0x3f6dbec43f353f35,0x3f35bf353f80a6f7,0xbf35bf35a78dbf80,0xbf6d3ec4bf8027c2,0xbec43f6dbf353f35
.quad 0x3f8000003f800000,0x3f8000003f800000,0x3ec4bf6da554bf80,0x3f6dbec43f35bf35,0xbf35bf35bf8025d4,0x3f35bf35a5f7bf80,0xbf6d3ec4261f3f80,0x3ec4bf6dbf35bf35
.quad 0xa68d3f803f80a654,0xa742bf80bf802677,0x3f6d3ec4a742bf80,0xbec4bf6dbf353f35,0x3f35bf35bf80269f,0xbf35bf35a60d3f80,0xbec4bf6da60d3f80,0xbf6dbec43f353f35
.quad 0xbf80a70d3f80a6d4,0xbf8027c23f80a6f7,0xbec43f6da777bf80,0xbf6d3ec43f35bf35,0x3f353f35bf8027c2,0xbf353f35a78dbf80,0x3f6dbec4258d3f80,0xbec43f6dbf35bf35
.quad 0xa796bf803f80a71f,0x268d3f80bf80a68d,0xbf6dbec4a796bf80,0x3ec43f6dbf353f35,0xbf353f35bf80a68d,0x3f353f3528163f80,0x3ec43f6d268d3f80,0x3f6d3ec43f353f35
.quad 0x3f8000003f80,0x3f8000003f80,0x3ec43f6d00003f80,0x3f6d3ec43f353f35,0x3f353f3500003f80,0x3f35bf353f80248d,0x3f6d3ec400003f80,0xbec4bf6d3f35bf35
.quad 0x3f80248d00003f80,0xbf80a554250dbf80,0x3f6dbec400003f80,0xbec43f6dbf35bf35,0x3f35bf3500003f80,0x3f353f35bf80a554,0x3ec4bf6d00003f80,0x3f6dbec4bf353f35
.quad 0x250dbf8000003f80,0x25d4bf80a58d3f80,0xbec4bf6d00003f80,0xbf6dbec43f353f35,0xbf35bf3500003f80,0xbf353f353f8025b0,0xbf6dbec400003f80,0x3ec43f6d3f35bf35
.quad 0xbf80a55400003f80,0x3f80261f25d4bf80,0xbf6d3ec400003f80,0x3ec4bf6dbf35bf35,0xbf353f3500003f80,0xbf35bf35bf80a5f7,0xbec43f6d00003f80,0xbf6d3ec4bf353f35
.quad 0x3f8000003f80,0x3f8000003f80,0x3f6dbec43f80248d,0x3ec4bf6d3f35bf35,0xbf35bf35250dbf80,0xbf353f35bf80a554,0xbec43f6dbf80a554,0x3f6dbec43f353f35
.quad 0x3f8025b0a58d3f80,0xbf80a5f725d4bf80,0xbec4bf6d3f8025b0,0x3f6d3ec4bf353f35,0xbf353f3525d4bf80,0xbf35bf353f80261f,0x3f6d3ec4bf80a5f7,0x3ec43f6dbf35bf35
.quad 0x2630bf80a60d3f80,0x2677bf80a6543f80,0xbf6d3ec43f80261f,0xbec43f6d3f35bf35,0x3f353f352630bf80,0x3f35bf35bf80a742,0x3ec4bf6dbf80a731,0xbf6d3ec43f353f35
.quad 0xbf80a742a6543f80,0x3f80a60d269fbf80,0x3ec43f6d3f80a68d,0xbf6dbec4bf353f35,0x3f35bf352677bf80,0x3f353f353f80a60d,0xbf6dbec4bf80a742,0xbec4bf6dbf35bf35
.quad 0x3f8000003f80,0x3f8000003f80,0xbec4bf6d250dbf80,0xbf6dbec4bf35bf35,0x3f353f35a58d3f80,0x3f35bf353f8025b0,0xbf6dbec425d4bf80,0x3ec43f6dbf353f35
.quad 0x3f80261fa60d3f80,0xbf80a7312630bf80,0xbf6d3ec42630bf80,0x3ec4bf6d3f353f35,0x3f35bf35a6543f80,0x3f353f35bf80a742,0xbec43f6d2677bf80,0xbf6d3ec43f35bf35
.quad 0x269fbf80a68d3f80,0x27b1bf80a6b03f80,0x3ec43f6d269fbf80,0x3f6d3ec4bf35bf35,0xbf35bf35a6b03f80,0xbf353f353f80a58e,0x3f6d3ec427b1bf80,0xbec4bf6dbf353f35
.quad 0xbf80a777a6d43f80,0x3f80258d27c2bf80,0x3f6dbec4a70dbf80,0xbec43f6d3f353f35,0xbf353f35a6f73f80,0xbf35bf35bf80a78d,0x3ec4bf6d27c2bf80,0x3f6dbec43f35bf35
.quad 0x3f8000003f80,0x3f8000003f80,0xbf6d3ec4bf80a554,0xbec43f6dbf353f35,0xbf35bf3525d4bf80,0xbf353f35bf80a5f7,0x3ec4bf6d3f80261f,0xbf6d3ec4bf35bf35
.quad 0x3f80a68da6543f80,0xbf80a7422677bf80,0x3ec43f6dbf80a742,0xbf6dbec43f35bf35,0xbf353f35269fbf80,0xbf35bf353f80a60d,0xbf6dbec43f80a60d,0xbec4bf6d3f353f35
.quad 0xa70dbf80a6d43f80,0x27c2bf80a6f73f80,0x3f6dbec4bf80a777,0x3ec4bf6dbf353f35,0x3f353f3527c2bf80,0x3f35bf35bf80a78d,0xbec43f6d3f80258d,0x3f6dbec4bf35bf35
.quad 0xbf80a796a71f3f80,0x3f80268da68dbf80,0xbec4bf6dbf80a796,0x3f6d3ec43f35bf35,0x3f35bf35a68dbf80,0x3f353f353f802816,0x3f6d3ec43f80268d,0x3ec43f6d3f353f35
.quad 0x3f8080003f808000,0x3f8080003f808000,0x3f6dbec43f808000,0x3ec4bf6d3f35bf35,0x3f35bf353f808000,0xbf35bf35248dbf80,0x3ec4bf6d3f808000,0xbf6d3ec4bf35bf35
.quad 0x248dbf803f808000,0xa5543f80bf80a50d,0xbec4bf6d3f808000,0x3f6d3ec4bf353f35,0xbf35bf353f808000,0x3f35bf35a5543f80,0xbf6dbec43f808000,0xbec4bf6d3f353f35
.quad 0xbf80a50d3f808000,0xbf80a5d43f80258d,0xbf6d3ec43f808000,0xbec43f6d3f35bf35,0xbf353f353f808000,0x3f353f3525b0bf80,0xbec43f6d3f808000,0x3f6dbec4bf35bf35
.quad 0xa5543f803f808000,0x261fbf80bf80a5d4,0x3ec43f6d3f808000,0xbf6dbec4bf353f35,0x3f353f353f808000,0xbf353f35a5f73f80,0x3f6d3ec43f808000,0x3ec43f6d3f353f35
.quad 0x3f8080003f808000,0x3f8080003f808000,0xbec4bf6d248dbf80,0xbf6dbec4bf35bf35,0xbf353f35bf80a50d,0x3f353f35a5543f80,0x3f6d3ec4a5543f80,0xbec4bf6d3f35bf35
.quad 0x25b0bf803f80258d,0xa5f73f80bf80a5d4,0xbf6d3ec425b0bf80,0x3ec4bf6d3f353f35,0x3f353f35bf80a5d4,0xbf353f35261fbf80,0x3ec4bf6da5f73f80,0x3f6dbec4bf353f35
.quad 0xbf80a6303f80260d,0xbf80a6773f802654,0x3ec43f6d261fbf80,0x3f6d3ec4bf35bf35,0x3f35bf35bf80a630,0xbf35bf35a7423f80,0xbf6dbec4a7313f80,0x3ec43f6d3f35bf35
.quad 0xa7423f803f802654,0xa60dbf80bf80a69f,0x3f6dbec4a68dbf80,0xbec43f6d3f353f35,0xbf35bf35bf80a677,0x3f35bf35a60dbf80,0xbec43f6da7423f80,0xbf6d3ec4bf353f35
.quad 0x3f8080003f808000,0x3f8080003f808000,0xbf6d3ec4bf80a50d,0xbec43f6dbf353f35,0x3f35bf353f80258d,0xbf35bf3525b0bf80,0xbec43f6dbf80a5d4,0x3f6dbec43f353f35
.quad 0x261fbf803f80260d,0xa7313f80bf80a630,0x3ec43f6dbf80a630,0xbf6dbec43f35bf35,0xbf35bf353f802654,0x3f35bf35a7423f80,0x3f6d3ec4bf80a677,0x3ec43f6dbf35bf35
.quad 0xbf80a69f3f80268d,0xbf80a7b13f8026b0,0x3f6dbec4bf80a69f,0x3ec4bf6dbf353f35,0xbf353f353f8026b0,0x3f353f35a58ebf80,0x3ec4bf6dbf80a7b1,0xbf6d3ec43f353f35
.quad 0xa7773f803f8026d4,0x258dbf80bf80a7c2,0xbec4bf6dbf80270d,0x3f6d3ec43f35bf35,0x3f353f353f8026f7,0xbf353f35a78d3f80,0xbf6dbec4bf80a7c2,0xbec4bf6dbf35bf35
.quad 0x3f8080003f808000,0x3f8080003f808000,0x3ec43f6da5543f80,0x3f6d3ec43f353f35,0xbf353f35bf80a5d4,0x3f353f35a5f73f80,0xbf6dbec4261fbf80,0x3ec43f6dbf353f35
.quad 0xa68dbf803f802654,0xa7423f80bf80a677,0x3f6dbec4a7423f80,0xbec43f6dbf35bf35,0x3f353f35bf80a69f,0xbf353f35a60dbf80,0xbec43f6da60dbf80,0xbf6d3ec43f35bf35
.quad 0xbf80270d3f8026d4,0xbf80a7c23f8026f7,0xbec4bf6da7773f80,0xbf6dbec43f353f35,0x3f35bf35bf80a7c2,0xbf35bf35a78d3f80,0x3f6d3ec4258dbf80,0xbec4bf6dbf353f35
.quad 0xa7963f803f80271f,0x268dbf80bf80268d,0xbf6d3ec4a7963f80,0x3ec4bf6dbf35bf35,0xbf35bf35bf80268d,0x3f35bf352816bf80,0x3ec4bf6d268dbf80,0x3f6dbec43f35bf35
.quad 0x80003f8080003f80,0x80003f8080003f80,0xbec43f6d80003f80,0xbf6d3ec4bf353f35,0xbf353f3580003f80,0xbf35bf35bf80248d,0xbf6d3ec480003f80,0x3ec4bf6dbf35bf35
.quad 0xbf80248d80003f80,0x3f80a554a50dbf80,0xbf6dbec480003f80,0x3ec43f6d3f35bf35,0xbf35bf3580003f80,0xbf353f353f80a554,0xbec4bf6d80003f80,0xbf6dbec43f353f35
.quad 0xa50dbf8080003f80,0xa5d4bf80258d3f80,0x3ec4bf6d80003f80,0x3f6dbec4bf353f35,0x3f35bf3580003f80,0x3f353f35bf8025b0,0x3f6dbec480003f80,0xbec43f6dbf35bf35
.quad 0x3f80a55480003f80,0xbf80261fa5d4bf80,0x3f6d3ec480003f80,0xbec4bf6d3f35bf35,0x3f353f3580003f80,0x3f35bf353f80a5f7,0x3ec43f6d80003f80,0x3f6d3ec43f353f35
.quad 0x80003f8080003f80,0x80003f8080003f80,0xbf6dbec4bf80248d,0xbec4bf6dbf35bf35,0x3f35bf35a50dbf80,0x3f353f353f80a554,0x3ec43f6d3f80a554,0xbf6dbec4bf353f35
.quad 0xbf8025b0258d3f80,0x3f80a5f7a5d4bf80,0x3ec4bf6dbf8025b0,0xbf6d3ec43f353f35,0x3f353f35a5d4bf80,0x3f35bf35bf80261f,0xbf6d3ec43f80a5f7,0xbec43f6d3f35bf35
.quad 0xa630bf80260d3f80,0xa677bf8026543f80,0x3f6d3ec4bf80261f,0x3ec43f6dbf35bf35,0xbf353f35a630bf80,0xbf35bf353f80a742,0xbec4bf6d3f80a731,0x3f6d3ec4bf353f35
.quad 0x3f80a74226543f80,0xbf80a60da69fbf80,0xbec43f6dbf80a68d,0x3f6dbec43f353f35,0xbf35bf35a677bf80,0xbf353f35bf80a60d,0x3f6dbec43f80a742,0x3ec4bf6d3f35bf35
.quad 0x80003f8080003f80,0x80003f8080003f80,0x3ec4bf6da50dbf80,0x3f6dbec43f35bf35,0xbf353f35258d3f80,0xbf35bf35bf8025b0,0x3f6dbec4a5d4bf80,0xbec43f6d3f353f35
.quad 0xbf80261f260d3f80,0x3f80a731a630bf80,0x3f6d3ec4a630bf80,0xbec4bf6dbf353f35,0xbf35bf3526543f80,0xbf353f353f80a742,0x3ec43f6da677bf80,0x3f6d3ec4bf35bf35
.quad 0xa69fbf80268d3f80,0xa7b1bf8026b03f80,0xbec43f6da69fbf80,0xbf6d3ec43f35bf35,0x3f35bf3526b03f80,0x3f353f35bf80a58e,0xbf6d3ec4a7b1bf80,0x3ec4bf6d3f353f35
.quad 0x3f80a77726d43f80,0xbf80258da7c2bf80,0xbf6dbec4270dbf80,0x3ec43f6dbf353f35,0x3f353f3526f73f80,0x3f35bf353f80a78d,0xbec4bf6da7c2bf80,0xbf6dbec4bf35bf35
.quad 0x80003f8080003f80,0x80003f8080003f80,0x3f6d3ec43f80a554,0x3ec43f6d3f353f35,0x3f35bf35a5d4bf80,0x3f353f353f80a5f7,0xbec4bf6dbf80261f,0x3f6d3ec43f35bf35
.quad 0xbf80a68d26543f80,0x3f80a742a677bf80,0xbec43f6d3f80a742,0x3f6dbec4bf35bf35,0x3f353f35a69fbf80,0x3f35bf35bf80a60d,0x3f6dbec4bf80a60d,0x3ec4bf6dbf353f35
.quad 0x270dbf8026d43f80,0xa7c2bf8026f73f80,0xbf6dbec43f80a777,0xbec4bf6d3f353f35,0xbf353f35a7c2bf80,0xbf35bf353f80a78d,0x3ec43f6dbf80258d,0xbf6dbec43f35bf35
.quad 0x3f80a796271f3f80,0xbf80268d268dbf80,0x3ec4bf6d3f80a796,0xbf6d3ec4bf35bf35,0xbf35bf35268dbf80,0xbf353f35bf802816,0xbf6d3ec4bf80268d,0xbec43f6dbf353f35
.quad 0x3f8000003f800000,0x3f8000003f800000,0x3f6d3ec43f800000,0x3ec43f6d3f353f35,0x3f353f353f800000,0xbf353f35248d3f80,0x3ec43f6d3f800000,0xbf6dbec4bf353f35
.quad 0x248d3f803f800000,0xa554bf80bf80250d,0xbec43f6d3f800000,0x3f6dbec4bf35bf35,0xbf353f353f800000,0x3f353f35a554bf80,0xbf6d3ec43f800000,0xbec43f6d3f35bf35
.quad 0xbf80250d3f800000,0xbf8025d43f80a58d,0xbf6dbec43f800000,0xbec4bf6d3f353f35,0xbf35bf353f800000,0x3f35bf3525b03f80,0xbec4bf6d3f800000,0x3f6d3ec4bf353f35
.quad 0xa554bf803f800000,0x261f3f80bf8025d4,0x3ec4bf6d3f800000,0xbf6d3ec4bf35bf35,0x3f35bf353f800000,0xbf35bf35a5f7bf80,0x3f6dbec43f800000,0x3ec4bf6d3f35bf35
.quad 0x3f8000003f800000,0x3f8000003f800000,0xbec43f6d248d3f80,0xbf6d3ec4bf353f35,0xbf35bf35bf80250d,0x3f35bf35a554bf80,0x3f6dbec4a554bf80,0xbec43f6d3f353f35
.quad 0x25b03f803f80a58d,0xa5f7bf80bf8025d4,0xbf6dbec425b03f80,0x3ec43f6d3f35bf35,0x3f35bf35bf8025d4,0xbf35bf35261f3f80,0x3ec43f6da5f7bf80,0x3f6d3ec4bf35bf35
.quad 0xbf8026303f80a60d,0xbf8026773f80a654,0x3ec4bf6d261f3f80,0x3f6dbec4bf353f35,0x3f353f35bf802630,0xbf353f35a742bf80,0xbf6d3ec4a731bf80,0x3ec4bf6d3f353f35
.quad 0xa742bf803f80a654,0xa60d3f80bf80269f,0x3f6d3ec4a68d3f80,0xbec4bf6d3f35bf35,0xbf353f35bf802677,0x3f353f35a60d3f80,0xbec4bf6da742bf80,0xbf6dbec4bf35bf35
.quad 0x3f8000003f800000,0x3f8000003f800000,0xbf6dbec4bf80250d,0xbec4bf6dbf35bf35,0x3f353f353f80a58d,0xbf353f3525b03f80,0xbec4bf6dbf8025d4,0x3f6d3ec43f35bf35
.quad 0x261f3f803f80a60d,0xa731bf80bf802630,0x3ec4bf6dbf802630,0xbf6d3ec43f353f35,0xbf353f353f80a654,0x3f353f35a742bf80,0x3f6dbec4bf802677,0x3ec4bf6dbf353f35
.quad 0xbf80269f3f80a68d,0xbf8027b13f80a6b0,0x3f6d3ec4bf80269f,0x3ec43f6dbf35bf35,0xbf35bf353f80a6b0,0x3f35bf35a58e3f80,0x3ec43f6dbf8027b1,0xbf6dbec43f35bf35
.quad 0xa777bf803f80a6d4,0x258d3f80bf8027c2,0xbec43f6dbf80a70d,0x3f6dbec43f353f35,0x3f35bf353f80a6f7,0xbf35bf35a78dbf80,0xbf6d3ec4bf8027c2,0xbec43f6dbf353f35
.quad 0x3f8000003f800000,0x3f8000003f800000,0x3ec4bf6da554bf80,0x3f6dbec43f35bf35,0xbf35bf35bf8025d4,0x3f35bf35a5f7bf80,0xbf6d3ec4261f3f80,0x3ec4bf6dbf35bf35
.quad 0xa68d3f803f80a654,0xa742bf80bf802677,0x3f6d3ec4a742bf80,0xbec4bf6dbf353f35,0x3f35bf35bf80269f,0xbf35bf35a60d3f80,0xbec4bf6da60d3f80,0xbf6dbec43f353f35
.quad 0xbf80a70d3f80a6d4,0xbf8027c23f80a6f7,0xbec43f6da777bf80,0xbf6d3ec43f35bf35,0x3f353f35bf8027c2,0xbf353f35a78dbf80,0x3f6dbec4258d3f80,0xbec43f6dbf35bf35
.quad 0xa796bf803f80a71f,0x268d3f80bf80a68d,0xbf6dbec4a796bf80,0x3ec43f6dbf353f35,0xbf353f35bf80a68d,0x3f353f3528163f80,0x3ec43f6d268d3f80,0x3f6d3ec43f353f35
.quad 0x3f8000003f800000,0x3f8000003f800000,0x3f7fec433f800000,0x3f7f4e6d3f7fb10f,0x3f7fb10f3f800000,0x3f7d3aac3f7ec46d,0x3f7f4e6d3f800000,0x3f79c79d3f7d3aac
.quad 0x3f7ec46d3f800000,0x3f74fa0b3f7b14be,0x3f7e13243f800000,0x3f6ed89e3f7853f8,0x3f7d3aac3f800000,0x3f676bd83f74fa0b,0x3f7c3b283f800000,0x3f5ebe053f710908
.quad 0x3f7b14be3f800000,0x3f54db313f6c835e,0x3f79c79d3f800000,0x3f49d1123f676bd8,0x3f7853f83f800000,0x3f3daef93f61c598,0x3f76ba073f800000,0x3f3085bb3f5b941a
.quad 0x3f74fa0b3f800000,0x3f2267993f54db31,0x3f7314473f800000,0x3f13682a3f4d9f02,0x3f7109083f800000,0x3f039c3d3f45e403,0x3f6ed89e3f800000,0x3ee633753f3daef9
.quad 0x3f8000003f800000,0x3f8000003f800000,0x3f7e13243f7ec46d,0x3f7c3b283f7d3aac,0x3f7853f83f7b14be,0x3f7109083f74fa0b,0x3f6ed89e3f74fa0b,0x3f5ebe053f676bd8
.quad 0x3f61c5983f6c835e,0x3f45e4033f54db31,0x3f514d3d3f61c598,0x3f2736563f3daef9,0x3f3daef93f54db31,0x3f039c3d3f226799,0x3f2736563f45e403,0x3eb8442a3f039c3d
.quad 0x3f0e39da3f3504f3,0x3e47c5c23ec3ef15,0x3ee633753f226799,0x3cc90ab03e78cfcc,0x3eac7cd43f0e39da,0xbe1640833dc8bd36,0x3e605c133ef15aea,0xbea09ae5bd48fb30
.quad 0x3dc8bd363ec3ef15,0xbef15aeabe47c5c2,0xbcc90ab03e94a031,0xbf1d7fd1beac7cd4,0xbe1640833e47c5c2,0xbf3daef9bef15aea,0xbe888e933dc8bd36,0xbf584853bf187fc0
.quad 0x3f8000003f800000,0x3f8000003f800000,0x3f79c79d3f7b14be,0x3f76ba073f7853f8,0x3f676bd83f6c835e,0x3f5b941a3f61c598,0x3f49d1123f54db31,0x3f3085bb3f3daef9
.quad 0x3f2267993f3504f3,0x3ef15aea3f0e39da,0x3ee633753f0e39da,0x3e605c133eac7cd4,0x3e78cfcc3ec3ef15,0xbd48fb303dc8bd36,0x3cc90ab03e47c5c2,0xbea09ae5be164083
.quad 0xbe47c5c2248d3132,0xbf0e39dabec3ef15,0xbecf7bcabe47c5c2,0xbf41d870bf187fc0,0xbf187fc0bec3ef15,0xbf676bd8bf45e403,0xbf41d870bf0e39da,0xbf7c3b28bf676bd8
.quad 0xbf61c598bf3504f3,0xbf7ec46dbf7b14be,0xbf76ba07bf54db31,0xbf6ed89ebf7fb10f,0xbf7fb10fbf6c835e,0xbf4d9f02bf74fa0b,0xbf7c3b28bf7b14be,0xbf1d7fd1bf5b941a
.quad 0x3f8000003f800000,0x3f8000003f800000,0x3f7314473f74fa0b,0x3f6ed89e3f710908,0x3f4d9f023f54db31,0x3f3daef93f45e403,0x3f13682a3f226799,0x3ee633753f039c3d
.quad 0x3e94a0313ec3ef15,0x3dc8bd363e47c5c2,0xbcc90ab03dc8bd36,0xbe888e93be164083,0xbeac7cd4be47c5c2,0xbf187fc0bef15aea,0xbf1d7fd1bef15aea,0xbf584853bf3daef9
.quad 0xbf54db31bf3504f3,0xbf7b14bebf6c835e,0xbf76ba07bf61c598,0xbf7c3b28bf7fb10f,0xbf7fb10fbf7b14be,0xbf5b941abf74fa0b,0xbf6ed89ebf7ec46d,0xbf1d7fd1bf4d9f02
.quad 0xbf45e403bf6c835e,0xbe94a031bf0e39da,0xbf08f59bbf45e403,0x3d96a905be78cfcc,0xbe78cfccbf0e39da,0x3edae8803dc8bd36,0x3d96a905be94a031,0x3f3968423edae880
.quad 0x0,0x0,0x3cc90ab000000000,0x3d96a9053d48fb30,0x3d48fb3000000000,0x3e1640833dc8bd36,0x3d96a90500000000,0x3e605c133e164083
.quad 0x3dc8bd3600000000,0x3e94a0313e47c5c2,0x3dfab27300000000,0x3eb8442a3e78cfcc,0x3e16408300000000,0x3edae8803e94a031,0x3e2f10a200000000,0x3efc5d273eac7cd4
.quad 0x3e47c5c200000000,0x3f0e39da3ec3ef15,0x3e605c1300000000,0x3f1d7fd13edae880,0x3e78cfcc00000000,0x3f2beb4a3ef15aea,0x3e888e9300000000,0x3f3968423f039c3d
.quad 0x3e94a03100000000,0x3f45e4033f0e39da,0x3ea09ae500000000,0x3f514d3d3f187fc0,0x3eac7cd400000000,0x3f5b941a3f226799,0x3eb8442a00000000,0x3f64aa593f2beb4a
.quad 0x0,0x0,0x3dfab2733dc8bd36,0x3e2f10a23e164083,0x3e78cfcc3e47c5c2,0x3eac7cd43e94a031,0x3eb8442a3e94a031,0x3efc5d273edae880
.quad 0x3ef15aea3ec3ef15,0x3f2267993f0e39da,0x3f13682a3ef15aea,0x3f41d8703f2beb4a,0x3f2beb4a3f0e39da,0x3f5b941a3f45e403,0x3f41d8703f226799,0x3f6ed89e3f5b941a
.quad 0x3f54db313f3504f3,0x3f7b14be3f6c835e,0x3f64aa593f45e403,0x3f7fec433f7853f8,0x3f7109083f54db31,0x3f7d3aac3f7ec46d,0x3f79c79d3f61c598,0x3f7314473f7fb10f
.quad 0x3f7ec46d3f6c835e,0x3f61c5983f7b14be,0x3f7fec433f74fa0b,0x3f49d1123f710908,0x3f7d3aac3f7b14be,0x3f2beb4a3f61c598,0x3f76ba073f7ec46d,0x3f08f59b3f4d9f02
.quad 0x0,0x0,0x3e605c133e47c5c2,0x3e888e933e78cfcc,0x3edae8803ec3ef15,0x3f039c3d3ef15aea,0x3f1d7fd13f0e39da,0x3f3968423f2beb4a
.quad 0x3f45e4033f3504f3,0x3f61c5983f54db31,0x3f64aa593f54db31,0x3f79c79d3f710908,0x3f7853f83f6c835e,0x3f7fb10f3f7ec46d,0x3f7fec433f7b14be,0x3f7314473f7d3aac
.quad 0x3f7b14be3f800000,0x3f54db313f6c835e,0x3f6a09a73f7b14be,0x3f2736563f4d9f02,0x3f4d9f023f6c835e,0x3edae8803f226799,0x3f2736563f54db31,0x3e2f10a23edae880
.quad 0x3ef15aea3f3504f3,0xbdc8bd363e47c5c2,0x3e888e933f0e39da,0xbeb8442abd48fb30,0x3d48fb303ec3ef15,0xbf187fc0be94a031,0xbe2f10a23e47c5c2,0xbf49d112bf039c3d
.quad 0x0,0x0,0x3ea09ae53e94a031,0x3eb8442a3eac7cd4,0x3f187fc03f0e39da,0x3f2beb4a3f226799,0x3f514d3d3f45e403,0x3f64aa593f5b941a
.quad 0x3f74fa0b3f6c835e,0x3f7ec46d3f7b14be,0x3f7fec433f7ec46d,0x3f76ba073f7d3aac,0x3f7109083f7b14be,0x3f4d9f023f61c598,0x3f49d1123f61c598,0x3f08f59b3f2beb4a
.quad 0x3f0e39da3f3504f3,0x3e47c5c23ec3ef15,0x3e888e933ef15aea,0xbe2f10a23d48fb30,0xbd48fb303e47c5c2,0xbf039c3dbe94a031,0xbeb8442abdc8bd36,0xbf49d112bf187fc0
.quad 0xbf226799bec3ef15,0xbf74fa0bbf54db31,0xbf584853bf226799,0xbf7f4e6dbf7853f8,0xbf7853f8bf54db31,0xbf676bd8bf7ec46d,0xbf7f4e6dbf74fa0b,0xbf3085bbbf676bd8
.quad 0x3600000036000000,0x3600000036000000,0x35ffec4336000000,0x35ff4e6d35ffb10f,0x35ffb10f36000000,0x35fd3aac35fec46d,0x35ff4e6d36000000,0x35f9c79d35fd3aac
.quad 0x35fec46d36000000,0x35f4fa0b35fb14be,0x35fe132436000000,0x35eed89e35f853f8,0x35fd3aac36000000,0x35e76bd835f4fa0b,0x35fc3b2836000000,0x35debe0535f10908
.quad 0x35fb14be36000000,0x35d4db3135ec835e,0x35f9c79d36000000,0x35c9d11235e76bd8,0x35f853f836000000,0x35bdaef935e1c598,0x35f6ba0736000000,0x35b085bb35db941a
.quad 0x35f4fa0b36000000,0x35a2679935d4db31,0x35f3144736000000,0x3593682a35cd9f02,0x35f1090836000000,0x35839c3d35c5e403,0x35eed89e36000000,0x3566337535bdaef9
.quad 0x3600000036000000,0x3600000036000000,0x35fe132435fec46d,0x35fc3b2835fd3aac,0x35f853f835fb14be,0x35f1090835f4fa0b,0x35eed89e35f4fa0b,0x35debe0535e76bd8
.quad 0x35e1c59835ec835e,0x35c5e40335d4db31,0x35d14d3d35e1c598,0x35a7365635bdaef9,0x35bdaef935d4db31,0x35839c3d35a26799,0x35a7365635c5e403,0x3538442a35839c3d
.quad 0x358e39da35b504f3,0x34c7c5c23543ef15,0x3566337535a26799,0x33490ab034f8cfcc,0x352c7cd4358e39da,0xb49640833448bd36,0x34e05c1335715aea,0xb5209ae5b3c8fb30
.quad 0x3448bd363543ef15,0xb5715aeab4c7c5c2,0xb3490ab03514a031,0xb59d7fd1b52c7cd4,0xb496408334c7c5c2,0xb5bdaef9b5715aea,0xb5088e933448bd36,0xb5d84853b5987fc0
.quad 0x3600000036000000,0x3600000036000000,0x35f9c79d35fb14be,0x35f6ba0735f853f8,0x35e76bd835ec835e,0x35db941a35e1c598,0x35c9d11235d4db31,0x35b085bb35bdaef9
.quad 0x35a2679935b504f3,0x35715aea358e39da,0x35663375358e39da,0x34e05c13352c7cd4,0x34f8cfcc3543ef15,0xb3c8fb303448bd36,0x33490ab034c7c5c2,0xb5209ae5b4964083
.quad 0xb4c7c5c21b0d3132,0xb58e39dab543ef15,0xb54f7bcab4c7c5c2,0xb5c1d870b5987fc0,0xb5987fc0b543ef15,0xb5e76bd8b5c5e403,0xb5c1d870b58e39da,0xb5fc3b28b5e76bd8
.quad 0xb5e1c598b5b504f3,0xb5fec46db5fb14be,0xb5f6ba07b5d4db31,0xb5eed89eb5ffb10f,0xb5ffb10fb5ec835e,0xb5cd9f02b5f4fa0b,0xb5fc3b28b5fb14be,0xb59d7fd1b5db941a
.quad 0x3600000036000000,0x3600000036000000,0x35f3144735f4fa0b,0x35eed89e35f10908,0x35cd9f0235d4db31,0x35bdaef935c5e403,0x3593682a35a26799,0x3566337535839c3d
.quad 0x3514a0313543ef15,0x3448bd3634c7c5c2,0xb3490ab03448bd36,0xb5088e93b4964083,0xb52c7cd4b4c7c5c2,0xb5987fc0b5715aea,0xb59d7fd1b5715aea,0xb5d84853b5bdaef9
.quad 0xb5d4db31b5b504f3,0xb5fb14beb5ec835e,0xb5f6ba07b5e1c598,0xb5fc3b28b5ffb10f,0xb5ffb10fb5fb14be,0xb5db941ab5f4fa0b,0xb5eed89eb5fec46d,0xb59d7fd1b5cd9f02
.quad 0xb5c5e403b5ec835e,0xb514a031b58e39da,0xb588f59bb5c5e403,0x3416a905b4f8cfcc,0xb4f8cfccb58e39da,0x355ae8803448bd36,0x3416a905b514a031,0x35b96842355ae880
.quad 0x0,0x0,0x33490ab000000000,0x3416a90533c8fb30,0x33c8fb3000000000,0x349640833448bd36,0x3416a90500000000,0x34e05c1334964083
.quad 0x3448bd3600000000,0x3514a03134c7c5c2,0x347ab27300000000,0x3538442a34f8cfcc,0x3496408300000000,0x355ae8803514a031,0x34af10a200000000,0x357c5d27352c7cd4
.quad 0x34c7c5c200000000,0x358e39da3543ef15,0x34e05c1300000000,0x359d7fd1355ae880,0x34f8cfcc00000000,0x35abeb4a35715aea,0x35088e9300000000,0x35b9684235839c3d
.quad 0x3514a03100000000,0x35c5e403358e39da,0x35209ae500000000,0x35d14d3d35987fc0,0x352c7cd400000000,0x35db941a35a26799,0x3538442a00000000,0x35e4aa5935abeb4a
.quad 0x0,0x0,0x347ab2733448bd36,0x34af10a234964083,0x34f8cfcc34c7c5c2,0x352c7cd43514a031,0x3538442a3514a031,0x357c5d27355ae880
.quad 0x35715aea3543ef15,0x35a26799358e39da,0x3593682a35715aea,0x35c1d87035abeb4a,0x35abeb4a358e39da,0x35db941a35c5e403,0x35c1d87035a26799,0x35eed89e35db941a
.quad 0x35d4db3135b504f3,0x35fb14be35ec835e,0x35e4aa5935c5e403,0x35ffec4335f853f8,0x35f1090835d4db31,0x35fd3aac35fec46d,0x35f9c79d35e1c598,0x35f3144735ffb10f
.quad 0x35fec46d35ec835e,0x35e1c59835fb14be,0x35ffec4335f4fa0b,0x35c9d11235f10908,0x35fd3aac35fb14be,0x35abeb4a35e1c598,0x35f6ba0735fec46d,0x3588f59b35cd9f02
.quad 0x0,0x0,0x34e05c1334c7c5c2,0x35088e9334f8cfcc,0x355ae8803543ef15,0x35839c3d35715aea,0x359d7fd1358e39da,0x35b9684235abeb4a
.quad 0x35c5e40335b504f3,0x35e1c59835d4db31,0x35e4aa5935d4db31,0x35f9c79d35f10908,0x35f853f835ec835e,0x35ffb10f35fec46d,0x35ffec4335fb14be,0x35f3144735fd3aac
.quad 0x35fb14be36000000,0x35d4db3135ec835e,0x35ea09a735fb14be,0x35a7365635cd9f02,0x35cd9f0235ec835e,0x355ae88035a26799,0x35a7365635d4db31,0x34af10a2355ae880
.quad 0x35715aea35b504f3,0xb448bd3634c7c5c2,0x35088e93358e39da,0xb538442ab3c8fb30,0x33c8fb303543ef15,0xb5987fc0b514a031,0xb4af10a234c7c5c2,0xb5c9d112b5839c3d
.quad 0x0,0x0,0x35209ae53514a031,0x3538442a352c7cd4,0x35987fc0358e39da,0x35abeb4a35a26799,0x35d14d3d35c5e403,0x35e4aa5935db941a
.quad 0x35f4fa0b35ec835e,0x35fec46d35fb14be,0x35ffec4335fec46d,0x35f6ba0735fd3aac,0x35f1090835fb14be,0x35cd9f0235e1c598,0x35c9d11235e1c598,0x3588f59b35abeb4a
.quad 0x358e39da35b504f3,0x34c7c5c23543ef15,0x35088e9335715aea,0xb4af10a233c8fb30,0xb3c8fb3034c7c5c2,0xb5839c3db514a031,0xb538442ab448bd36,0xb5c9d112b5987fc0
.quad 0xb5a26799b543ef15,0xb5f4fa0bb5d4db31,0xb5d84853b5a26799,0xb5ff4e6db5f853f8,0xb5f853f8b5d4db31,0xb5e76bd8b5fec46d,0xb5ff4e6db5f4fa0b,0xb5b085bbb5e76bd8
.quad 0x3d493f8000003f80,0x3e163f7d3dc93f7f,0x3edb3f6700003f80,0x3f783e793f463f22,0x3f3e3f2c00003f80,0x3f18bf4e3f7fbdc9,0x3f713eac00003f80,0xbf04bf5c3f22bf46
.quad 0x3f80bd4900003f80,0xbf7d3e16bdc9bf7f,0x3f67bedb00003f80,0xbe793f78bf46bf22,0x3f2cbf3e00003f80,0x3f4e3f18bf7f3dc9,0x3eacbf7100003f80,0x3f5cbf04bf223f46
.quad 0xbd49bf8000003f80,0xbe16bf7d3dc93f7f,0xbedbbf6700003f80,0xbf78be793f463f22,0xbf3ebf2c00003f80,0xbf183f4e3f7fbdc9,0xbf71beac00003f80,0x3f043f5c3f22bf46
.quad 0xbf803d4900003f80,0x3f7dbe16bdc9bf7f,0xbf673edb00003f80,0x3e79bf78bf46bf22,0xbf2c3f3e00003f80,0xbf4ebf18bf7f3dc9,0xbeac3f7100003f80,0xbf5c3f04bf223f46
.quad 0x3e793f783e483f7b,0x3eac3f713e953f75,0x3f4ebf183f7bbe48,0x3d49bf803ef1bf62,0xbf5cbf04be48bf7b,0xbedb3f67bf753e95,0xbe163f7dbf7b3e48,0x3f3ebf2c3f623ef1
.quad 0x3f78be793e483f7b,0xbf713eacbe95bf75,0xbf18bf4e3f7bbe48,0x3f803d49bef13f62,0xbf043f5cbe48bf7b,0xbf67bedb3f75be95,0x3f7d3e16bf7b3e48,0x3f2c3f3ebf62bef1
.quad 0xbe79bf783e483f7b,0xbeacbf713e953f75,0xbf4e3f183f7bbe48,0xbd493f803ef1bf62,0x3f5c3f04be48bf7b,0x3edbbf67bf753e95,0x3e16bf7dbf7b3e48,0xbf3e3f2c3f623ef1
.quad 0xbf783e793e483f7b,0x3f71beacbe95bf75,0x3f183f4e3f7bbe48,0xbf80bd49bef13f62,0x3f04bf5cbe48bf7b,0x3f673edb3f75be95,0xbf7dbe16bf7b3e48,0xbf2cbf3ebf62bef1
.quad 0x3edb3f673ec43f6d,0x3f043f5c3ef13f62,0xbf3ebf2cbec4bf6d,0xbf7d3e16bf75be95,0x3f713eac3ec43f6d,0x3e79bf783f62bef1,0xbf803d49bec4bf6d,0x3f4e3f18be953f75
.quad 0x3f67bedb3ec43f6d,0xbf5c3f04bef1bf62,0xbf2c3f3ebec4bf6d,0xbe16bf7d3f753e95,0x3eacbf713ec43f6d,0x3f783e79bf623ef1,0x3d493f80bec4bf6d,0xbf183f4e3e95bf75
.quad 0xbedbbf673ec43f6d,0xbf04bf5c3ef13f62,0x3f3e3f2cbec4bf6d,0x3f7dbe16bf75be95,0xbf71beac3ec43f6d,0xbe793f783f62bef1,0x3f80bd49bec4bf6d,0xbf4ebf18be953f75
.quad 0xbf673edb3ec43f6d,0x3f5cbf04bef1bf62,0x3f2cbf3ebec4bf6d,0x3e163f7d3f753e95,0xbeac3f713ec43f6d,0xbf78be79bf623ef1,0xbd49bf80bec4bf6d,0x3f18bf4e3e95bf75
.quad 0x3f183f4e3f0e3f55,0x3f2c3f3e3f223f46,0xbf043f5cbf553f0e,0x3eac3f71bdc93f7f,0xbf7dbe16bf0ebf55,0xbd493f80bf463f22,0xbe79bf783f55bf0e,0xbedb3f67bf7fbdc9
.quad 0x3f4ebf183f0e3f55,0xbf3e3f2cbf22bf46,0x3f5c3f04bf553f0e,0xbf713eac3dc9bf7f,0xbe163f7dbf0ebf55,0xbf80bd493f46bf22,0xbf783e793f55bf0e,0xbf67bedb3f7f3dc9
.quad 0xbf18bf4e3f0e3f55,0xbf2cbf3e3f223f46,0x3f04bf5cbf553f0e,0xbeacbf71bdc93f7f,0x3f7d3e16bf0ebf55,0x3d49bf80bf463f22,0x3e793f783f55bf0e,0x3edbbf67bf7fbdc9
.quad 0xbf4e3f183f0e3f55,0x3f3ebf2cbf22bf46,0xbf5cbf04bf553f0e,0x3f71beac3dc9bf7f,0x3e16bf7dbf0ebf55,0x3f803d493f46bf22,0x3f78be793f55bf0e,0x3f673edb3f7f3dc9
.quad 0x3f80bd493f808000,0x3f7dbe163f7fbdc9,0x3f67bedb3f808000,0x3e79bf783f22bf46,0x3f2cbf3e3f808000,0xbf4ebf18bdc9bf7f,0x3eacbf713f808000,0xbf5c3f04bf46bf22
.quad 0xbd49bf803f808000,0x3e163f7dbf7f3dc9,0xbedbbf673f808000,0x3f783e79bf223f46,0xbf3ebf2c3f808000,0x3f18bf4e3dc93f7f,0xbf71beac3f808000,0xbf04bf5c3f463f22
.quad 0xbf803d493f808000,0xbf7d3e163f7fbdc9,0xbf673edb3f808000,0xbe793f783f22bf46,0xbf2c3f3e3f808000,0x3f4e3f18bdc9bf7f,0xbeac3f713f808000,0x3f5cbf04bf46bf22
.quad 0x3d493f803f808000,0xbe16bf7dbf7f3dc9,0x3edb3f673f808000,0xbf78be79bf223f46,0x3f3e3f2c3f808000,0xbf183f4e3dc93f7f,0x3f713eac3f808000,0x3f043f5c3f463f22
.quad 0x3f78be793f7bbe48,0x3f71beac3f75be95,0xbf18bf4ebe48bf7b,0xbf80bd49bf62bef1,0xbf043f5cbf7b3e48,0x3f673edb3e953f75,0x3f7d3e163e483f7b,0xbf2cbf3e3ef1bf62
.quad 0xbe79bf783f7bbe48,0x3eac3f71bf753e95,0xbf4e3f18be48bf7b,0x3d49bf803f623ef1,0x3f5c3f04bf7b3e48,0xbedb3f67be95bf75,0x3e16bf7d3e483f7b,0x3f3ebf2cbef13f62
.quad 0xbf783e793f7bbe48,0xbf713eac3f75be95,0x3f183f4ebe48bf7b,0x3f803d49bf62bef1,0x3f04bf5cbf7b3e48,0xbf67bedb3e953f75,0xbf7dbe163e483f7b,0x3f2c3f3e3ef1bf62
.quad 0x3e793f783f7bbe48,0xbeacbf71bf753e95,0x3f4ebf18be48bf7b,0xbd493f803f623ef1,0xbf5cbf04bf7b3e48,0x3edbbf67be95bf75,0xbe163f7d3e483f7b,0xbf3e3f2cbef13f62
.quad 0x3f67bedb3f6dbec4,0x3f5cbf043f62bef1,0xbf2c3f3ebf6d3ec4,0x3e163f7dbe953f75,0x3eacbf713f6dbec4,0xbf78be79bef1bf62,0x3d493f80bf6d3ec4,0x3f18bf4e3f753e95
.quad 0xbedbbf673f6dbec4,0x3f043f5cbf623ef1,0x3f3e3f2cbf6d3ec4,0xbf7d3e163e95bf75,0xbf71beac3f6dbec4,0x3e79bf783ef13f62,0x3f80bd49bf6d3ec4,0x3f4e3f18bf75be95
.quad 0xbf673edb3f6dbec4,0xbf5c3f043f62bef1,0x3f2cbf3ebf6d3ec4,0xbe16bf7dbe953f75,0xbeac3f713f6dbec4,0x3f783e79bef1bf62,0xbd49bf80bf6d3ec4,0xbf183f4e3f753e95
.quad 0x3edb3f673f6dbec4,0xbf04bf5cbf623ef1,0xbf3ebf2cbf6d3ec4,0x3f7dbe163e95bf75,0x3f713eac3f6dbec4,0xbe793f783ef13f62,0xbf803d49bf6d3ec4,0xbf4ebf18bf75be95
.quad 0x3f4ebf183f55bf0e,0x3f3ebf2c3f46bf22,0x3f5c3f043f0e3f55,0x3f71beac3f7f3dc9,0xbe163f7dbf553f0e,0x3f803d493f223f46,0xbf783e79bf0ebf55,0x3f673edbbdc93f7f
.quad 0xbf18bf4e3f55bf0e,0x3f2c3f3ebf463f22,0x3f04bf5c3f0e3f55,0x3eac3f71bf7fbdc9,0x3f7d3e16bf553f0e,0xbd493f80bf22bf46,0x3e793f78bf0ebf55,0xbedb3f673dc9bf7f
.quad 0xbf4e3f183f55bf0e,0xbf3e3f2c3f46bf22,0xbf5cbf043f0e3f55,0xbf713eac3f7f3dc9,0x3e16bf7dbf553f0e,0xbf80bd493f223f46,0x3f78be79bf0ebf55,0xbf67bedbbdc93f7f
.quad 0x3f183f4e3f55bf0e,0xbf2cbf3ebf463f22,0xbf043f5c3f0e3f55,0xbeacbf71bf7fbdc9,0xbf7dbe16bf553f0e,0x3d49bf80bf22bf46,0xbe79bf78bf0ebf55,0x3edbbf673dc9bf7f
.quad 0x80003f8080003f80,0x80003f8080003f80,0xbedb3f67bd493f80,0xbf713eacbf3e3f2c,0xbf463f22bdc93f7f,0xbf22bf46bf7fbdc9,0xbf783e79be163f7d,0x3f04bf5cbf18bf4e
.quad 0xbf7bbe48be483f7b,0x3f7b3e483e48bf7b,0xbf4ebf18be793f78,0x3e163f7d3f5cbf04,0xbef1bf62be953f75,0xbf623ef13f753e95,0xbd49bf80beac3f71,0xbf3ebf2c3edb3f67
.quad 0x3ec4bf6dbec43f6d,0x3ec4bf6dbec43f6d,0x3f3ebf2cbedb3f67,0x3f803d49bf713eac,0x3f75be95bef13f62,0x3e953f75bf62bef1,0x3f7d3e16bf043f5c,0xbf4e3f18be79bf78
.quad 0x3f553f0ebf0e3f55,0xbf55bf0e3f0ebf55,0x3f043f5cbf183f4e,0x3e79bf783f7dbe16,0x3dc93f7fbf223f46,0x3f7fbdc93f463f22,0xbeac3f71bf2c3f3e,0x3edb3f673d493f80
.quad 0x80003f8080003f80,0x80003f8080003f80,0xbf67bedbbf80bd49,0xbeacbf71bf2cbf3e,0x3f46bf223dc9bf7f,0x3f223f463f7f3dc9,0x3e793f783f7d3e16,0xbf5cbf04bf4e3f18
.quad 0xbf7bbe48be483f7b,0x3f7b3e483e48bf7b,0x3f18bf4ebf78be79,0xbf7d3e163f043f5c,0x3ef13f623e95bf75,0x3f62bef1bf75be95,0xbf803d493f713eac,0xbf2c3f3e3f67bedb
.quad 0x3ec4bf6dbec43f6d,0x3ec4bf6dbec43f6d,0x3f2c3f3ebf67bedb,0xbd493f80beacbf71,0xbf753e953ef1bf62,0xbe95bf753f623ef1,0x3e16bf7d3f5c3f04,0x3f183f4ebf783e79
.quad 0x3f553f0ebf0e3f55,0xbf55bf0e3f0ebf55,0xbf5c3f04bf4ebf18,0x3f783e793e163f7d,0xbdc9bf7f3f22bf46,0xbf7f3dc9bf46bf22,0x3f713eac3f3e3f2c,0x3f67bedb3f80bd49
.quad 0x80003f8080003f80,0x80003f8080003f80,0x3edbbf673d49bf80,0x3f71beac3f3ebf2c,0xbf463f22bdc93f7f,0xbf22bf46bf7fbdc9,0x3f78be793e16bf7d,0xbf043f5c3f183f4e
.quad 0xbf7bbe48be483f7b,0x3f7b3e483e48bf7b,0x3f4e3f183e79bf78,0xbe16bf7dbf5c3f04,0xbef1bf62be953f75,0xbf623ef13f753e95,0x3d493f803eacbf71,0x3f3e3f2cbedbbf67
.quad 0x3ec4bf6dbec43f6d,0x3ec4bf6dbec43f6d,0xbf3e3f2c3edbbf67,0xbf80bd493f71beac,0x3f75be95bef13f62,0x3e953f75bf62bef1,0xbf7dbe163f04bf5c,0x3f4ebf183e793f78
.quad 0x3f553f0ebf0e3f55,0xbf55bf0e3f0ebf55,0xbf04bf5c3f18bf4e,0xbe793f78bf7d3e16,0x3dc93f7fbf223f46,0x3f7fbdc93f463f22,0x3eacbf713f2cbf3e,0xbedbbf67bd49bf80
.quad 0x80003f8080003f80,0x80003f8080003f80,0x3f673edb3f803d49,0x3eac3f713f2c3f3e,0x3f46bf223dc9bf7f,0x3f223f463f7f3dc9,0xbe79bf78bf7dbe16,0x3f5c3f043f4ebf18
.quad 0xbf7bbe48be483f7b,0x3f7b3e483e48bf7b,0xbf183f4e3f783e79,0x3f7dbe16bf04bf5c,0x3ef13f623e95bf75,0x3f62bef1bf75be95,0x3f80bd49bf71beac,0x3f2cbf3ebf673edb
.quad 0x3ec4bf6dbec43f6d,0x3ec4bf6dbec43f6d,0xbf2cbf3e3f673edb,0x3d49bf803eac3f71,0xbf753e953ef1bf62,0xbe95bf753f623ef1,0xbe163f7dbf5cbf04,0xbf18bf4e3f78be79
.quad 0x3f553f0ebf0e3f55,0xbf55bf0e3f0ebf55,0x3f5cbf043f4e3f18,0xbf78be79be16bf7d,0xbdc9bf7f3f22bf46,0xbf7f3dc9bf46bf22,0xbf71beacbf3ebf2c,0xbf673edbbf803d49
.quad 0x3f8000003f800000,0x3f8000003f800000,0x3f673edb3f803d49,0x3eac3f713f2c3f3e,0x3f223f463f7f3dc9,0xbf463f22bdc93f7f,0x3e793f783f7d3e16,0xbf5cbf04bf4e3f18
.quad 0xbe483f7b3f7b3e48,0x3e48bf7bbf7bbe48,0xbf183f4e3f783e79,0x3f7dbe16bf04bf5c,0xbf623ef13f753e95,0x3ef13f623e95bf75,0xbf803d493f713eac,0xbf2c3f3e3f67bedb
.quad 0xbf6dbec43f6d3ec4,0xbf6dbec43f6d3ec4,0xbf2cbf3e3f673edb,0x3d49bf803eac3f71,0xbe95bf753f623ef1,0x3f75be95bef13f62,0x3e16bf7d3f5c3f04,0x3f183f4ebf783e79
.quad 0x3f0ebf553f553f0e,0xbf0e3f55bf55bf0e,0x3f5cbf043f4e3f18,0xbf78be79be16bf7d,0x3f7fbdc93f463f22,0xbdc9bf7f3f22bf46,0x3f713eac3f3e3f2c,0x3f67bedb3f80bd49
.quad 0x3f8000003f800000,0x3f8000003f800000,0xbedb3f67bd493f80,0xbf713eacbf3e3f2c,0xbf22bf46bf7fbdc9,0x3f46bf223dc9bf7f,0x3f78be793e16bf7d,0xbf043f5c3f183f4e
.quad 0xbe483f7b3f7b3e48,0x3e48bf7bbf7bbe48,0xbf4ebf18be793f78,0x3e163f7d3f5cbf04,0x3f62bef1bf75be95,0xbef1bf62be953f75,0x3d493f803eacbf71,0x3f3e3f2cbedbbf67
.quad 0xbf6dbec43f6d3ec4,0xbf6dbec43f6d3ec4,0x3f3ebf2cbedb3f67,0x3f803d49bf713eac,0x3e953f75bf62bef1,0xbf753e953ef1bf62,0xbf7dbe163f04bf5c,0x3f4ebf183e793f78
.quad 0x3f0ebf553f553f0e,0xbf0e3f55bf55bf0e,0x3f043f5cbf183f4e,0x3e79bf783f7dbe16,0xbf7f3dc9bf46bf22,0x3dc93f7fbf223f46,0x3eacbf713f2cbf3e,0xbedbbf67bd49bf80
.quad 0x3f8000003f800000,0x3f8000003f800000,0xbf67bedbbf80bd49,0xbeacbf71bf2cbf3e,0x3f223f463f7f3dc9,0xbf463f22bdc93f7f,0xbe79bf78bf7dbe16,0x3f5c3f043f4ebf18
.quad 0xbe483f7b3f7b3e48,0x3e48bf7bbf7bbe48,0x3f18bf4ebf78be79,0xbf7d3e163f043f5c,0xbf623ef13f753e95,0x3ef13f623e95bf75,0x3f80bd49bf71beac,0x3f2cbf3ebf673edb
.quad 0xbf6dbec43f6d3ec4,0xbf6dbec43f6d3ec4,0x3f2c3f3ebf67bedb,0xbd493f80beacbf71,0xbe95bf753f623ef1,0x3f75be95bef13f62,0xbe163f7dbf5cbf04,0xbf18bf4e3f78be79
.quad 0x3f0ebf553f553f0e,0xbf0e3f55bf55bf0e,0xbf5c3f04bf4ebf18,0x3f783e793e163f7d,0x3f7fbdc93f463f22,0xbdc9bf7f3f22bf46,0xbf71beacbf3ebf2c,0xbf673edbbf803d49
.quad 0x3f8000003f800000,0x3f8000003f800000,0x3edbbf673d49bf80,0x3f71beac3f3ebf2c,0xbf22bf46bf7fbdc9,0x3f46bf223dc9bf7f,0xbf783e79be163f7d,0x3f04bf5cbf18bf4e
.quad 0xbe483f7b3f7b3e48,0x3e48bf7bbf7bbe48,0x3f4e3f183e79bf78,0xbe16bf7dbf5c3f04,0x3f62bef1bf75be95,0xbef1bf62be953f75,0xbd49bf80beac3f71,0xbf3ebf2c3edb3f67
.quad 0xbf6dbec43f6d3ec4,0xbf6dbec43f6d3ec4,0xbf3e3f2c3edbbf67,0xbf80bd493f71beac,0x3e953f75bf62bef1,0xbf753e953ef1bf62,0x3f7d3e16bf043f5c,0xbf4e3f18be79bf78
.quad 0x3f0ebf553f553f0e,0xbf0e3f55bf55bf0e,0xbf04bf5c3f18bf4e,0xbe793f78bf7d3e16,0xbf7f3dc9bf46bf22,0x3dc93f7fbf223f46,0xbeac3f71bf2c3f3e,0x3edb3f673d493f80
.quad 0x3f7fffb13f800000,0x3f7ffd393f7ffec4,0x3f7fe7053f800000,0x3f7f1f493f7f9c18,0x3f7fa6e33f800000,0x3f7cdf6c3f7e9bc9,0x3f7f3f543f800000,0x3f7940c03f7cfe73
.quad 0x3f7eb0693f800000,0x3f74484b3f7ac516,0x3f7dfa383f800000,0x3f6dfcf23f77f110,0x3f7d1cdd3f800000,0x3f6667713f748422,0x3f7c187a3f800000,0x3f5d924d3f708066
.quad 0x3f7aed373f800000,0x3f5389c73f6be858,0x3f799b433f800000,0x3f485bca3f66becc,0x3f7822d13f800000,0x3f3c17d93f6106f2,0x3f76841b3f800000,0x3f2ecef73f5ac450
.quad 0x3f74bf623f800000,0x3f2093933f53fac3,0x3f72d4eb3f800000,0x3f11796b3f4cae79,0x3f70c5013f800000,0x3f0195733f44e3f5,0x3f6e8ff83f800000,0x3ee1fb6a3f3ca003
.quad 0x3f7ff84a3f7ffb11,0x3f7ff0e33f7ff4e6,0x3f7d906e3f7e70b0,0x3f7b3bab3f7c7eb0,0x3f77583a3f7a7302,0x3f6f20b03f73913f,0x3f6d67a13f740bdd,0x3f5bfb343f655e0b
.quad 0x3f5fe4e93f6b4b0c,0x3f425b893f5233c6,0x3f4f04173f604621,0x3f2302d33f3a7ca4,0x3f3b06293f531849,0x3efdbabb3f1ebc12,0x3f24381a3f43e200,0x3eadf73c3eff17b2
.quad 0x3f0af1b73f32c8c9,0x3e3228d43ebb31a0,0x3edf28a93f1ff6cb,0x3b490fc63e667c66,0x3ea5129f3f0b9a6b,0xbe2bf8043da3308c,0x3e5101f13eebcbbb,0xbeab0201bd8a200a
.quad 0x3da973ba3ebe1d4a,0xbefafef7be5a3997,0xbd2351cb3e8e9a22,0xbf21cbfbbeb554ec,0xbe25c58c3e3b6ecf,0xbf4154e1bef9a02d,0xbe901c2c3dafb680,0xbf5b2c79bf1c420c
.quad 0x3f7fe7053f7fec43,0x3f7fdaaf3f7fe129,0x3f7822d13f79c79d,0x3f74484b3f764d97,0x3f644fac3f6a09a7,0x3f5703483f5df6be,0x3f4564393f514d3d,0x3f2a2a803f385216
.quad 0x3f1ce11f3f3085bb,0x3ee1fb6a3f07a136,0x3ed97cb93f08f59b,0x3e3e853e3e9d9e78,0x3e5d4b1a3eb8442a,0xbda973ba3d8a200a,0xbb490fc63e2f10a2,0xbeb0eacbbe354098
.quad 0xbe636c83bcc90ab0,0xbf1553b7bed25a09,0xbedc53c1be605c13,0xbf476085bf1ebc12,0xbf1e1e22becf7bca,0xbf6afb8cbf4ac77f,0xbf466354bf13682a,0xbf7d906ebf6aab7b
.quad 0xbf650479bf396842,0xbf7dc68cbf7c7eb0,0xbf788486bf584853,0xbf6b99fbbf7f2f9d,0xbf7ff0e3bf6ed89e,0xbf485bcabf7294f8,0xbf7aed37bf7c3b28,0xbf16999fbf577026
.quad 0x3f7fcbe23f7fd397,0x3f7fba9e3f7fc38f,0x3f6faf1b3f721352,0x3f6a5ad93f6d1c1d,0x3f4760853f4f7a1f,0x3f3592e73f3ebc1b,0x3f0af1b73f1b02c6,0x3ed0eb2a3ef41f07
.quad 0x3e80f8c03eb263ef,0x3d55880e3e1c76de,0xbd83db0a3d7b2b74,0xbe9f1cdfbe419b37,0xbebf926fbe6c9a7f,0xbf21cbfbbf0242b1,0xbf256bcbbf00e7e4,0xbf5e5aa6bf44e3f5
.quad 0xbf5a5ba0bf3b8f3b,0xbf7d1cddbf708066,0xbf7940c0bf660f88,0xbf79f35ebf7ffec4,0xbf7efcc9bf7cbfc9,0xbf554aa4bf718f57,0xbf6afb8cbf7dabcc,0xbf140c5fbf46e22a
.quad 0xbf3f41fcbf68bf3c,0xbe7bdba4bf04f484,0xbf003a06bf3fc767,0x3df475c0be4dee60,0xbe5101f1bf064b82,0x3eeff7fb3e1008b7,0x3de7fa9abe827dc0,0x3f4154e13eee9479
.quad 0x3b490fc600000000,0x3c16cb583bc90f88,0x3ce22a7a00000000,0x3da973ba3d621469,0x3d55880e00000000,0x3e1f917b3dd53db9,0x3d9cecf900000000,0x3e698bba3e1c76de
.quad 0x3dcefdb700000000,0x3e9920fe3e4dee60,0x3e00774500000000,0x3ebca7af3e7ee6e1,0x3e195be000000000,0x3edf28a93e97a117,0x3e3228d400000000,0x3f003a063eaf713a
.quad 0x3e4ada4f00000000,0x3f102dd53ec6d529,0x3e636c8300000000,0x3f1f599f3eddbe79,0x3e7bdba400000000,0x3f2da8593ef41f07,0x3e8a11f700000000,0x3f3b06293f04f484
.quad 0x3e9620d200000000,0x3f4760853f0f8784,0x3ea2188700000000,0x3f52a6493f19c200,0x3eadf73c00000000,0x3f5cc7d13f239da9,0x3eb9bb1e00000000,0x3f65b7103f2d1469
.quad 0x3c7b514b3c490e90,0x3cafea693c96c9b6,0x3e0cec4a3de1bc2e,0x3e44b0b93e28defc,0x3e8402703e541501,0x3eb6ccc33e9d9e78,0x3ebf926f3e9aa086,0x3f02ef9f3ee363fa
.quad 0x3ef840c83ec9b953,0x3f269de33f121eb0,0x3f16999f3ef6e0cb,0x3f4564393f2f61a5,0x3f2ecef73f10d3cd,0x3f5e5aa63f48d8b3,0x3f4463373f24d225,0x3f70c5013f5df6be
.quad 0x3f5703483f373a23,0x3f7c187a3f6e46be,0x3f6667713f47de65,0x3f7fffb13f796e4e,0x3f7254703f5695e5,0x3f7c5d3a3f7f2f9d,0x3f7a9c593f633c5a,0x3f714c7a3f7f6ac7
.quad 0x3f7f1f493f6db293,0x3f5f20db3f7a1e84,0x3f7fcbe23f75dec6,0x3f4663543f6f6830,0x3f7c9f8a3f7baccd,0x3f27ce613f5f8327,0x3f75a67b3f7f0e58,0x3f0448893f4ac77f
.quad 0x3ce22a7a3cc90ab0,0x3d0a342f3cfb49ba,0x3e7bdba43e605c13,0x3e9920fe3e8b9507,0x3ee79a5d3ecf7bca,0x3f0af1b73eff17b2,0x3f2302d33f13682a,0x3f3f41fc3f31a81d
.quad 0x3f4a4c873f396842,0x3f65b7103f591e6a,0x3f67c1873f584853,0x3f7b87b23f73913f,0x3f79f35e3f6ed89e,0x3f7f1f493f7f6ac7,0x3f7fffb13f7c3b28,0x3f703b373f7bf531
.quad 0x3f799b433f7fec43,0x3f4fefa83f696591,0x3f6715993f79c79d,0x3f2093933f48d8b3,0x3f4955213f6a09a7,0x3ecb2aae3f1c420c,0x3f21cbfb3f514d3d,0x3e0cec4a3ecc9b8b
.quad 0x3ee4cbfe3f3085bb,0xbe06b26e3e28defc,0x3e75c35a3f08f59b,0xbec8477cbda3308c,0x3cafea693eb8442a,0xbf1f599fbea395c5,0xbe4ada4f3e2f10a2,0xbf4f0417bf0a48ad
.quad 0x3d2351cb3d16c32c,0x3d3c6dd53d2fe007,0x3eb3dca53ea68f12,0x3ece0bea3ec1071e,0x3f2093933f15f6d9,0x3f34768f3f2ac082,0x3f5703483f4bbbf8,0x3f69b7e43f6106f2
.quad 0x3f77beb73f6ff573,0x3f7fa6e33f7cfe73,0x3f7f78083f7f84ab,0x3f73530e3f7b61fc,0x3f6d67a13f791298,0x3f4663543f5c61c7,0x3f4360513f5d2d53,0x3efdbabb3f239da9
.quad 0x3f05a02c3f2e3bde,0x3e195be03eaf713a,0x3e698bba3ee0924f,0xbe5d4b1a3bc90f88,0xbdb5f8da3e22abb6,0xbf0d9281bea986c4,0xbecb2aaebe09cf86,0xbf50d937bf212ff9
.quad 0xbf2a2a80bed53641,0xbf7822d1bf5ac450,0xbf5d924dbf299415,0xbf7e2b72bf7ac516,0xbf7a9c59bf59f26a,0xbf62241abf7d7474,0xbf7e5a38bf778bc5,0xbf27ce61bf628210
.quad 0x3600000036000000,0x3600000036000000,0x35ffe70535ffffb1,0x35ff3f5435ffa6e3,0x35ff9c1835fffec4,0x35fcfe7335fe9bc9,0x35ff1f4935fffd39,0x35f940c035fcdf6c
.quad 0x35fe70b035fffb11,0x35f40bdd35fa7302,0x35fd906e35fff84a,0x35ed67a135f7583a,0x35fc7eb035fff4e6,0x35e55e0b35f3913f,0x35fb3bab35fff0e3,0x35dbfb3435ef20b0
.quad 0x35f9c79d35ffec43,0x35d14d3d35ea09a7,0x35f822d135ffe705,0x35c5643935e44fac,0x35f64d9735ffe129,0x35b8521635ddf6be,0x35f4484b35ffdaaf,0x35aa2a8035d70348
.quad 0x35f2135235ffd397,0x359b02c635cf7a1f,0x35efaf1b35ffcbe2,0x358af1b735c76085,0x35ed1c1d35ffc38f,0x35741f0735bebc1b,0x35ea5ad935ffba9e,0x3550eb2a35b592e7
.quad 0x3600000036000000,0x3600000036000000,0x35fdfa3835feb069,0x35fc187a35fd1cdd,0x35f7f11035fac516,0x35f0806635f48422,0x35edfcf235f4484b,0x35dd924d35e66771
.quad 0x35e0462135eb4b0c,0x35c3e20035d31849,0x35cf041735dfe4e9,0x35a4381a35bb0629,0x35ba7ca435d233c6,0x357f17b2359ebc12,0x35a302d335c25b89,0x352df73c357dbabb
.quad 0x3588f59b35b085bb,0x34af10a23538442a,0x35597cb9359ce11f,0xb1c90fc634dd4b1a,0x351d9e783587a136,0xb4b54098340a200a,0x34be853e3561fb6a,0xb530eacbb42973ba
.quad 0x33fb2b74353263ef,0xb580e7e4b4ec9a7f,0xb403db0a3500f8c0,0xb5a56bcbb53f926f,0xb4c19b37349c76de,0xb5c4e3f5b58242b1,0xb51f1cdf33d5880e,0xb5de5aa6b5a1cbfb
.quad 0x3600000036000000,0x3600000036000000,0x35f99b4335faed37,0x35f6841b35f822d1,0x35e6becc35ebe858,0x35dac45035e106f2,0x35c85bca35d389c7,0x35aecef735bc17d9
.quad 0x359ff6cb35b2c8c9,0x356bcbbb358b9a6b,0x355f28a9358af1b7,0x34d101f13525129f,0x34e67c66353b31a0,0xb40a200a3423308c,0x31c90fc634b228d4,0xb52b0201b4abf804
.quad 0xb4e05c13b3490ab0,0xb593682ab54f7bca,0xb55c53c1b4e36c83,0xb5c66354b59e1e22,0xb59ebc12b5525a09,0xb5eaab7bb5cac77f,0xb5c76085b59553b7,0xb5fd906eb5eafb8c
.quad 0xb5e60f88b5bb8f3b,0xb5fdabccb5fcbfc9,0xb5f940c0b5da5ba0,0xb5eafb8cb5fefcc9,0xb5fffec4b5f08066,0xb5c6e22ab5f18f57,0xb5f9f35eb5fd1cdd,0xb5940c5fb5d54aa4
.quad 0x3600000036000000,0x3600000036000000,0x35f2d4eb35f4bf62,0x35ee8ff835f0c501,0x35ccae7935d3fac3,0x35bca00335c4e3f5,0x3591796b35a09393,0x3561fb6a35819573
.quad 0x350e9a22353e1d4a,0x342fb68034bb6ecf,0xb3a351cb342973ba,0xb5101c2cb4a5c58c,0xb53554ecb4da3997,0xb59c420cb579a02d,0xb5a1cbfbb57afef7,0xb5db2c79b5c154e1
.quad 0xb5d84853b5b96842,0xb5fc3b28b5eed89e,0xb5f88486b5e50479,0xb5faed37b5fff0e3,0xb5ff2f9db5fc7eb0,0xb5d77026b5f294f8,0xb5eb99fbb5fdc68c,0xb596999fb5c85bca
.quad 0xb5bfc767b5e8bf3c,0xb5027dc0b5864b82,0xb5803a06b5bf41fc,0x3467fa9ab4d101f1,0xb4cdee60b584f484,0x356e9479349008b7,0x347475c0b4fbdba4,0x35c154e1356ff7fb
.quad 0x0,0x0,0x33622a7a31c90fc6,0x341cecf933d5880e,0x33e2146932490f88,0x349c76de34553db9,0x342973ba3296cb58,0x34e98bba349f917b
.quad 0x3461bc2e32c90e90,0x351aa08634d41501,0x348cec4a32fb514b,0x353f926f35040270,0x34a8defc3316c9b6,0x356363fa351d9e78,0x34c4b0b9332fea69,0x3582ef9f3536ccc3
.quad 0x34e05c1333490ab0,0x3593682a354f7bca,0x34fbdba433622a7a,0x35a302d335679a5d,0x350b9507337b49ba,0x35b1a81d357f17b2,0x351920fe338a342f,0x35bf41fc358af1b7
.quad 0x35268f123396c32c,0x35cbbbf83595f6d9,0x3533dca533a351cb,0x35d7034835a09393,0x3541071e33afe007,0x35e106f235aac082,0x354e0bea33bc6dd5,0x35e9b7e435b4768f
.quad 0x0,0x0,0x34807745344efdb7,0x34b228d434995be0,0x34fee6e134cdee60,0x352f713a3517a117,0x353ca7af351920fe,0x35803a06355f28a9
.quad 0x3576e0cb3549b953,0x35a4d2253590d3cd,0x3596999f357840c8,0x35c4633735aecef7,0x35af61a535921eb0,0x35ddf6be35c8d8b3,0x35c5643935a69de3,0x35f0c50135de5aa6
.quad 0x35d8485335b96842,0x35fc3b2835eed89e,0x35e7c18735ca4c87,0x35ffffb135f9f35e,0x35f3913f35d91e6a,0x35fbf53135ff6ac7,0x35fb87b235e5b710,0x35f03b3735ff1f49
.quad 0x35ff84ab35eff573,0x35dd2d5335f91298,0x35ff780835f7beb7,0x35c3605135ed67a1,0x35fb61fc35fcfe73,0x35a39da935dc61c7,0x35f3530e35ffa6e3,0x357dbabb35c66354
.quad 0x0,0x0,0x34e36c8334cada4f,0x350a11f734fbdba4,0x355dbe793546d529,0x3584f48435741f07,0x359f599f35902dd5,0x35bb062935ada859
.quad 0x35c7de6535b73a23,0x35e33c5a35d695e5,0x35e6677135d70348,0x35fa9c5935f25470,0x35f96e4e35ee46be,0x35ff6ac735ff2f9d,0x35ffffb135fc187a,0x35f14c7a35fc5d3a
.quad 0x35f9c79d35ffec43,0x35d14d3d35ea09a7,0x35e7159935f99b43,0x35a1cbfb35c95521,0x35c8d8b335e96591,0x354c9b8b359c420c,0x35a0939335cfefa8,0x348cec4a354b2aae
.quad 0x3560924f35ae3bde,0xb489cf8634a2abb6,0x34e98bba3585a02c,0xb54b2aaeb435f8da,0x32490f88352f713a,0xb5a12ff9b52986c4,0xb4dd4b1a34995be0,0xb5d0d937b58d9281
.quad 0x0,0x0,0x35221887351620d2,0x3539bb1e352df73c,0x3599c200358f8784,0x35ad146935a39da9,0x35d2a64935c76085,0x35e5b71035dcc7d1
.quad 0x35f5dec635edb293,0x35ff0e5835fbaccd,0x35ffcbe235ff1f49,0x35f5a67b35fc9f8a,0x35ef683035fa1e84,0x35cac77f35df8327,0x35c6635435df20db,0x3584488935a7ce61
.quad 0x3588f59b35b085bb,0x34af10a23538442a,0x34f5c35a3564cbfe,0xb4cada4f332fea69,0xb423308c34a8defc,0xb58a48adb52395c5,0xb548477cb486b26e,0xb5cf0417b59f599f
.quad 0xb5a99415b5553641,0xb5f78bc5b5d9f26a,0xb5dd924db5aa2a80,0xb5fe5a38b5fa9c59,0xb5fac516b5dac450,0xb5e28210b5fd7474,0xb5fe2b72b5f822d1,0xb5a7ce61b5e2241a
.quad 0x3dc93f7f00003f80,0x3e953f753e483f7b,0x3ef13f6200003f80,0x3f7f3dc93f553f0e,0x3f463f2200003f80,0x3ef1bf623f7bbe48,0x3f753e9500003f80,0xbf22bf463f0ebf55
.quad 0x3f7fbdc900003f80,0xbf753e95be48bf7b,0x3f62bef100003f80,0xbdc93f7fbf55bf0e,0x3f22bf4600003f80,0x3f623ef1bf7b3e48,0x3e95bf7500003f80,0x3f46bf22bf0e3f55
.quad 0xbdc9bf7f00003f80,0xbe95bf753e483f7b,0xbef1bf6200003f80,0xbf7fbdc93f553f0e,0xbf46bf2200003f80,0xbef13f623f7bbe48,0xbf75be9500003f80,0x3f223f463f0ebf55
.quad 0xbf7f3dc900003f80,0x3f75be95be48bf7b,0xbf623ef100003f80,0x3dc9bf7fbf55bf0e,0xbf223f4600003f80,0xbf62bef1bf7b3e48,0xbe953f7500003f80,0xbf463f22bf0e3f55
.quad 0x3ef13f623ec43f6d,0x3f223f463f0e3f55,0x3f22bf463f6dbec4,0xbe95bf753e48bf7b,0xbf75be95bec4bf6d,0xbdc93f7fbf553f0e,0x3dc93f7fbf6d3ec4,0x3ef1bf623f7b3e48
.quad 0x3f62bef13ec43f6d,0xbf463f22bf0ebf55,0xbf46bf223f6dbec4,0x3f75be95be483f7b,0xbe953f75bec4bf6d,0xbf7fbdc93f55bf0e,0x3f7fbdc9bf6d3ec4,0x3f623ef1bf7bbe48
.quad 0xbef1bf623ec43f6d,0xbf22bf463f0e3f55,0xbf223f463f6dbec4,0x3e953f753e48bf7b,0x3f753e95bec4bf6d,0x3dc9bf7fbf553f0e,0xbdc9bf7fbf6d3ec4,0xbef13f623f7b3e48
.quad 0xbf623ef13ec43f6d,0x3f46bf22bf0ebf55,0x3f463f223f6dbec4,0xbf753e95be483f7b,0x3e95bf75bec4bf6d,0x3f7f3dc93f55bf0e,0xbf7f3dc9bf6d3ec4,0xbf62bef1bf7bbe48
.quad 0x3f463f223f353f35,0x3f623ef13f553f0e,0xbf75be95bf35bf35,0xbf463f22bf7b3e48,0x3f7fbdc93f353f35,0xbe95bf753f0ebf55,0xbf623ef1bf35bf35,0x3f7f3dc93e483f7b
.quad 0x3f22bf463f353f35,0xbef13f62bf55bf0e,0xbe953f75bf35bf35,0xbf22bf463f7bbe48,0xbdc9bf7f3f353f35,0x3f75be95bf0e3f55,0x3ef13f62bf35bf35,0xbdc93f7fbe48bf7b
.quad 0xbf46bf223f353f35,0xbf62bef13f553f0e,0x3f753e95bf35bf35,0x3f46bf22bf7b3e48,0xbf7f3dc93f353f35,0x3e953f753f0ebf55,0x3f62bef1bf35bf35,0xbf7fbdc93e483f7b
.quad 0xbf223f463f353f35,0x3ef1bf62bf55bf0e,0x3e95bf75bf35bf35,0x3f223f463f7bbe48,0x3dc93f7f3f353f35,0xbf753e95bf0e3f55,0xbef1bf62bf35bf35,0x3dc9bf7fbe48bf7b
.quad 0x3f753e953f6d3ec4,0x3f7f3dc93f7b3e48,0x3dc93f7fbec43f6d,0x3f623ef13f0e3f55,0xbf623ef1bf6dbec4,0x3f223f46be483f7b,0xbf46bf223ec4bf6d,0x3e953f75bf553f0e
.quad 0x3e95bf753f6d3ec4,0xbdc93f7fbf7bbe48,0x3f7fbdc9bec43f6d,0xbef13f62bf0ebf55,0x3ef13f62bf6dbec4,0xbf463f223e48bf7b,0xbf223f463ec4bf6d,0xbf753e953f55bf0e
.quad 0xbf75be953f6d3ec4,0xbf7fbdc93f7b3e48,0xbdc9bf7fbec43f6d,0xbf62bef13f0e3f55,0x3f62bef1bf6dbec4,0xbf22bf46be483f7b,0x3f463f223ec4bf6d,0xbe95bf75bf553f0e
.quad 0xbe953f753f6d3ec4,0x3dc9bf7fbf7bbe48,0xbf7f3dc9bec43f6d,0x3ef1bf62bf0ebf55,0xbef1bf62bf6dbec4,0x3f46bf223e48bf7b,0x3f22bf463ec4bf6d,0x3f75be953f55bf0e
.quad 0x3f7fbdc93f808000,0x3f75be953f7bbe48,0x3f62bef13f808000,0x3dc9bf7f3f0ebf55,0x3f22bf463f808000,0xbf62bef1be48bf7b,0x3e95bf753f808000,0xbf463f22bf55bf0e
.quad 0xbdc9bf7f3f808000,0x3e953f75bf7b3e48,0xbef1bf623f808000,0x3f7f3dc9bf0e3f55,0xbf46bf223f808000,0x3ef1bf623e483f7b,0xbf75be953f808000,0xbf22bf463f553f0e
.quad 0xbf7f3dc93f808000,0xbf753e953f7bbe48,0xbf623ef13f808000,0xbdc93f7f3f0ebf55,0xbf223f463f808000,0x3f623ef1be48bf7b,0xbe953f753f808000,0x3f46bf22bf55bf0e
.quad 0x3dc93f7f3f808000,0xbe95bf75bf7b3e48,0x3ef13f623f808000,0xbf7fbdc9bf0e3f55,0x3f463f223f808000,0xbef13f623e483f7b,0x3f753e953f808000,0x3f223f463f553f0e
.quad 0x3f62bef13f6dbec4,0x3f46bf223f55bf0e,0xbf46bf22bec4bf6d,0xbf753e95bf7bbe48,0xbe953f75bf6d3ec4,0x3f7f3dc93f0e3f55,0x3f7fbdc93ec43f6d,0xbf62bef13e48bf7b
.quad 0xbef1bf623f6dbec4,0x3f223f46bf553f0e,0xbf223f46bec4bf6d,0xbe95bf753f7b3e48,0x3f753e95bf6d3ec4,0xbdc93f7fbf0ebf55,0xbdc9bf7f3ec43f6d,0x3ef1bf62be483f7b
.quad 0xbf623ef13f6dbec4,0xbf463f223f55bf0e,0x3f463f22bec4bf6d,0x3f75be95bf7bbe48,0x3e95bf75bf6d3ec4,0xbf7fbdc93f0e3f55,0xbf7f3dc93ec43f6d,0x3f623ef13e48bf7b
.quad 0x3ef13f623f6dbec4,0xbf22bf46bf553f0e,0x3f22bf46bec4bf6d,0x3e953f753f7b3e48,0xbf75be95bf6d3ec4,0x3dc9bf7fbf0ebf55,0x3dc93f7f3ec43f6d,0xbef13f62be483f7b
.quad 0x3f22bf463f35bf35,0x3ef1bf623f0ebf55,0xbe953f75bf353f35,0x3f223f463e483f7b,0xbdc9bf7f3f35bf35,0xbf753e95bf55bf0e,0x3ef13f62bf353f35,0x3dc9bf7f3f7bbe48
.quad 0xbf46bf223f35bf35,0x3f623ef1bf0e3f55,0x3f753e95bf353f35,0xbf463f22be48bf7b,0xbf7f3dc93f35bf35,0xbe95bf753f553f0e,0x3f62bef1bf353f35,0x3f7f3dc9bf7b3e48
.quad 0xbf223f463f35bf35,0xbef13f623f0ebf55,0x3e95bf75bf353f35,0xbf22bf463e483f7b,0x3dc93f7f3f35bf35,0x3f75be95bf55bf0e,0xbef1bf62bf353f35,0xbdc93f7f3f7bbe48
.quad 0x3f463f223f35bf35,0xbf62bef1bf0e3f55,0xbf75be95bf353f35,0x3f46bf22be48bf7b,0x3f7fbdc93f35bf35,0x3e953f753f553f0e,0xbf623ef1bf353f35,0xbf7fbdc9bf7b3e48
.quad 0x3e95bf753ec4bf6d,0x3dc9bf7f3e48bf7b,0x3f7fbdc93f6d3ec4,0x3ef1bf623f55bf0e,0x3ef13f62bec43f6d,0x3f46bf223f7b3e48,0xbf223f46bf6dbec4,0x3f75be953f0e3f55
.quad 0xbf75be953ec4bf6d,0x3f7f3dc9be483f7b,0xbdc9bf7f3f6d3ec4,0x3f623ef1bf553f0e,0x3f62bef1bec43f6d,0x3f223f46bf7bbe48,0x3f463f22bf6dbec4,0x3e953f75bf0ebf55
.quad 0xbe953f753ec4bf6d,0xbdc93f7f3e48bf7b,0xbf7f3dc93f6d3ec4,0xbef13f623f55bf0e,0xbef1bf62bec43f6d,0xbf463f223f7b3e48,0x3f22bf46bf6dbec4,0xbf753e953f0e3f55
.quad 0x3f753e953ec4bf6d,0xbf7fbdc9be483f7b,0x3dc93f7f3f6d3ec4,0xbf62bef1bf553f0e,0xbf623ef1bec43f6d,0xbf22bf46bf7bbe48,0xbf46bf22bf6dbec4,0xbe95bf75bf0ebf55
.quad 0x80003f8080003f80,0x80003f8080003f80,0xbef13f62bdc93f7f,0xbf753e95bf463f22,0xbf553f0ebe483f7b,0xbf0ebf55bf7bbe48,0xbf7f3dc9be953f75,0x3f22bf46bef1bf62
.quad 0xbf6dbec4bec43f6d,0x3f6d3ec43ec4bf6d,0xbf22bf46bef13f62,0xbdc93f7f3f75be95,0xbe48bf7bbf0e3f55,0xbf7b3e483f553f0e,0x3e95bf75bf223f46,0xbef1bf623dc93f7f
.quad 0x3f35bf35bf353f35,0x3f35bf35bf353f35,0x3f75be95bf463f22,0x3f623ef1bf7fbdc9,0x3f7b3e48bf553f0e,0xbe483f7bbf0ebf55,0x3f463f22bf623ef1,0xbf7f3dc93e95bf75
.quad 0x3ec43f6dbf6d3ec4,0xbec4bf6d3f6dbec4,0xbdc93f7fbf753e95,0x3f46bf223f623ef1,0xbf0e3f55bf7b3e48,0x3f553f0e3e483f7b,0xbf623ef1bf7f3dc9,0xbe953f75bf223f46
.quad 0x80003f8080003f80,0x80003f8080003f80,0xbf62bef1bf7fbdc9,0xbe95bf75bf22bf46,0x3f55bf0e3e48bf7b,0x3f0e3f553f7b3e48,0x3dc93f7f3f753e95,0xbf46bf22bf623ef1
.quad 0xbf6dbec4bec43f6d,0x3f6d3ec43ec4bf6d,0x3f46bf22bf62bef1,0xbf7fbdc93e953f75,0x3e483f7b3f0ebf55,0x3f7bbe48bf55bf0e,0xbf75be953f463f22,0xbf623ef13f7fbdc9
.quad 0x3f35bf35bf353f35,0x3f35bf35bf353f35,0x3e953f75bf22bf46,0xbef13f623dc9bf7f,0xbf7bbe483f55bf0e,0x3e48bf7b3f0e3f55,0x3f22bf463ef13f62,0x3dc93f7fbf75be95
.quad 0x3ec43f6dbf6d3ec4,0xbec4bf6d3f6dbec4,0xbf7fbdc9be95bf75,0x3f223f46bef13f62,0x3f0ebf553f7bbe48,0xbf55bf0ebe48bf7b,0x3ef13f623dc93f7f,0x3f753e953f463f22
.quad 0x80003f8080003f80,0x80003f8080003f80,0x3ef1bf623dc9bf7f,0x3f75be953f46bf22,0xbf553f0ebe483f7b,0xbf0ebf55bf7bbe48,0x3f7fbdc93e95bf75,0xbf223f463ef13f62
.quad 0xbf6dbec4bec43f6d,0x3f6d3ec43ec4bf6d,0x3f223f463ef1bf62,0x3dc9bf7fbf753e95,0xbe48bf7bbf0e3f55,0xbf7b3e483f553f0e,0xbe953f753f22bf46,0x3ef13f62bdc9bf7f
.quad 0x3f35bf35bf353f35,0x3f35bf35bf353f35,0xbf753e953f46bf22,0xbf62bef13f7f3dc9,0x3f7b3e48bf553f0e,0xbe483f7bbf0ebf55,0xbf46bf223f62bef1,0x3f7fbdc9be953f75
.quad 0x3ec43f6dbf6d3ec4,0xbec4bf6d3f6dbec4,0x3dc9bf7f3f75be95,0xbf463f22bf62bef1,0xbf0e3f55bf7b3e48,0x3f553f0e3e483f7b,0x3f62bef13f7fbdc9,0x3e95bf753f22bf46
.quad 0x80003f8080003f80,0x80003f8080003f80,0x3f623ef13f7f3dc9,0x3e953f753f223f46,0x3f55bf0e3e48bf7b,0x3f0e3f553f7b3e48,0xbdc9bf7fbf75be95,0x3f463f223f62bef1
.quad 0xbf6dbec4bec43f6d,0x3f6d3ec43ec4bf6d,0xbf463f223f623ef1,0x3f7f3dc9be95bf75,0x3e483f7b3f0ebf55,0x3f7bbe48bf55bf0e,0x3f753e95bf46bf22,0x3f62bef1bf7f3dc9
.quad 0x3f35bf35bf353f35,0x3f35bf35bf353f35,0xbe95bf753f223f46,0x3ef1bf62bdc93f7f,0xbf7bbe483f55bf0e,0x3e48bf7b3f0e3f55,0xbf223f46bef1bf62,0xbdc9bf7f3f753e95
.quad 0x3ec43f6dbf6d3ec4,0xbec4bf6d3f6dbec4,0x3f7f3dc93e953f75,0xbf22bf463ef1bf62,0x3f0ebf553f7bbe48,0xbf55bf0ebe48bf7b,0xbef1bf62bdc9bf7f,0xbf75be95bf46bf22
.quad 0x3f8000003f800000,0x3f8000003f800000,0x3f623ef13f7f3dc9,0x3e953f753f223f46,0x3f0e3f553f7b3e48,0xbf553f0ebe483f7b,0x3dc93f7f3f753e95,0xbf46bf22bf623ef1
.quad 0xbec43f6d3f6d3ec4,0x3ec4bf6dbf6dbec4,0xbf463f223f623ef1,0x3f7f3dc9be95bf75,0xbf7b3e483f553f0e,0x3e483f7b3f0ebf55,0xbf75be953f463f22,0xbf623ef13f7fbdc9
.quad 0xbf35bf353f353f35,0xbf35bf353f353f35,0xbe95bf753f223f46,0x3ef1bf62bdc93f7f,0x3e48bf7b3f0e3f55,0x3f7b3e48bf553f0e,0x3f22bf463ef13f62,0x3dc93f7fbf75be95
.quad 0x3f6dbec43ec43f6d,0xbf6d3ec4bec4bf6d,0x3f7f3dc93e953f75,0xbf22bf463ef1bf62,0x3f553f0e3e483f7b,0x3f0ebf553f7bbe48,0x3ef13f623dc93f7f,0x3f753e953f463f22
.quad 0x3f8000003f800000,0x3f8000003f800000,0xbef13f62bdc93f7f,0xbf753e95bf463f22,0xbf0ebf55bf7bbe48,0x3f55bf0e3e48bf7b,0x3f7fbdc93e95bf75,0xbf223f463ef13f62
.quad 0xbec43f6d3f6d3ec4,0x3ec4bf6dbf6dbec4,0xbf22bf46bef13f62,0xbdc93f7f3f75be95,0x3f7bbe48bf55bf0e,0xbe48bf7bbf0e3f55,0xbe953f753f22bf46,0x3ef13f62bdc9bf7f
.quad 0xbf35bf353f353f35,0xbf35bf353f353f35,0x3f75be95bf463f22,0x3f623ef1bf7fbdc9,0xbe483f7bbf0ebf55,0xbf7bbe483f55bf0e,0xbf46bf223f62bef1,0x3f7fbdc9be953f75
.quad 0x3f6dbec43ec43f6d,0xbf6d3ec4bec4bf6d,0xbdc93f7fbf753e95,0x3f46bf223f623ef1,0xbf55bf0ebe48bf7b,0xbf0e3f55bf7b3e48,0x3f62bef13f7fbdc9,0x3e95bf753f22bf46
.quad 0x3f8000003f800000,0x3f8000003f800000,0xbf62bef1bf7fbdc9,0xbe95bf75bf22bf46,0x3f0e3f553f7b3e48,0xbf553f0ebe483f7b,0xbdc9bf7fbf75be95,0x3f463f223f62bef1
.quad 0xbec43f6d3f6d3ec4,0x3ec4bf6dbf6dbec4,0x3f46bf22bf62bef1,0xbf7fbdc93e953f75,0xbf7b3e483f553f0e,0x3e483f7b3f0ebf55,0x3f753e95bf46bf22,0x3f62bef1bf7f3dc9
.quad 0xbf35bf353f353f35,0xbf35bf353f353f35,0x3e953f75bf22bf46,0xbef13f623dc9bf7f,0x3e48bf7b3f0e3f55,0x3f7b3e48bf553f0e,0xbf223f46bef1bf62,0xbdc9bf7f3f753e95
.quad 0x3f6dbec43ec43f6d,0xbf6d3ec4bec4bf6d,0xbf7fbdc9be95bf75,0x3f223f46bef13f62,0x3f553f0e3e483f7b,0x3f0ebf553f7bbe48,0xbef1bf62bdc9bf7f,0xbf75be95bf46bf22
.quad 0x3f8000003f800000,0x3f8000003f800000,0x3ef1bf623dc9bf7f,0x3f75be953f46bf22,0xbf0ebf55bf7bbe48,0x3f55bf0e3e48bf7b,0xbf7f3dc9be953f75,0x3f22bf46bef1bf62
.quad 0xbec43f6d3f6d3ec4,0x3ec4bf6dbf6dbec4,0x3f223f463ef1bf62,0x3dc9bf7fbf753e95,0x3f7bbe48bf55bf0e,0xbe48bf7bbf0e3f55,0x3e95bf75bf223f46,0xbef1bf623dc93f7f
.quad 0xbf35bf353f353f35,0xbf35bf353f353f35,0xbf753e953f46bf22,0xbf62bef13f7f3dc9,0xbe483f7bbf0ebf55,0xbf7bbe483f55bf0e,0x3f463f22bf623ef1,0xbf7f3dc93e95bf75
.quad 0x3f6dbec43ec43f6d,0xbf6d3ec4bec4bf6d,0x3dc9bf7f3f75be95,0xbf463f22bf62bef1,0xbf55bf0ebe48bf7b,0xbf0e3f55bf7b3e48,0xbf623ef1bf7f3dc9,0xbe953f75bf223f46
.quad 0x3f7ffec43f800000,0x3f7ff4e63f7ffb11,0x3f7fe1293f800000,0x3f7eea9d3f7f84ab,0x3f7f9c183f800000,0x3f7c7eb03f7e70b0,0x3f7f2f9d3f800000,0x3f78b47b3f7cbfc9
.quad 0x3f7e9bc93f800000,0x3f73913f3f7a7302,0x3f7de0b13f800000,0x3f6d1c1d3f778bc5,0x3f7cfe733f800000,0x3f655e0b3f740bdd,0x3f7bf5313f800000,0x3f5c61c73f6ff573
.quad 0x3f7ac5163f800000,0x3f5233c63f6b4b0c,0x3f796e4e3f800000,0x3f46e22a3f660f88,0x3f77f1103f800000,0x3f3a7ca43f604621,0x3f764d973f800000,0x3f2d14693f59f26a
.quad 0x3f7484223f800000,0x3f1ebc123f531849,0x3f7294f83f800000,0x3f0f87843f4bbbf8,0x3f7080663f800000,0x3eff17b23f43e200,0x3f6e46be3f800000,0x3eddbe793f3b8f3b
.quad 0x3f7fe1293f7fec43,0x3f7fc38f3f7fd397,0x3f7cfe733f7e1324,0x3f7a1e843f7baccd,0x3f764d973f79c79d,0x3f6d1c1d3f721352,0x3f6be8583f731447,0x3f591e6a3f633c5a
.quad 0x3f5df6be3f6a09a7,0x3f3ebc1b3f4f7a1f,0x3f4cae793f5ebe05,0x3f1ebc123f373a23,0x3f3852163f514d3d,0x3ef41f073f1b02c6,0x3f212ff93f41d870,0x3ea395c53ef6e0cb
.quad 0x3f07a1363f3085bb,0x3e1c76de3eb263ef,0x3ed8106b3f1d7fd1,0xbc96c9b63e541501,0x3e9d9e783f08f59b,0xbe419b373d7b2b74,0x3e419b373ee63375,0xbeb554ecbdafb680
.quad 0x3d8a200a3eb8442a,0xbf0242b1be6c9a7f,0xbd6214693e888e93,0xbf26050abebe1d4a,0xbe3540983e2f10a2,0xbf44e3f5bf00e7e4,0xbe97a1173d96a905,0xbf5df6bebf1ff6cb
.quad 0x3f7f9c183f7fb10f,0x3f7f6ac73f7f84ab,0x3f764d973f7853f8,0x3f718f573f740bdd,0x3f6106f23f676bd8,0x3f5233c63f59f26a,0x3f40d0da3f4d9f02,0x3f239da93f32c8c9
.quad 0x3f173c073f2beb4a,0x3ed25a093f00e7e4,0x3ecc9b8b3f039c3d,0x3e1c76de3e8e9a22,0x3e419b373eac7cd4,0xbdee38763d16c32c,0xbcfb49ba3e164083,0xbec1071ebe541501
.quad 0xbe7ee6e1bd48fb30,0xbf1c420cbee0924f,0xbee900b7be78cfcc,0xbf4cae79bf24d225,0xbf239da9bedae880,0xbf6e46bebf4f7a1f,0xbf4ac77fbf187fc0,0xbf7e9bc9bf6db293
.quad 0xbf6816a8bf3daef9,0xbf7c7eb0bf7dabcc,0xbf7a1e84bf5b941a,0xbf6816a8bf7e70b0,0xbf7ffec4bf710908,0xbf42de29bf6ff573,0xbf796e4ebf7d3aac,0xbf0f8784bf531849
.quad 0x3f7f2f9d3f7f4e6d,0x3f7eea9d3f7f0e58,0x3f6be8583f6ed89e,0x3f655e0b3f68bf3c,0x3f40d0da3f49d112,0x3f2d14693f373a23,0x3f0242b13f13682a,0x3ebb31a03ee0924f
.quad 0x3e5a39973ea09ae5,0x3bc90f883de1bc2e,0xbdd53db93cc90ab0,0xbeb554ecbe6c9a7f,0xbed25a09be888e93,0xbf2ac082bf0b9a6b,0xbf2d1469bf08f59b,0xbf63f473bf4bbbf8
.quad 0xbf5f8327bf41d870,0xbf7e9bc9bf740bdd,0xbf7b61fcbf6a09a7,0xbf772417bf7fd397,0xbf7de0b1bf7e1324,0xbf4e8d90bf6db293,0xbf66beccbf7c3b28,0xbf0a48adbf3fc767
.quad 0xbf385216bf64aa59,0xbe4dee60bef6e0cb,0xbeee9479bf396842,0x3e28defcbe22abb6,0xbe28defcbefc5d27,0x3f0242b13e3b6ecf,0x3e1c76debe605c13,0x3f48d8b33f00e7e4
.quad 0x3bc90f8800000000,0x3c96c9b63c490e90,0x3cfb49ba00000000,0x3dbc3ac33d7b2b74,0x3d62146900000000,0x3e28defc3de1bc2e,0x3da3308c00000000,0x3e72b6513e22abb6
.quad 0x3dd53db900000000,0x3e9d9e783e541501,0x3e03950200000000,0x3ec1071e3e827dc0,0x3e1c76de00000000,0x3ee363fa3e9aa086,0x3e35409800000000,0x3f0242b13eb263ef
.quad 0x3e4dee6000000000,0x3f121eb03ec9b953,0x3e667c6600000000,0x3f212ff93ee0924f,0x3e7ee6e100000000,0x3f2f61a53ef6e0cb,0x3e8b950700000000,0x3f3ca0033f064b82
.quad 0x3e97a11700000000,0x3f48d8b33f10d3cd,0x3ea395c500000000,0x3f53fac33f1b02c6,0x3eaf713a00000000,0x3f5df6be3f24d225,0x3ebb31a000000000,0x3f66becc3f2e3bde
.quad 0x3cfb49ba3cc90ab0,0x3d2fe0073d16c32c,0x3e1c76de3dfab273,0x3e5a39973e3b6ecf,0x3e8b95073e605c13,0x3ec1071e3ea68f12,0x3ec6d5293ea09ae5,0x3f07a1363eebcbbb
.quad 0x3eff17b23ecf7bca,0x3f2ac0823f15f6d9,0x3f19c2003efc5d27,0x3f48d8b33f32c8c9,0x3f31a81d3f13682a,0x3f6106f23f4bbbf8,0x3f46e22a3f273656,0x3f7294f83f604621
.quad 0x3f591e6a3f396842,0x3f7cfe733f6ff573,0x3f6816a83f49d112,0x3f7ff4e63f7a7302,0x3f73913f3f584853,0x3f7b61fc3f7f84ab,0x3f7b61fc3f64aa59,0x3f6f68303f7f0e58
.quad 0x3f7f6ac73f6ed89e,0x3f5c61c73f791298,0x3f7f9c183f76ba07,0x3f42de293f6db293,0x3f7bf5313f7c3b28,0x3f239da93f5d2d53,0x3f7484223f7f4e6d,0x3eff17b23f47de65
.quad 0x3d6214693d48fb30,0x3d8a200a3d7b2b74,0x3e8b95073e78cfcc,0x3ea986c43e9aa086,0x3ef41f073edae880,0x3f121eb03f064b82,0x3f2866053f187fc0,0x3f44e3f53f373a23
.quad 0x3f4e8d903f3daef9,0x3f6965913f5d2d53,0x3f6aab7b3f5b941a,0x3f7cfe733f75dec6,0x3f7b61fc3f710908,0x3f7e43233f7fd397,0x3f7fe1293f7d3aac,0x3f6d1c1d3f7a7302
.quad 0x3f77f1103f7fb10f,0x3f4ac77f3f660f88,0x3f63f4733f7853f8,0x3f19c2003f43e200,0x3f44e3f53f676bd8,0x3ebb31a03f15f6d9,0x3f1c420c3f4d9f02,0x3dd53db93ebe1d4a
.quad 0x3ed8106b3f2beb4a,0xbe28defc3e09cf86,0x3e5a39973f039c3d,0xbed8106bbde1bc2e,0xbbc90f883eac7cd4,0xbf26050abeb263ef,0xbe667c663e164083,0xbf53fac3bf10d3cd
.quad 0x3da3308c3d96a905,0x3dbc3ac33dafb680,0x3ec6d5293eb8442a,0x3ee363fa3ed53641,0x3f2866053f1d7fd1,0x3f3ca0033f32c8c9,0x3f5c61c73f514d3d,0x3f6e46be3f660f88
.quad 0x3f7a1e843f731447,0x3f7ffec43f7e70b0,0x3f7e9bc93f7fec43,0x3f6f68303f791298,0x3f6965913f76ba07,0x3f3ebc1b3f5695e5,0x3f3ca0033f584853,0x3ee900b73f1b02c6
.quad 0x3ef9a02d3f273656,0x3dd53db93e9aa086,0x3e419b373ecf7bca,0xbe8586cebd16c32c,0xbe0395023dfab273,0xbf173c07bebe1d4a,0xbeddbe79be2f10a2,0xbf577026bf299415
.quad 0xbf31a81dbee63375,0xbf7ac516bf604621,0xbf628210bf3085bb,0xbf7c7eb0bf7cbfc9,0xbf7c7eb0bf5ebe05,0xbf5c61c7bf7baccd,0xbf7cfe73bf79c79d,0xbf1ebc12bf5d2d53
.quad 0x3600000036000000,0x3600000036000000,0x35ffe12935fffec4,0x35ff2f9d35ff9c18,0x35ff84ab35fffb11,0x35fcbfc935fe70b0,0x35feea9d35fff4e6,0x35f8b47b35fc7eb0
.quad 0x35fe132435ffec43,0x35f3144735f9c79d,0x35fcfe7335ffe129,0x35ebe85835f64d97,0x35fbaccd35ffd397,0x35e33c5a35f21352,0x35fa1e8435ffc38f,0x35d91e6a35ed1c1d
.quad 0x35f853f835ffb10f,0x35cd9f0235e76bd8,0x35f64d9735ff9c18,0x35c0d0da35e106f2,0x35f40bdd35ff84ab,0x35b2c8c935d9f26a,0x35f18f5735ff6ac7,0x35a39da935d233c6
.quad 0x35eed89e35ff4e6d,0x3593682a35c9d112,0x35ebe85835ff2f9d,0x358242b135c0d0da,0x35e8bf3c35ff0e58,0x3560924f35b73a23,0x35e55e0b35feea9d,0x353b31a035ad1469
.quad 0x3600000036000000,0x3600000036000000,0x35fde0b135fe9bc9,0x35fbf53135fcfe73,0x35f78bc535fa7302,0x35eff57335f40bdd,0x35ed1c1d35f3913f,0x35dc61c735e55e0b
.quad 0x35debe0535ea09a7,0x35c1d87035d14d3d,0x35ccae7935ddf6be,0x35a12ff935b85216,0x35b73a2335cf7a1f,0x3576e0cb359b02c6,0x359ebc1235bebc1b,0x352395c535741f07
.quad 0x35839c3d35abeb4a,0x34964083352c7cd4,0x354c9b8b35973c07,0xb37b49ba34c19b37,0x350e9a223580e7e4,0xb4d415013396c32c,0x349c76de35525a09,0xb541071eb46e3876
.quad 0x33490ab035209ae5,0xb588f59bb5088e93,0xb4553db934da3997,0xb5ad1469b5525a09,0xb4ec9a7f3461bc2e,0xb5cbbbf8b58b9a6b,0xb53554ec32490f88,0xb5e3f473b5aac082
.quad 0x3600000036000000,0x3600000036000000,0x35f96e4e35fac516,0x35f64d9735f7f110,0x35e60f8835eb4b0c,0x35d9f26a35e04621,0x35c6e22a35d233c6,0x35ad146935ba7ca4
.quad 0x359d7fd135b085bb,0x356633753588f59b,0x3558106b3587a136,0x34c19b37351d9e78,0x34d41501353263ef,0xb42fb68033fb2b74,0xb316c9b6349c76de,0xb53554ecb4c19b37
.quad 0xb4f8cfccb3c8fb30,0xb5987fc0b55ae880,0xb56900b7b4fee6e1,0xb5cac77fb5a39da9,0xb5a4d225b560924f,0xb5edb293b5cf7a1f,0xb5ccae79b59c420c,0xb5fe9bc9b5ee46be
.quad 0xb5ea09a7b5c1d870,0xb5fc3b28b5fe1324,0xb5fb61fcb5df8327,0xb5e6beccb5fde0b1,0xb5ffd397b5f40bdd,0xb5bfc767b5edb293,0xb5f72417b5fe9bc9,0xb58a48adb5ce8d90
.quad 0x3600000036000000,0x3600000036000000,0x35f294f835f48422,0x35ee46be35f08066,0x35cbbbf835d31849,0x35bb8f3b35c3e200,0x358f8784359ebc12,0x355dbe79357f17b2
.quad 0x35088e933538442a,0x3416a90534af10a2,0xb3e21469340a200a,0xb517a117b4b54098,0xb53e1d4ab4ec9a7f,0xb59ff6cbb580e7e4,0xb5a6050ab58242b1,0xb5ddf6beb5c4e3f5
.quad 0xb5db941ab5bdaef9,0xb5fd3aacb5f10908,0xb5fa1e84b5e816a8,0xb5f96e4eb5fffec4,0xb5fe70b0b5fdabcc,0xb5d31849b5eff573,0xb5e816a8b5fc7eb0,0xb58f8784b5c2de29
.quad 0xb5b96842b5e4aa59,0xb4e05c13b57c5d27,0xb56e9479b5b85216,0x349c76deb4a8defc,0xb4a2abb6b576e0cb,0x3580e7e434bb6ecf,0x34a8defcb4cdee60,0x35c8d8b3358242b1
.quad 0x0,0x0,0x337b49ba32490f88,0x3423308c33e21469,0x33fb2b7432c90e90,0x34a2abb63461bc2e,0x343c3ac33316c9b6,0x34f2b65134a8defc
.quad 0x347ab27333490ab0,0x35209ae534e05c13,0x349c76de337b49ba,0x3546d529350b9507,0x34bb6ecf3396c32c,0x356bcbbb35268f12,0x34da399733afe007,0x3587a1363541071e
.quad 0x34f8cfcc33c8fb30,0x35987fc0355ae880,0x350b950733e21469,0x35a8660535741f07,0x351aa08633fb2b74,0x35b73a2335864b82,0x352986c4340a200a,0x35c4e3f535921eb0
.quad 0x3538442a3416a905,0x35d14d3d359d7fd1,0x3546d5293423308c,0x35dc61c735a86605,0x35553641342fb680,0x35e60f8835b2c8c9,0x356363fa343c3ac3,0x35ee46be35bca003
.quad 0x0,0x0,0x3483950234553db9,0x34b54098349c76de,0x35027dc034d41501,0x353263ef351aa086,0x3541071e351d9e78,0x358242b1356363fa
.quad 0x357c5d27354f7bca,0x35a736563593682a,0x3599c200357f17b2,0x35c6e22a35b1a81d,0x35b2c8c93595f6d9,0x35e0462135cbbbf8,0x35c8d8b335aac082,0x35f294f835e106f2
.quad 0x35db941a35bdaef9,0x35fd3aac35f10908,0x35eaab7b35ce8d90,0x35ffe12935fb61fc,0x35f5dec635dd2d53,0x35fa730235ffd397,0x35fcfe7335e96591,0x35ed1c1d35fe4323
.quad 0x35ffec4335f31447,0x35d8485335f6ba07,0x35fe9bc935fa1e84,0x35bca00335e96591,0x35f9129835fe70b0,0x359b02c635d695e5,0x35ef683035fffec4,0x356900b735bebc1b
.quad 0x0,0x0,0x34e67c6634cdee60,0x350b950734fee6e1,0x3560924f3549b953,0x35864b823576e0cb,0x35a12ff935921eb0,0x35bca00335af61a5
.quad 0x35c9d11235b96842,0x35e4aa5935d84853,0x35e816a835d91e6a,0x35fb61fc35f3913f,0x35fa730235eff573,0x35ff0e5835ff84ab,0x35fff4e635fcfe73,0x35ef683035fb61fc
.quad 0x35f853f835ffb10f,0x35cd9f0235e76bd8,0x35e3f47335f7f110,0x359c420c35c4e3f5,0x35c3e20035e60f88,0x353e1d4a3595f6d9,0x3599c20035cac77f,0x34553db9353b31a0
.quad 0x354f7bca35a73656,0xb4af10a2347ab273,0x34c19b373579a02d,0xb55dbe79b4839502,0xb396c32c351aa086,0xb5a99415b53e1d4a,0xb50586ce34553db9,0xb5d77026b5973c07
.quad 0x0,0x0,0x352395c53517a117,0x353b31a0352f713a,0x359b02c63590d3cd,0x35ae3bde35a4d225,0x35d3fac335c8d8b3,0x35e6becc35ddf6be
.quad 0x35f6ba0735eed89e,0x35ff4e6d35fc3b28,0x35ff9c1835ff6ac7,0x35f4842235fbf531,0x35edb29335f91298,0x35c7de6535dd2d53,0x35c2de2935dc61c7,0x357f17b235a39da9
.quad 0x35839c3d35abeb4a,0x34964083352c7cd4,0x34da39973558106b,0xb4e67c66b2490f88,0xb461bc2e3489cf86,0xb590d3cdb53263ef,0xb558106bb4a8defc,0xb5d3fac3b5a6050a
.quad 0xb5b085bbb5663375,0xb5f9c79db5debe05,0xb5e28210b5b1a81d,0xb5fcfe73b5fc7eb0,0xb5fcbfc9b5e04621,0xb5dd2d53b5fbaccd,0xb5fc7eb0b5fac516,0xb59ebc12b5dc61c7
.quad 0x3e163f7d00003f80,0x3edb3f673e953f75,0x3f043f5c00003f80,0x3f80bd493f623ef1,0x3f4e3f1800003f80,0x3eacbf713f75be95,0x3f783e7900003f80,0xbf3ebf2c3ef1bf62
.quad 0x3f7dbe1600003f80,0xbf673edbbe95bf75,0x3f5cbf0400003f80,0x3d493f80bf62bef1,0x3f18bf4e00003f80,0x3f713eacbf753e95,0x3e79bf7800003f80,0x3f2cbf3ebef13f62
.quad 0xbe16bf7d00003f80,0xbedbbf673e953f75,0xbf04bf5c00003f80,0xbf803d493f623ef1,0xbf4ebf1800003f80,0xbeac3f713f75be95,0xbf78be7900003f80,0x3f3e3f2c3ef1bf62
.quad 0xbf7d3e1600003f80,0x3f67bedbbe95bf75,0xbf5c3f0400003f80,0xbd49bf80bf62bef1,0xbf183f4e00003f80,0xbf71beacbf753e95,0xbe793f7800003f80,0xbf2c3f3ebef13f62
.quad 0x3f2c3f3e3f0e3f55,0x3f5c3f043f463f22,0x3edbbf673f55bf0e,0xbf18bf4ebdc9bf7f,0xbf80bd49bf0ebf55,0x3e793f78bf223f46,0x3eac3f71bf553f0e,0x3e16bf7d3f7fbdc9
.quad 0x3f3ebf2c3f0e3f55,0xbf043f5cbf46bf22,0xbf67bedb3f55bf0e,0x3f4ebf183dc93f7f,0xbd493f80bf0ebf55,0xbf783e793f22bf46,0x3f71beacbf553f0e,0x3f7d3e16bf7f3dc9
.quad 0xbf2cbf3e3f0e3f55,0xbf5cbf043f463f22,0xbedb3f673f55bf0e,0x3f183f4ebdc9bf7f,0x3f803d49bf0ebf55,0xbe79bf78bf223f46,0xbeacbf71bf553f0e,0xbe163f7d3f7fbdc9
.quad 0xbf3e3f2c3f0e3f55,0x3f04bf5cbf46bf22,0x3f673edb3f55bf0e,0xbf4e3f183dc93f7f,0x3d49bf80bf0ebf55,0x3f78be793f22bf46,0xbf713eacbf553f0e,0xbf7dbe16bf7f3dc9
.quad 0x3f783e793f6d3ec4,0x3f80bd493f7f3dc9,0xbf7d3e16bf6dbec4,0xbeac3f71bf463f22,0x3f5cbf043f6d3ec4,0xbf3ebf2c3dc9bf7f,0xbf183f4ebf6dbec4,0x3f67bedb3f223f46
.quad 0x3e79bf783f6d3ec4,0x3d493f80bf7fbdc9,0x3e163f7dbf6dbec4,0xbf71beac3f46bf22,0xbf04bf5c3f6d3ec4,0x3f2cbf3ebdc93f7f,0x3f4e3f18bf6dbec4,0x3edb3f67bf22bf46
.quad 0xbf78be793f6d3ec4,0xbf803d493f7f3dc9,0x3f7dbe16bf6dbec4,0x3eacbf71bf463f22,0xbf5c3f043f6d3ec4,0x3f3e3f2c3dc9bf7f,0x3f18bf4ebf6dbec4,0xbf673edb3f223f46
.quad 0xbe793f783f6d3ec4,0xbd49bf80bf7fbdc9,0xbe16bf7dbf6dbec4,0x3f713eac3f46bf22,0x3f043f5c3f6d3ec4,0xbf2c3f3ebdc93f7f,0xbf4ebf18bf6dbec4,0xbedbbf67bf22bf46
.quad 0x3f71beac3f7bbe48,0x3f4ebf183f62bef1,0x3f2c3f3e3e483f7b,0x3f78be793f753e95,0xbedb3f67bf7b3e48,0x3f7d3e163ef13f62,0xbf80bd49be48bf7b,0x3f5c3f04be953f75
.quad 0xbeacbf713f7bbe48,0x3f183f4ebf623ef1,0x3f3ebf2c3e483f7b,0x3e793f78bf75be95,0x3f673edbbf7b3e48,0xbe163f7dbef1bf62,0xbd493f80be48bf7b,0xbf043f5c3e95bf75
.quad 0xbf713eac3f7bbe48,0xbf4e3f183f62bef1,0xbf2cbf3e3e483f7b,0xbf783e793f753e95,0x3edbbf67bf7b3e48,0xbf7dbe163ef13f62,0x3f803d49be48bf7b,0xbf5cbf04be953f75
.quad 0x3eac3f713f7bbe48,0xbf18bf4ebf623ef1,0xbf3e3f2c3e483f7b,0xbe79bf78bf75be95,0xbf67bedbbf7b3e48,0x3e16bf7dbef1bf62,0x3d49bf80be48bf7b,0x3f04bf5c3e95bf75
.quad 0x3f7dbe163f808000,0x3f67bedb3f75be95,0x3f5cbf043f808000,0xbd49bf803ef1bf62,0x3f18bf4e3f808000,0xbf71beacbe95bf75,0x3e79bf783f808000,0xbf2c3f3ebf62bef1
.quad 0xbe16bf7d3f808000,0x3edb3f67bf753e95,0xbf04bf5c3f808000,0x3f80bd49bef13f62,0xbf4ebf183f808000,0x3eacbf713e953f75,0xbf78be793f808000,0xbf3ebf2c3f623ef1
.quad 0xbf7d3e163f808000,0xbf673edb3f75be95,0xbf5c3f043f808000,0x3d493f803ef1bf62,0xbf183f4e3f808000,0x3f713eacbe95bf75,0xbe793f783f808000,0x3f2cbf3ebf62bef1
.quad 0x3e163f7d3f808000,0xbedbbf67bf753e95,0x3f043f5c3f808000,0xbf803d49bef13f62,0x3f4e3f183f808000,0xbeac3f713e953f75,0x3f783e793f808000,0x3f3e3f2c3f623ef1
.quad 0x3f3ebf2c3f55bf0e,0x3f04bf5c3f22bf46,0xbf67bedbbf0ebf55,0xbf4e3f18bf7f3dc9,0xbd493f80bf553f0e,0x3f78be793f463f22,0x3f71beac3f0e3f55,0xbf7dbe16bdc9bf7f
.quad 0xbf2cbf3e3f55bf0e,0x3f5c3f04bf223f46,0xbedb3f67bf0ebf55,0xbf18bf4e3f7fbdc9,0x3f803d49bf553f0e,0x3e793f78bf46bf22,0xbeacbf713f0e3f55,0x3e16bf7d3dc93f7f
.quad 0xbf3e3f2c3f55bf0e,0xbf043f5c3f22bf46,0x3f673edbbf0ebf55,0x3f4ebf18bf7f3dc9,0x3d49bf80bf553f0e,0xbf783e793f463f22,0xbf713eac3f0e3f55,0x3f7d3e16bdc9bf7f
.quad 0x3f2c3f3e3f55bf0e,0xbf5cbf04bf223f46,0x3edbbf67bf0ebf55,0x3f183f4e3f7fbdc9,0xbf80bd49bf553f0e,0xbe79bf78bf46bf22,0x3eac3f713f0e3f55,0xbe163f7d3dc93f7f
.quad 0x3e79bf783ec4bf6d,0xbd49bf803dc9bf7f,0x3e163f7dbec43f6d,0x3f713eac3f223f46,0xbf04bf5c3ec4bf6d,0xbf2c3f3ebf7fbdc9,0x3f4e3f18bec43f6d,0xbedbbf673f46bf22
.quad 0xbf78be793ec4bf6d,0x3f80bd49bdc93f7f,0x3f7dbe16bec43f6d,0xbeac3f71bf22bf46,0xbf5c3f043ec4bf6d,0xbf3ebf2c3f7f3dc9,0x3f18bf4ebec43f6d,0x3f67bedbbf463f22
.quad 0xbe793f783ec4bf6d,0x3d493f803dc9bf7f,0xbe16bf7dbec43f6d,0xbf71beac3f223f46,0x3f043f5c3ec4bf6d,0x3f2cbf3ebf7fbdc9,0xbf4ebf18bec43f6d,0x3edb3f673f46bf22
.quad 0x3f783e793ec4bf6d,0xbf803d49bdc93f7f,0xbf7d3e16bec43f6d,0x3eacbf71bf22bf46,0x3f5cbf043ec4bf6d,0x3f3e3f2c3f7f3dc9,0xbf183f4ebec43f6d,0xbf673edbbf463f22
.quad 0xbeacbf71be48bf7b,0xbf18bf4ebef1bf62,0x3f3ebf2c3f7bbe48,0xbe79bf783e95bf75,0x3f673edb3e483f7b,0x3e16bf7d3f62bef1,0xbd493f80bf7b3e48,0x3f04bf5c3f753e95
.quad 0xbf713eacbe48bf7b,0x3f4ebf183ef13f62,0xbf2cbf3e3f7bbe48,0x3f78be79be953f75,0x3edbbf673e483f7b,0x3f7d3e16bf623ef1,0x3f803d49bf7b3e48,0x3f5c3f04bf75be95
.quad 0x3eac3f71be48bf7b,0x3f183f4ebef1bf62,0xbf3e3f2c3f7bbe48,0x3e793f783e95bf75,0xbf67bedb3e483f7b,0xbe163f7d3f62bef1,0x3d49bf80bf7b3e48,0xbf043f5c3f753e95
.quad 0x3f71beacbe48bf7b,0xbf4e3f183ef13f62,0x3f2c3f3e3f7bbe48,0xbf783e79be953f75,0xbedb3f673e483f7b,0xbf7dbe16bf623ef1,0xbf80bd49bf7b3e48,0xbf5cbf04bf75be95
.quad 0x80003f8080003f80,0x80003f8080003f80,0xbf043f5cbe163f7d,0xbf783e79bf4e3f18,0xbf623ef1be953f75,0xbef1bf62bf75be95,0xbf80bd49bedb3f67,0x3f3ebf2cbeacbf71
.quad 0xbf55bf0ebf0e3f55,0x3f553f0e3f0ebf55,0xbedbbf67bf2c3f3e,0xbeac3f713f80bd49,0x3dc9bf7fbf463f22,0xbf7fbdc93f223f46,0x3f18bf4ebf5c3f04,0xbe16bf7dbe793f78
.quad 0x3f6dbec4bf6d3ec4,0x3f6dbec4bf6d3ec4,0x3f7d3e16bf783e79,0x3f183f4ebf5cbf04,0x3f463f22bf7f3dc9,0xbf223f46bdc9bf7f,0x3eac3f71bf80bd49,0xbf67bedb3f3ebf2c
.quad 0xbe483f7bbf7bbe48,0x3e48bf7b3f7b3e48,0xbf2c3f3ebf71beac,0x3f80bd493edb3f67,0xbf753e95bf62bef1,0x3e953f75bef13f62,0xbf78be79bf4ebf18,0xbf5c3f04bf7d3e16
.quad 0x80003f8080003f80,0x80003f8080003f80,0xbf5cbf04bf7dbe16,0xbe79bf78bf18bf4e,0x3f62bef13e95bf75,0x3ef13f623f753e95,0xbd493f803f673edb,0xbf2cbf3ebf713eac
.quad 0xbf55bf0ebf0e3f55,0x3f553f0e3f0ebf55,0x3f67bedbbf3ebf2c,0xbf71beac3d493f80,0xbdc93f7f3f46bf22,0x3f7f3dc9bf22bf46,0xbf4ebf183f043f5c,0xbf7d3e163f783e79
.quad 0x3f6dbec4bf6d3ec4,0x3f6dbec4bf6d3ec4,0xbe163f7dbe79bf78,0xbf4e3f183f04bf5c,0xbf46bf223f7fbdc9,0x3f22bf463dc93f7f,0x3f71beacbd493f80,0xbedb3f67bf2cbf3e
.quad 0xbe483f7bbf7bbe48,0x3e48bf7b3f7b3e48,0xbf3ebf2c3eacbf71,0x3d493f80bf673edb,0x3f75be953f623ef1,0xbe95bf753ef1bf62,0xbe793f78bf183f4e,0x3f043f5c3e163f7d
.quad 0x80003f8080003f80,0x80003f8080003f80,0x3f04bf5c3e16bf7d,0x3f78be793f4ebf18,0xbf623ef1be953f75,0xbef1bf62bf75be95,0x3f803d493edbbf67,0xbf3e3f2c3eac3f71
.quad 0xbf55bf0ebf0e3f55,0x3f553f0e3f0ebf55,0x3edb3f673f2cbf3e,0x3eacbf71bf803d49,0x3dc9bf7fbf463f22,0xbf7fbdc93f223f46,0xbf183f4e3f5cbf04,0x3e163f7d3e79bf78
.quad 0x3f6dbec4bf6d3ec4,0x3f6dbec4bf6d3ec4,0xbf7dbe163f78be79,0xbf18bf4e3f5c3f04,0x3f463f22bf7f3dc9,0xbf223f46bdc9bf7f,0xbeacbf713f803d49,0x3f673edbbf3e3f2c
.quad 0xbe483f7bbf7bbe48,0x3e48bf7b3f7b3e48,0x3f2cbf3e3f713eac,0xbf803d49bedbbf67,0xbf753e95bf62bef1,0x3e953f75bef13f62,0x3f783e793f4e3f18,0x3f5cbf043f7dbe16
.quad 0x80003f8080003f80,0x80003f8080003f80,0x3f5c3f043f7d3e16,0x3e793f783f183f4e,0x3f62bef13e95bf75,0x3ef13f623f753e95,0x3d49bf80bf67bedb,0x3f2c3f3e3f71beac
.quad 0xbf55bf0ebf0e3f55,0x3f553f0e3f0ebf55,0xbf673edb3f3e3f2c,0x3f713eacbd49bf80,0xbdc93f7f3f46bf22,0x3f7f3dc9bf22bf46,0x3f4e3f18bf04bf5c,0x3f7dbe16bf78be79
.quad 0x3f6dbec4bf6d3ec4,0x3f6dbec4bf6d3ec4,0x3e16bf7d3e793f78,0x3f4ebf18bf043f5c,0xbf46bf223f7fbdc9,0x3f22bf463dc93f7f,0xbf713eac3d49bf80,0x3edbbf673f2c3f3e
.quad 0xbe483f7bbf7bbe48,0x3e48bf7b3f7b3e48,0x3f3e3f2cbeac3f71,0xbd49bf803f67bedb,0x3f75be953f623ef1,0xbe95bf753ef1bf62,0x3e79bf783f18bf4e,0xbf04bf5cbe16bf7d
.quad 0x3f8000003f800000,0x3f8000003f800000,0x3f5c3f043f7d3e16,0x3e793f783f183f4e,0x3ef13f623f753e95,0xbf623ef1be953f75,0xbd493f803f673edb,0xbf2cbf3ebf713eac
.quad 0xbf0e3f553f553f0e,0x3f0ebf55bf55bf0e,0xbf673edb3f3e3f2c,0x3f713eacbd49bf80,0xbf7fbdc93f223f46,0xbdc93f7f3f46bf22,0xbf4ebf183f043f5c,0xbf7d3e163f783e79
.quad 0xbec4bf6d3ec43f6d,0xbec4bf6d3ec43f6d,0x3e16bf7d3e793f78,0x3f4ebf18bf043f5c,0x3f22bf463dc93f7f,0x3f463f22bf7f3dc9,0x3f71beacbd493f80,0xbedb3f67bf2cbf3e
.quad 0x3f7b3e48be483f7b,0xbf7bbe483e48bf7b,0x3f3e3f2cbeac3f71,0xbd49bf803f67bedb,0x3e953f75bef13f62,0x3f75be953f623ef1,0xbe793f78bf183f4e,0x3f043f5c3e163f7d
.quad 0x3f8000003f800000,0x3f8000003f800000,0xbf043f5cbe163f7d,0xbf783e79bf4e3f18,0xbef1bf62bf75be95,0x3f62bef13e95bf75,0x3f803d493edbbf67,0xbf3e3f2c3eac3f71
.quad 0xbf0e3f553f553f0e,0x3f0ebf55bf55bf0e,0xbedbbf67bf2c3f3e,0xbeac3f713f80bd49,0x3f7f3dc9bf22bf46,0x3dc9bf7fbf463f22,0xbf183f4e3f5cbf04,0x3e163f7d3e79bf78
.quad 0xbec4bf6d3ec43f6d,0xbec4bf6d3ec43f6d,0x3f7d3e16bf783e79,0x3f183f4ebf5cbf04,0xbf223f46bdc9bf7f,0xbf46bf223f7fbdc9,0xbeacbf713f803d49,0x3f673edbbf3e3f2c
.quad 0x3f7b3e48be483f7b,0xbf7bbe483e48bf7b,0xbf2c3f3ebf71beac,0x3f80bd493edb3f67,0xbe95bf753ef1bf62,0xbf753e95bf62bef1,0x3f783e793f4e3f18,0x3f5cbf043f7dbe16
.quad 0x3f8000003f800000,0x3f8000003f800000,0xbf5cbf04bf7dbe16,0xbe79bf78bf18bf4e,0x3ef13f623f753e95,0xbf623ef1be953f75,0x3d49bf80bf67bedb,0x3f2c3f3e3f71beac
.quad 0xbf0e3f553f553f0e,0x3f0ebf55bf55bf0e,0x3f67bedbbf3ebf2c,0xbf71beac3d493f80,0xbf7fbdc93f223f46,0xbdc93f7f3f46bf22,0x3f4e3f18bf04bf5c,0x3f7dbe16bf78be79
.quad 0xbec4bf6d3ec43f6d,0xbec4bf6d3ec43f6d,0xbe163f7dbe79bf78,0xbf4e3f183f04bf5c,0x3f22bf463dc93f7f,0x3f463f22bf7f3dc9,0xbf713eac3d49bf80,0x3edbbf673f2c3f3e
.quad 0x3f7b3e48be483f7b,0xbf7bbe483e48bf7b,0xbf3ebf2c3eacbf71,0x3d493f80bf673edb,0x3e953f75bef13f62,0x3f75be953f623ef1,0x3e79bf783f18bf4e,0xbf04bf5cbe16bf7d
.quad 0x3f8000003f800000,0x3f8000003f800000,0x3f04bf5c3e16bf7d,0x3f78be793f4ebf18,0xbef1bf62bf75be95,0x3f62bef13e95bf75,0xbf80bd49bedb3f67,0x3f3ebf2cbeacbf71
.quad 0xbf0e3f553f553f0e,0x3f0ebf55bf55bf0e,0x3edb3f673f2cbf3e,0x3eacbf71bf803d49,0x3f7f3dc9bf22bf46,0x3dc9bf7fbf463f22,0x3f18bf4ebf5c3f04,0xbe16bf7dbe793f78
.quad 0xbec4bf6d3ec43f6d,0xbec4bf6d3ec43f6d,0xbf7dbe163f78be79,0xbf18bf4e3f5c3f04,0xbf223f46bdc9bf7f,0xbf46bf223f7fbdc9,0x3eac3f71bf80bd49,0xbf67bedb3f3ebf2c
.quad 0x3f7b3e48be483f7b,0xbf7bbe483e48bf7b,0x3f2cbf3e3f713eac,0xbf803d49bedbbf67,0xbe95bf753ef1bf62,0xbf753e95bf62bef1,0xbf78be79bf4ebf18,0xbf5c3f04bf7d3e16
.quad 0x3f7ffd393f800000,0x3f7fe7053f7ff4e6,0x3f7fdaaf3f800000,0x3f7eb0693f7f6ac7,0x3f7f90b13f800000,0x3f7c187a3f7e4323,0x3f7f1f493f800000,0x3f7822d13f7c7eb0
.quad 0x3f7e868b3f800000,0x3f72d4eb3f7a1e84,0x3f7dc68c3f800000,0x3f6c36243f772417,0x3f7cdf6c3f800000,0x3f644fac3f73913f,0x3f7bd14d3f800000,0x3f5b2c793f6f6830
.quad 0x3f7a9c593f800000,0x3f50d9373f6aab7b,0x3f7940c03f800000,0x3f4564393f655e0b,0x3f77beb73f800000,0x3f38dd653f5f8327,0x3f76167a3f800000,0x3f2b561b3f591e6a
.quad 0x3f74484b3f800000,0x3f1ce11f3f5233c6,0x3f7254703f800000,0x3f0d92813f4ac77f,0x3f703b373f800000,0x3efafef73f42de29,0x3f6dfcf23f800000,0x3ed97cb93f3a7ca4
.quad 0x3f7fba9e3f7fd397,0x3f7f78083f7f9c18,0x3f7c5d3a3f7dabcc,0x3f78e3d63f7ac516,0x3f75341d3f791298,0x3f6afb8c3f708066,0x3f6a5ad93f721352,0x3f5627fe3f6106f2
.quad 0x3f5bfb343f68bf3c,0x3f3b06293f4cae79,0x3f4a4c873f5d2d53,0x3f1a62933f33e7bc,0x3f3592e73f4f7a1f,0x3eea66813f173c07,0x3f1e1e223f3fc767,0x3e9920fe3eee9479
.quad 0x3f0448893f2e3bde,0x3e06b26e3ea986c4,0x3ed0eb2a3f1b02c6,0xbd2351cb3e419b37,0x3e9620d23f064b82,0xbe57278f3d2fe007,0x3e3228d43ee0924f,0xbebf926fbdd53db9
.quad 0x3d55880e3eb263ef,0xbf06f686be7ee6e1,0xbd9064b43e827dc0,0xbf2a2a80bec6d529,0xbe44b0b93e22abb6,0xbf485bcabf04f484,0xbe9f1cdf3d7b2b74,0xbf60a6cfbf239da9
.quad 0x3f7f1f493f7f4e6d,0x3f7eb0693f7eea9d,0x3f74484b3f76ba07,0x3f6e8ff83f718f57,0x3f5d924d3f64aa59,0x3f4d26fd3f55b993,0x3f3c17d93f49d112,0x3f1ce11f3f2d1469
.quad 0x3f11796b3f273656,0x3ec27b553ef41f07,0x3ebf926f3efc5d27,0x3df475c03e7ee6e1,0x3e25c58c3ea09ae5,0xbe195be03bc90f88,0xbd6ea0383dfab273,0xbed0eb2abe72b651
.quad 0xbe8d17c0bd96a905,0xbf2302d3beee9479,0xbef58035be888e93,0xbf51c0c2bf2ac082,0xbf28fd41bee63375,0xbf714c7abf53fac3,0xbf4f0417bf1d7fd1,0xbf7f5ce9bf708066
.quad 0xbf6afb8cbf41d870,0xbf7aed37bf7e9bc9,0xbf7b87b2bf5ebe05,0xbf644facbf7d7474,0xbf7fdaafbf731447,0xbf3d27b8bf6d1c1d,0xbf77beb7bf7e1324,0xbf084b92bf4e8d90
.quad 0x3f7e2b723f7e70b0,0x3f7d906e3f7de0b1,0x3f67c1873f6b4b0c,0x3f5fe4e93f63f473,0x3f39f2ac3f43e200,0x3f24381a3f2f61a5,0x3ef2bd433f0b9a6b,0x3ea5129f3ecc9b8b
.quad 0x3e3228d43e8e9a22,0xbd2351cb3d8a200a,0xbe1324cabc490e90,0xbecb2aaebe8b9507,0xbee4cbfebe9aa086,0xbf33587abf14b039,0xbf34768fbf10d3cd,0xbf6912aebf5233c6
.quad 0xbf644facbf47de65,0xbf7f90b1bf772417,0xbf7d1cddbf6db293,0xbf73ced9bf7f2f9d,0xbf7c5d3abf7f0e58,0xbf476085bf696591,0xbf62241abf7a7302,0xbf003a06bf385216
.quad 0xbf311722bf604621,0xbe1f917bbee363fa,0xbedc53c1bf32c8c9,0x3e57278fbdee3876,0xbe007745beebcbbb,0x3f0c42c93e667c66,0x3e44b0b9be3b6ecf,0x3f4fefa83f0a48ad
.quad 0x3c16cb5800000000,0x3ce22a7a3c96c9b6,0x3d0a342f00000000,0x3dcefdb73d8a200a,0x3d6ea03800000000,0x3e3228d43dee3876,0x3da973ba00000000,0x3e7bdba43e28defc
.quad 0x3ddb7d3700000000,0x3ea218873e5a3997,0x3e06b26e00000000,0x3ec5625c3e8586ce,0x3e1f917b00000000,0x3ee79a5d3e9d9e78,0x3e3857ec00000000,0x3f0448893eb554ec
.quad 0x3e5101f100000000,0x3f140c5f3ecc9b8b,0x3e698bba00000000,0x3f2302d33ee363fa,0x3e80f8c000000000,0x3f3117223ef9a02d,0x3e8d17c000000000,0x3f3e35c53f07a136
.quad 0x3e9920fe00000000,0x3f4a4c873f121eb0,0x3ea5129f00000000,0x3f554aa43f1c420c,0x3eb0eacb00000000,0x3f5f20db3f26050a,0x3ebca7af00000000,0x3f67c1873f2f61a5
.quad 0x3d3c6dd53d16c32c,0x3d83db0a3d621469,0x3e2bf8043e09cf86,0x3e6fa8b23e4dee60,0x3e931f353e6c9a7f,0x3ecb2aae3eaf713a,0x3ece0bea3ea68f12,0x3f0c42c93ef41f07
.quad 0x3f02ef9f3ed53641,0x3f2ecef73f19c200,0x3f1ce11f3f00e7e4,0x3f4c35783f36206c,0x3f34768f3f15f6d9,0x3f6398ac3f4e8d90,0x3f4955213f299415,0x3f74484b3f628210
.quad 0x3f5b2c793f3b8f3b,0x3f7dc68c3f718f57,0x3f69b7e43f4bbbf8,0x3f7fcbe23f7b61fc,0x3f74bf623f59f26a,0x3f7a49103f7fc38f,0x3f7c187a3f660f88,0x3f6d67a13f7e9bc9
.quad 0x3f7fa6e33f6ff573,0x3f5988ad3f77f110,0x3f7f5ce93f778bc5,0x3f3f41fc3f6be858,0x3f7b3bab3f7cbfc9,0x3f1f599f3f5ac450,0x3f73530e3f7f84ab,0x3ef580353f44e3f5
.quad 0x3da973ba3d96a905,0x3dcefdb73dbc3ac3,0x3e9920fe3e888e93,0x3eb9bb1e3ea986c4,0x3f003a063ee63375,0x3f19210f3f0cead0,0x3f2da8593f1d7fd1,0x3f4a4c873f3ca003
.quad 0x3f52a6493f41d870,0x3f6cd0073f6106f2,0x3f6d67a13f5ebe05,0x3f7e2b723f77f110,0x3f7c9f8a3f731447,0x3f7d1cdd3f7ffec4,0x3f7f90b13f7e1324,0x3f69b7e43f78b47b
.quad 0x3f76167a3f7f4e6d,0x3f4564393f628210,0x3f60a6cf3f76ba07,0x3f12c39a3f3ebc1b,0x3f404c5c3f64aa59,0x3eab02013f0f8784,0x3f16999f3f49d112,0x3d9064b43eaf713a
.quad 0x3ecb2aae3f273656,0xbe4ada4f3dd53db9,0x3e3e853e3efc5d27,0xbee79a5dbe1008b7,0xbd0a342f3ea09ae5,0xbf2c800fbec1071e,0xbe80f8c03dfab273,0xbf58b3a1bf173c07
.quad 0x3df475c03de1bc2e,0x3e0cec4a3e039502,0x3ed97cb93ec9b953,0x3ef840c83ee900b7,0x3f2ff3e63f24d225,0x3f4463373f3a7ca4,0x3f61668a3f5695e5,0x3f7254703f6aab7b
.quad 0x3f7c187a3f75dec6,0x3f7fcbe23f7f6ac7,0x3f7d57de3f7ffb11,0x3f6afb8c3f764d97,0x3f6504793f740bdd,0x3f36ad7f3f5064af,0x3f3592e73f531849,0x3ed3c8673f121eb0
.quad 0x3ee79a5d3f1ff6cb,0x3d6ea0383e8586ce,0x3e195be03ebe1d4a,0xbe9c1fafbda3308c,0xbe2bf8043dafb680,0xbf209393bed25a09,0xbeeff7fbbe541501,0xbf5d924dbf31a81d
.quad 0xbf38dd65bef6e0cb,0xbf7cdf6cbf655e0b,0xbf671599bf373a23,0xbf7a4910bf7e4323,0xbf7dfa38bf633c5a,0xbf5627febf796e4e,0xbf7b3babbf7baccd,0xbf1553b7bf577026
.quad 0x3600000036000000,0x3600000036000000,0x35ffdaaf35fffd39,0x35ff1f4935ff90b1,0x35ff6ac735fff4e6,0x35fc7eb035fe4323,0x35feb06935ffe705,0x35f822d135fc187a
.quad 0x35fdabcc35ffd397,0x35f2135235f91298,0x35fc5d3a35ffba9e,0x35ea5ad935f5341d,0x35fac51635ff9c18,0x35e106f235f08066,0x35f8e3d635ff7808,0x35d627fe35eafb8c
.quad 0x35f6ba0735ff4e6d,0x35c9d11235e4aa59,0x35f4484b35ff1f49,0x35bc17d935dd924d,0x35f18f5735feea9d,0x35ad146935d5b993,0x35ee8ff835feb069,0x359ce11f35cd26fd
.quad 0x35eb4b0c35fe70b0,0x358b9a6b35c3e200,0x35e7c18735fe2b72,0x3572bd4335b9f2ac,0x35e3f47335fde0b1,0x354c9b8b35af61a5,0x35dfe4e935fd906e,0x3525129f35a4381a
.quad 0x3600000036000000,0x3600000036000000,0x35fdc68c35fe868b,0x35fbd14d35fcdf6c,0x35f7241735fa1e84,0x35ef683035f3913f,0x35ec362435f2d4eb,0x35db2c7935e44fac
.quad 0x35dd2d5335e8bf3c,0x35bfc76735cf7a1f,0x35ca4c8735dbfb34,0x359e1e2235b592e7,0x35b3e7bc35ccae79,0x356e947935973c07,0x359a629335bb0629,0x351920fe356a6681
.quad 0x357c5d2735a73656,0x347ab27335209ae5,0x353f926f3591796b,0xb3eea03834a5c58c,0x34fee6e135741f07,0xb4f2b65132490f88,0x347475c035427b55,0xb550eb2ab4995be0
.quad 0xb2c90e90350e9a22,0xb590d3cdb51aa086,0xb49324ca34b228d4,0xb5b4768fb564cbfe,0xb50b9507340a200a,0xb5d233c6b594b039,0xb54b2aaeb3a351cb,0xb5e912aeb5b3587a
.quad 0x3600000036000000,0x3600000036000000,0x35f940c035fa9c59,0x35f6167a35f7beb7,0x35e55e0b35eaab7b,0x35d91e6a35df8327,0x35c5643935d0d937,0x35ab561b35b8dd65
.quad 0x359b02c635ae3bde,0x3560924f35864b82,0x3550eb2a35844889,0x34b228d4351620d2,0x34c19b37352986c4,0xb4553db933afe007,0xb3a351cb3486b26e,0xb53f926fb4d7278f
.quad 0xb5088e93b416a905,0xb59d7fd1b5663375,0xb5758035b50d17c0,0xb5cf0417b5a8fd41,0xb5aac082b56e9479,0xb5f08066b5d3fac3,0xb5d1c0c2b5a302d3,0xb5ff5ce9b5f14c7a
.quad 0xb5edb293b5c7de65,0xb5fa7302b5ff0e58,0xb5fd1cddb5e44fac,0xb5e2241ab5fc5d3a,0xb5ff2f9db5f72417,0xb5b85216b5e96591,0xb5f3ced9b5ff90b1,0xb5803a06b5c76085
.quad 0x3600000036000000,0x3600000036000000,0x35f2547035f4484b,0x35edfcf235f03b37,0x35cac77f35d233c6,0x35ba7ca435c2de29,0x358d9281359ce11f,0x35597cb9357afef7
.quad 0x35027dc0353263ef,0x33fb2b7434a2abb6,0xb41064b433d5880e,0xb51f1cdfb4c4b0b9,0xb546d529b4fee6e1,0xb5a39da9b584f484,0xb5aa2a80b586f686,0xb5e0a6cfb5c85bca
.quad 0xb5debe05b5c1d870,0xb5fe1324b5f31447,0xb5fb87b2b5eafb8c,0xb5f7beb7b5ffdaaf,0xb5fd7474b5fe9bc9,0xb5ce8d90b5ed1c1d,0xb5e44facb5faed37,0xb5884b92b5bd27b8
.quad 0xb5b2c8c9b5e04621,0xb4bb6ecfb56bcbbb,0xb55c53c1b5b11722,0x34c4b0b9b4807745,0xb46e3876b56363fa,0x358a48ad34e67c66,0x34d7278fb49f917b,0x35cfefa8358c42c9
.quad 0x0,0x0,0x338a342f3296cb58,0x342973ba33eea038,0x340a200a3316c9b6,0x34a8defc346e3876,0x344efdb733622a7a,0x34fbdba434b228d4
.quad 0x3489cf863396c32c,0x35268f1234ec9a7f,0x34abf80433bc6dd5,0x354e0bea35131f35,0x34cdee6033e21469,0x35741f07352f713a,0x34efa8b23403db0a,0x358c42c9354b2aae
.quad 0x35088e933416a905,0x359d7fd135663375,0x351920fe342973ba,0x35ada85935803a06,0x352986c4343c3ac3,0x35bca003358cead0,0x3539bb1e344efdb7,0x35ca4c873599210f
.quad 0x3549b9533461bc2e,0x35d695e535a4d225,0x35597cb9347475c0,0x35e1668a35aff3e6,0x356900b734839502,0x35eaab7b35ba7ca4,0x357840c8348cec4a,0x35f2547035c46337
.quad 0x0,0x0,0x3486b26e345b7d37,0x34b857ec349f917b,0x350586ce34da3997,0x353554ec351d9e78,0x3545625c35221887,0x3584488935679a5d
.quad 0x3580e7e435553641,0x35a994153595f6d9,0x359ce11f3582ef9f,0x35c9552135b4768f,0x35b6206c3599c200,0x35e2821035ce8d90,0x35cc357835aecef7,0x35f4484b35e398ac
.quad 0x35debe0535c1d870,0x35fe132435f31447,0x35ed67a135d2a649,0x35ff90b135fc9f8a,0x35f7f11035e106f2,0x35f8b47b35fffec4,0x35fe2b7235ecd007,0x35e9b7e435fd1cdd
.quad 0x35fffb1135f5dec6,0x35d3184935f40bdd,0x35fd57de35fc187a,0x35b592e735e50479,0x35f64d9735ff6ac7,0x35921eb035d064af,0x35eafb8c35ffcbe2,0x3553c86735b6ad7f
.quad 0x0,0x0,0x34e98bba34d101f1,0x350d17c03500f8c0,0x356363fa354c9b8b,0x3587a1363579a02d,0x35a302d335940c5f,0x35be35c535b11722
.quad 0x35cbbbf835bb8f3b,0x35e60f8835d9f26a,0x35e9b7e435db2c79,0x35fc187a35f4bf62,0x35fb61fc35f18f57,0x35fe9bc935ffc38f,0x35ffcbe235fdc68c,0x35ed67a135fa4910
.quad 0x35f6ba0735ff4e6d,0x35c9d11235e4aa59,0x35e0a6cf35f6167a,0x3596999f35c04c5c,0x35bebc1b35e28210,0x352f713a358f8784,0x3592c39a35c56439,0x341064b4352b0201
.quad 0x353e1d4a359ff6cb,0xb4d41501342fb680,0x34995be035679a5d,0xb56ff7fbb4abf804,0xb423308c350586ce,0xb5b1a81db5525a09,0xb51c1faf33eea038,0xb5dd924db5a09393
.quad 0x0,0x0,0x3525129f351920fe,0x353ca7af3530eacb,0x359c420c35921eb0,0x35af61a535a6050a,0x35d54aa435ca4c87,0x35e7c18735df20db
.quad 0x35f78bc535eff573,0x35ff84ab35fcbfc9,0x35ff5ce935ffa6e3,0x35f3530e35fb3bab,0x35ebe85835f7f110,0x35c4e3f535dac450,0x35bf41fc35d988ad,0x35758035359f599f
.quad 0x357c5d2735a73656,0x347ab27335209ae5,0x34be853e354b2aae,0xb500f8c0b38a342f,0xb49008b734553db9,0xb5973c07b541071e,0xb5679a5db4cada4f,0xb5d8b3a1b5ac800f
.quad 0xb5b73a23b576e0cb,0xb5fbaccdb5e33c5a,0xb5e71599b5b8dd65,0xb5fb3babb5fdfa38,0xb5fe4323b5e55e0b,0xb5d77026b5f96e4e,0xb5fa4910b5fcdf6c,0xb59553b7b5d627fe
.quad 0x3e483f7b00003f80,0x3f0e3f553ec43f6d,0x3f0e3f5500003f80,0x3f7bbe483f6d3ec4,0x3f553f0e00003f80,0x3e48bf7b3f6dbec4,0x3f7b3e4800003f80,0xbf55bf0e3ec4bf6d
.quad 0x3f7bbe4800003f80,0xbf553f0ebec4bf6d,0x3f55bf0e00003f80,0x3e483f7bbf6dbec4,0x3f0ebf5500003f80,0x3f7b3e48bf6d3ec4,0x3e48bf7b00003f80,0x3f0ebf55bec43f6d
.quad 0xbe48bf7b00003f80,0xbf0ebf553ec43f6d,0xbf0ebf5500003f80,0xbf7b3e483f6d3ec4,0xbf55bf0e00003f80,0xbe483f7b3f6dbec4,0xbf7bbe4800003f80,0x3f553f0e3ec4bf6d
.quad 0xbf7b3e4800003f80,0x3f55bf0ebec4bf6d,0xbf553f0e00003f80,0xbe48bf7bbf6dbec4,0xbf0e3f5500003f80,0xbf7bbe48bf6d3ec4,0xbe483f7b00003f80,0xbf0e3f55bec43f6d
.quad 0x3f553f0e3f353f35,0x3f7b3e483f6d3ec4,0x3e48bf7b3f35bf35,0xbf55bf0ebec4bf6d,0xbf7b3e48bf35bf35,0x3f0e3f55bec43f6d,0x3f0e3f55bf353f35,0xbe48bf7b3f6dbec4
.quad 0x3f0ebf553f353f35,0xbe483f7bbf6dbec4,0xbf7bbe483f35bf35,0x3f0ebf553ec43f6d,0x3e483f7bbf35bf35,0xbf553f0e3ec4bf6d,0x3f55bf0ebf353f35,0x3f7bbe48bf6d3ec4
.quad 0xbf55bf0e3f353f35,0xbf7bbe483f6d3ec4,0xbe483f7b3f35bf35,0x3f553f0ebec4bf6d,0x3f7bbe48bf35bf35,0xbf0ebf55bec43f6d,0xbf0ebf55bf353f35,0x3e483f7b3f6dbec4
.quad 0xbf0e3f553f353f35,0x3e48bf7bbf6dbec4,0x3f7b3e483f35bf35,0xbf0e3f553ec43f6d,0xbe48bf7bbf35bf35,0x3f55bf0e3ec4bf6d,0xbf553f0ebf353f35,0xbf7b3e48bf6d3ec4
.quad 0x3f7bbe483f80248d,0x3f55bf0e3f6dbec4,0xbf553f0ebf80a554,0x3e483f7bbec43f6d,0x3f0ebf553f8025b0,0xbf7bbe48bec4bf6d,0xbe483f7bbf80a5f7,0x3f0ebf553f6d3ec4
.quad 0xbe48bf7b3f80261f,0x3f0e3f55bf6d3ec4,0x3f0e3f55bf80a731,0xbf7b3e483ec4bf6d,0xbf55bf0e3f80a68d,0x3e48bf7b3ec43f6d,0x3f7b3e48bf80a742,0x3f553f0ebf6dbec4
.quad 0xbf7b3e483f80a654,0xbf553f0e3f6dbec4,0x3f55bf0ebf80a754,0xbe48bf7bbec43f6d,0xbf0e3f553f80a60d,0x3f7b3e48bec4bf6d,0x3e48bf7bbf80a765,0xbf0e3f553f6d3ec4
.quad 0x3e483f7b3f80a58e,0xbf0ebf55bf6d3ec4,0xbf0ebf55bf80a777,0x3f7bbe483ec4bf6d,0x3f553f0e3f80a137,0xbe483f7b3ec43f6d,0xbf7bbe48bf80a784,0xbf55bf0ebf6dbec4
.quad 0x3f0ebf553f35bf35,0x3e48bf7b3ec4bf6d,0x3f7b3e483f353f35,0x3f0ebf553f6dbec4,0x3e483f7bbf353f35,0x3f55bf0e3f6d3ec4,0xbf553f0ebf35bf35,0x3f7bbe483ec43f6d
.quad 0xbf55bf0e3f35bf35,0x3f7b3e48bec43f6d,0x3e48bf7b3f353f35,0x3f553f0ebf6d3ec4,0x3f7bbe48bf353f35,0x3f0e3f55bf6dbec4,0x3f0e3f55bf35bf35,0x3e483f7bbec4bf6d
.quad 0xbf0e3f553f35bf35,0xbe483f7b3ec4bf6d,0xbf7bbe483f353f35,0xbf0e3f553f6dbec4,0xbe48bf7bbf353f35,0xbf553f0e3f6d3ec4,0x3f55bf0ebf35bf35,0xbf7b3e483ec43f6d
.quad 0x3f553f0e3f35bf35,0xbf7bbe48bec43f6d,0xbe483f7b3f353f35,0xbf55bf0ebf6d3ec4,0xbf7b3e48bf353f35,0xbf0ebf55bf6dbec4,0xbf0ebf55bf35bf35,0xbe48bf7bbec4bf6d
.quad 0x3f7bbe483f808000,0x3f55bf0e3f6dbec4,0x3f55bf0e3f808000,0xbe48bf7b3ec4bf6d,0x3f0ebf553f808000,0xbf7bbe48bec4bf6d,0x3e48bf7b3f808000,0xbf0e3f55bf6dbec4
.quad 0xbe48bf7b3f808000,0x3f0e3f55bf6d3ec4,0xbf0ebf553f808000,0x3f7bbe48bec43f6d,0xbf55bf0e3f808000,0x3e48bf7b3ec43f6d,0xbf7bbe483f808000,0xbf55bf0e3f6d3ec4
.quad 0xbf7b3e483f808000,0xbf553f0e3f6dbec4,0xbf553f0e3f808000,0x3e483f7b3ec4bf6d,0xbf0e3f553f808000,0x3f7b3e48bec4bf6d,0xbe483f7b3f808000,0x3f0ebf55bf6dbec4
.quad 0x3e483f7b3f808000,0xbf0ebf55bf6d3ec4,0x3f0e3f553f808000,0xbf7b3e48bec43f6d,0x3f553f0e3f808000,0xbe483f7b3ec43f6d,0x3f7b3e483f808000,0x3f553f0e3f6d3ec4
.quad 0x3f0ebf553f35bf35,0x3e48bf7b3ec4bf6d,0xbf7bbe48bf35bf35,0xbf0e3f55bf6d3ec4,0x3e483f7bbf353f35,0x3f55bf0e3f6d3ec4,0x3f55bf0e3f353f35,0xbf7b3e48bec4bf6d
.quad 0xbf55bf0e3f35bf35,0x3f7b3e48bec43f6d,0xbe483f7bbf35bf35,0xbf55bf0e3f6dbec4,0x3f7bbe48bf353f35,0x3f0e3f55bf6dbec4,0xbf0ebf553f353f35,0xbe48bf7b3ec43f6d
.quad 0xbf0e3f553f35bf35,0xbe483f7b3ec4bf6d,0x3f7b3e48bf35bf35,0x3f0ebf55bf6d3ec4,0xbe48bf7bbf353f35,0xbf553f0e3f6d3ec4,0xbf553f0e3f353f35,0x3f7bbe48bec4bf6d
.quad 0x3f553f0e3f35bf35,0xbf7bbe48bec43f6d,0x3e48bf7bbf35bf35,0x3f553f0e3f6dbec4,0xbf7b3e48bf353f35,0xbf0ebf55bf6dbec4,0x3f0e3f553f353f35,0x3e483f7b3ec43f6d
.quad 0xbe48bf7b248dbf80,0xbf0ebf55bec4bf6d,0x3f0e3f55a5543f80,0x3f7bbe483f6d3ec4,0xbf55bf0e25b0bf80,0xbe483f7bbf6d3ec4,0x3f7b3e48a5f73f80,0xbf55bf0e3ec4bf6d
.quad 0xbf7b3e48261fbf80,0x3f55bf0e3ec43f6d,0x3f55bf0ea7313f80,0x3e483f7bbf6dbec4,0xbf0e3f55a68dbf80,0xbf7bbe483f6dbec4,0x3e48bf7ba7423f80,0x3f0ebf55bec43f6d
.quad 0x3e483f7ba654bf80,0x3f0e3f55bec4bf6d,0xbf0ebf55a7543f80,0xbf7b3e483f6d3ec4,0x3f553f0ea60dbf80,0x3e48bf7bbf6d3ec4,0xbf7bbe48a7653f80,0x3f553f0e3ec4bf6d
.quad 0x3f7bbe48a58ebf80,0xbf553f0e3ec43f6d,0xbf553f0ea7773f80,0xbe48bf7bbf6dbec4,0x3f0ebf55a137bf80,0x3f7b3e483f6dbec4,0xbe483f7ba7843f80,0xbf0e3f55bec43f6d
.quad 0xbf55bf0ebf35bf35,0xbf7bbe48bf6dbec4,0x3e48bf7b3f35bf35,0xbf55bf0ebec4bf6d,0x3f7bbe483f353f35,0xbf0ebf553ec4bf6d,0x3f0e3f55bf353f35,0xbe48bf7b3f6dbec4
.quad 0xbf0e3f55bf35bf35,0x3e48bf7b3f6d3ec4,0xbf7bbe483f35bf35,0x3f0ebf553ec43f6d,0xbe48bf7b3f353f35,0x3f55bf0ebec43f6d,0x3f55bf0ebf353f35,0x3f7bbe48bf6d3ec4
.quad 0x3f553f0ebf35bf35,0x3f7b3e48bf6dbec4,0xbe483f7b3f35bf35,0x3f553f0ebec4bf6d,0xbf7b3e483f353f35,0x3f0e3f553ec4bf6d,0xbf0ebf55bf353f35,0x3e483f7b3f6dbec4
.quad 0x3f0ebf55bf35bf35,0xbe483f7b3f6d3ec4,0x3f7b3e483f35bf35,0xbf0e3f553ec43f6d,0x3e483f7b3f353f35,0xbf553f0ebec43f6d,0xbf553f0ebf353f35,0xbf7b3e48bf6d3ec4
.quad 0x80003f8080003f80,0x80003f8080003f80,0xbf0e3f55be483f7b,0xbf7b3e48bf553f0e,0xbf6d3ec4bec43f6d,0xbec4bf6dbf6dbec4,0xbf7bbe48bf0e3f55,0x3f55bf0ebe48bf7b
.quad 0xbf35bf35bf353f35,0x3f353f353f35bf35,0xbe48bf7bbf553f0e,0xbf0e3f553f7b3e48,0x3ec4bf6dbf6d3ec4,0xbf6dbec43ec43f6d,0x3f55bf0ebf7b3e48,0x3e48bf7bbf0e3f55
.quad 0x3f80a554bf80248d,0x3f80a5f7bf8025b0,0x3f553f0ebf7bbe48,0x3e483f7bbf0ebf55,0x3ec43f6dbf6dbec4,0xbf6d3ec43ec4bf6d,0xbe483f7bbf55bf0e,0xbf0ebf553f7bbe48
.quad 0xbf353f35bf35bf35,0x3f35bf353f353f35,0xbf7b3e48bf0ebf55,0x3f553f0ebe483f7b,0xbf6dbec4bec4bf6d,0xbec43f6dbf6d3ec4,0xbf0ebf55be48bf7b,0xbf7bbe48bf55bf0e
.quad 0x80003f8080003f80,0x80003f8080003f80,0xbf55bf0ebf7bbe48,0xbe48bf7bbf0ebf55,0x3f6dbec43ec4bf6d,0x3ec43f6d3f6d3ec4,0xbe483f7b3f553f0e,0xbf0ebf55bf7b3e48
.quad 0xbf35bf35bf353f35,0x3f353f353f35bf35,0x3f7bbe48bf0ebf55,0xbf55bf0ebe483f7b,0xbec43f6d3f6dbec4,0x3f6d3ec4bec4bf6d,0xbf0ebf553e483f7b,0xbf7bbe483f553f0e
.quad 0x3f80a731bf80261f,0x3f80a742bf80a68d,0xbf0e3f553e48bf7b,0xbf7b3e483f55bf0e,0xbec4bf6d3f6d3ec4,0x3f6dbec4bec43f6d,0x3f7b3e48bf0e3f55,0xbf553f0ebe48bf7b
.quad 0xbf353f35bf35bf35,0x3f35bf353f353f35,0xbe48bf7b3f55bf0e,0xbf0e3f55bf7bbe48,0x3f6d3ec43ec43f6d,0x3ec4bf6d3f6dbec4,0xbf553f0ebf7b3e48,0xbe483f7bbf0e3f55
.quad 0x80003f8080003f80,0x80003f8080003f80,0x3f0ebf553e48bf7b,0x3f7bbe483f55bf0e,0xbf6d3ec4bec43f6d,0xbec4bf6dbf6dbec4,0x3f7b3e483f0ebf55,0xbf553f0e3e483f7b
.quad 0xbf35bf35bf353f35,0x3f353f353f35bf35,0x3e483f7b3f55bf0e,0x3f0ebf55bf7bbe48,0x3ec4bf6dbf6d3ec4,0xbf6dbec43ec43f6d,0xbf553f0e3f7bbe48,0xbe483f7b3f0ebf55
.quad 0x3f80a754bf80a654,0x3f80a765bf80a60d,0xbf55bf0e3f7b3e48,0xbe48bf7b3f0e3f55,0x3ec43f6dbf6dbec4,0xbf6d3ec43ec4bf6d,0x3e48bf7b3f553f0e,0x3f0e3f55bf7b3e48
.quad 0xbf353f35bf35bf35,0x3f35bf353f353f35,0x3f7bbe483f0e3f55,0xbf55bf0e3e48bf7b,0xbf6dbec4bec4bf6d,0xbec43f6dbf6d3ec4,0x3f0e3f553e483f7b,0x3f7b3e483f553f0e
.quad 0x80003f8080003f80,0x80003f8080003f80,0x3f553f0e3f7b3e48,0x3e483f7b3f0e3f55,0x3f6dbec43ec4bf6d,0x3ec43f6d3f6d3ec4,0x3e48bf7bbf55bf0e,0x3f0e3f553f7bbe48
.quad 0xbf35bf35bf353f35,0x3f353f353f35bf35,0xbf7b3e483f0e3f55,0x3f553f0e3e48bf7b,0xbec43f6d3f6dbec4,0x3f6d3ec4bec4bf6d,0x3f0e3f55be48bf7b,0x3f7b3e48bf55bf0e
.quad 0x3f80a777bf80a58e,0x3f80a784bf80a137,0x3f0ebf55be483f7b,0x3f7bbe48bf553f0e,0xbec4bf6d3f6d3ec4,0x3f6dbec4bec43f6d,0xbf7bbe483f0ebf55,0x3f55bf0e3e483f7b
.quad 0xbf353f35bf35bf35,0x3f35bf353f353f35,0x3e483f7bbf553f0e,0x3f0ebf553f7b3e48,0x3f6d3ec43ec43f6d,0x3ec4bf6d3f6dbec4,0x3f55bf0e3f7bbe48,0x3e48bf7b3f0ebf55
.quad 0x3f8000003f800000,0x3f8000003f800000,0x3f553f0e3f7b3e48,0x3e483f7b3f0e3f55,0x3ec43f6d3f6d3ec4,0xbf6d3ec4bec43f6d,0xbe483f7b3f553f0e,0xbf0ebf55bf7b3e48
.quad 0xbf353f353f353f35,0x3f35bf35bf35bf35,0xbf7b3e483f0e3f55,0x3f553f0e3e48bf7b,0xbf6dbec43ec43f6d,0xbec43f6d3f6dbec4,0xbf0ebf553e483f7b,0xbf7bbe483f553f0e
.quad 0xa554bf80248d3f80,0xa5f7bf8025b03f80,0x3f0ebf55be483f7b,0x3f7bbe48bf553f0e,0x3f6dbec4bec43f6d,0x3ec43f6dbf6dbec4,0x3f7b3e48bf0e3f55,0xbf553f0ebe48bf7b
.quad 0x3f353f35bf353f35,0xbf35bf353f35bf35,0x3e483f7bbf553f0e,0x3f0ebf553f7b3e48,0xbec43f6dbf6d3ec4,0x3f6d3ec43ec43f6d,0xbf553f0ebf7b3e48,0xbe483f7bbf0e3f55
.quad 0x3f8000003f800000,0x3f8000003f800000,0xbf0e3f55be483f7b,0xbf7b3e48bf553f0e,0xbec4bf6dbf6dbec4,0x3f6dbec43ec4bf6d,0x3f7b3e483f0ebf55,0xbf553f0e3e483f7b
.quad 0xbf353f353f353f35,0x3f35bf35bf35bf35,0xbe48bf7bbf553f0e,0xbf0e3f553f7b3e48,0x3f6d3ec4bec4bf6d,0x3ec4bf6dbf6d3ec4,0xbf553f0e3f7bbe48,0xbe483f7b3f0ebf55
.quad 0xa731bf80261f3f80,0xa742bf80a68d3f80,0x3f553f0ebf7bbe48,0x3e483f7bbf0ebf55,0xbf6d3ec43ec4bf6d,0xbec4bf6d3f6d3ec4,0x3e48bf7b3f553f0e,0x3f0e3f55bf7b3e48
.quad 0x3f353f35bf353f35,0xbf35bf353f35bf35,0xbf7b3e48bf0ebf55,0x3f553f0ebe483f7b,0x3ec4bf6d3f6dbec4,0xbf6dbec4bec4bf6d,0x3f0e3f553e483f7b,0x3f7b3e483f553f0e
.quad 0x3f8000003f800000,0x3f8000003f800000,0xbf55bf0ebf7bbe48,0xbe48bf7bbf0ebf55,0x3ec43f6d3f6d3ec4,0xbf6d3ec4bec43f6d,0x3e48bf7bbf55bf0e,0x3f0e3f553f7bbe48
.quad 0xbf353f353f353f35,0x3f35bf35bf35bf35,0x3f7bbe48bf0ebf55,0xbf55bf0ebe483f7b,0xbf6dbec43ec43f6d,0xbec43f6d3f6dbec4,0x3f0e3f55be48bf7b,0x3f7b3e48bf55bf0e
.quad 0xa754bf80a6543f80,0xa765bf80a60d3f80,0xbf0e3f553e48bf7b,0xbf7b3e483f55bf0e,0x3f6dbec4bec43f6d,0x3ec43f6dbf6dbec4,0xbf7bbe483f0ebf55,0x3f55bf0e3e483f7b
.quad 0x3f353f35bf353f35,0xbf35bf353f35bf35,0xbe48bf7b3f55bf0e,0xbf0e3f55bf7bbe48,0xbec43f6dbf6d3ec4,0x3f6d3ec43ec43f6d,0x3f55bf0e3f7bbe48,0x3e48bf7b3f0ebf55
.quad 0x3f8000003f800000,0x3f8000003f800000,0x3f0ebf553e48bf7b,0x3f7bbe483f55bf0e,0xbec4bf6dbf6dbec4,0x3f6dbec43ec4bf6d,0xbf7bbe48bf0e3f55,0x3f55bf0ebe48bf7b
.quad 0xbf353f353f353f35,0x3f35bf35bf35bf35,0x3e483f7b3f55bf0e,0x3f0ebf55bf7bbe48,0x3f6d3ec4bec4bf6d,0x3ec4bf6dbf6d3ec4,0x3f55bf0ebf7b3e48,0x3e48bf7bbf0e3f55
.quad 0xa777bf80a58e3f80,0xa784bf80a1373f80,0xbf55bf0e3f7b3e48,0xbe48bf7b3f0e3f55,0xbf6d3ec43ec4bf6d,0xbec4bf6d3f6d3ec4,0xbe483f7bbf55bf0e,0xbf0ebf553f7bbe48
.quad 0x3f353f35bf353f35,0xbf35bf353f35bf35,0x3f7bbe483f0e3f55,0xbf55bf0e3e48bf7b,0x3ec4bf6d3f6dbec4,0xbf6dbec4bec4bf6d,0xbf0ebf55be48bf7b,0xbf7bbe48bf55bf0e
.quad 0x3f7ffb113f800000,0x3f7fd3973f7fec43,0x3f7fd3973f800000,0x3f7e70b03f7f4e6d,0x3f7f84ab3f800000,0x3f7baccd3f7e1324,0x3f7f0e583f800000,0x3f778bc53f7c3b28
.quad 0x3f7e70b03f800000,0x3f7213523f79c79d,0x3f7dabcc3f800000,0x3f6b4b0c3f76ba07,0x3f7cbfc93f800000,0x3f633c5a3f731447,0x3f7baccd3f800000,0x3f59f26a3f6ed89e
.quad 0x3f7a73023f800000,0x3f4f7a1f3f6a09a7,0x3f7912983f800000,0x3f43e2003f64aa59,0x3f778bc53f800000,0x3f373a233f5ebe05,0x3f75dec63f800000,0x3f2994153f584853
.quad 0x3f740bdd3f800000,0x3f1b02c63f514d3d,0x3f7213523f800000,0x3f0b9a6b3f49d112,0x3f6ff5733f800000,0x3ef6e0cb3f41d870,0x3f6db2933f800000,0x3ed536413f396842
.quad 0x3f7f84ab3f7fb10f,0x3f7f0e583f7f4e6d,0x3f7baccd3f7d3aac,0x3f778bc53f79c79d,0x3f740bdd3f7853f8,0x3f68bf3c3f6ed89e,0x3f68bf3c3f710908,0x3f5318493f5ebe05
.quad 0x3f59f26a3f676bd8,0x3f373a233f49d112,0x3f47de653f5b941a,0x3f15f6d93f3085bb,0x3f32c8c93f4d9f02,0x3ee0924f3f13682a,0x3f1b02c63f3daef9,0x3e8e9a223ee63375
.quad 0x3f00e7e43f2beb4a,0x3de1bc2e3ea09ae5,0x3ec9b9533f187fc0,0xbd7b2b743e2f10a2,0x3e8e9a223f039c3d,0xbe6c9a7f3cc90ab0,0x3e22abb63edae880,0xbec9b953bdfab273
.quad 0x3d16c32c3eac7cd4,0xbf0b9a6bbe888e93,0xbdafb6803e78cfcc,0xbf2e3bdebecf7bca,0xbe5415013e164083,0xbf4bbbf8bf08f59b,0xbea68f123d48fb30,0xbf633c5abf273656
.quad 0x3f7e70b03f7ec46d,0x3f7dabcc3f7e1324,0x3f7213523f74fa0b,0x3f6b4b0c3f6ed89e,0x3f59f26a3f61c598,0x3f47de653f514d3d,0x3f373a233f45e403,0x3f15f6d93f273656
.quad 0x3f0b9a6b3f226799,0x3eb263ef3ee63375,0x3eb263ef3ef15aea,0x3dafb6803e605c13,0x3e09cf863e94a031,0xbe3b6ecfbcc90ab0,0xbdafb6803dc8bd36,0xbee0924fbe888e93
.quad 0xbe9aa086bdc8bd36,0xbf299415befc5d27,0xbf00e7e4be94a031,0xbf5695e5bf3085bb,0xbf2e3bdebef15aea,0xbf740bddbf584853,0xbf531849bf226799,0xbf7fd397bf731447
.quad 0xbf6db293bf45e403,0xbf791298bf7f4e6d,0xbf7cbfc9bf61c598,0xbf604621bf7c3b28,0xbf7f84abbf74fa0b,0xbf373a23bf6a09a7,0xbf75dec6bf7ec46d,0xbf00e7e4bf49d112
.quad 0x3f7cbfc93f7d3aac,0x3f7baccd3f7c3b28,0x3f633c5a3f676bd8,0x3f59f26a3f5ebe05,0x3f32c8c93f3daef9,0x3f1b02c63f273656,0x3ee0924f3f039c3d,0x3e8e9a223eb8442a
.quad 0x3e09cf863e78cfcc,0xbdafb6803cc90ab0,0xbe3b6ecfbd48fb30,0xbee0924fbea09ae5,0xbef6e0cbbeac7cd4,0xbf3b8f3bbf1d7fd1,0xbf3b8f3bbf187fc0,0xbf6db293bf584853
.quad 0xbf68bf3cbf4d9f02,0xbf7ffb11bf79c79d,0xbf7e70b0bf710908,0xbf6ff573bf7e1324,0xbf7a7302bf7fb10f,0xbf3fc767bf64aa59,0xbf5d2d53bf7853f8,0xbeebcbbbbf3085bb
.quad 0xbf299415bf5b941a,0xbde1bc2ebecf7bca,0xbec9b953bf2beb4a,0x3e827dc0bd96a905,0xbdafb680bedae880,0x3f15f6d93e888e93,0x3e6c9a7fbe164083,0x3f5695e53f13682a
.quad 0x3c490e9000000000,0x3d16c32c3cc90ab0,0x3d16c32c00000000,0x3de1bc2e3d96a905,0x3d7b2b7400000000,0x3e3b6ecf3dfab273,0x3dafb68000000000,0x3e827dc03e2f10a2
.quad 0x3de1bc2e00000000,0x3ea68f123e605c13,0x3e09cf8600000000,0x3ec9b9533e888e93,0x3e22abb600000000,0x3eebcbbb3ea09ae5,0x3e3b6ecf00000000,0x3f064b823eb8442a
.quad 0x3e54150100000000,0x3f15f6d93ecf7bca,0x3e6c9a7f00000000,0x3f24d2253ee63375,0x3e827dc000000000,0x3f32c8c93efc5d27,0x3e8e9a2200000000,0x3f3fc7673f08f59b
.quad 0x3e9aa08600000000,0x3f4bbbf83f13682a,0x3ea68f1200000000,0x3f5695e53f1d7fd1,0x3eb263ef00000000,0x3f6046213f273656,0x3ebe1d4a00000000,0x3f68bf3c3f3085bb
.quad 0x3d7b2b743d48fb30,0x3dafb6803d96a905,0x3e3b6ecf3e164083,0x3e827dc03e605c13,0x3e9aa0863e78cfcc,0x3ed536413eb8442a,0x3ed536413eac7cd4,0x3f10d3cd3efc5d27
.quad 0x3f064b823edae880,0x3f32c8c93f1d7fd1,0x3f1ff6cb3f039c3d,0x3f4f7a1f3f396842,0x3f373a233f187fc0,0x3f660f883f514d3d,0x3f4bbbf83f2beb4a,0x3f75dec63f64aa59
.quad 0x3f5d2d533f3daef9,0x3f7e70b03f731447,0x3f6b4b0c3f4d9f02,0x3f7f84ab3f7c3b28,0x3f75dec63f5b941a,0x3f7912983f7fec43,0x3f7cbfc93f676bd8,0x3f6b4b0c3f7e1324
.quad 0x3f7fd3973f710908,0x3f5695e53f76ba07,0x3f7f0e583f7853f8,0x3f3b8f3b3f6a09a7,0x3f7a73023f7d3aac,0x3f1b02c63f584853,0x3f7213523f7fb10f,0x3eebcbbb3f41d870
.quad 0x3de1bc2e3dc8bd36,0x3e09cf863dfab273,0x3ea68f123e94a031,0x3ec9b9533eb8442a,0x3f064b823ef15aea,0x3f1ff6cb3f13682a,0x3f32c8c93f226799,0x3f4f7a1f3f41d870
.quad 0x3f5695e53f45e403,0x3f6ff5733f64aa59,0x3f6ff5733f61c598,0x3f7f0e583f79c79d,0x3f7dabcc3f74fa0b,0x3f7baccd3f7fec43,0x3f7f0e583f7ec46d,0x3f660f883f76ba07
.quad 0x3f740bdd3f7ec46d,0x3f3fc7673f5ebe05,0x3f5d2d533f74fa0b,0x3f0b9a6b3f396842,0x3f3b8f3b3f61c598,0x3e9aa0863f08f59b,0x3f10d3cd3f45e403,0x3d16c32c3ea09ae5
.quad 0x3ebe1d4a3f226799,0xbe6c9a7f3d96a905,0x3e22abb63ef15aea,0xbef6e0cbbe2f10a2,0xbd7b2b743e94a031,0xbf32c8c9becf7bca,0xbe8e9a223dc8bd36,0xbf5d2d53bf1d7fd1
.quad 0x3e22abb63e164083,0x3e3b6ecf3e2f10a2,0x3eebcbbb3edae880,0x3f064b823efc5d27,0x3f373a233f2beb4a,0x3f4bbbf83f41d870,0x3f660f883f5b941a,0x3f75dec63f6ed89e
.quad 0x3f7dabcc3f7853f8,0x3f7f0e583f7fec43,0x3f7baccd3f7fb10f,0x3f660f883f731447,0x3f6046213f710908,0x3f2e3bde3f49d112,0x3f2e3bde3f4d9f02,0x3ebe1d4a3f08f59b
.quad 0x3ed536413f187fc0,0x3c490e903e605c13,0x3de1bc2e3eac7cd4,0xbeb263efbdfab273,0xbe5415013d48fb30,0xbf299415bee63375,0xbf00e7e4be78cfcc,0xbf633c5abf396842
.quad 0xbf3fc767bf039c3d,0xbf7e70b0bf6a09a7,0xbf6b4b0cbf3daef9,0xbf778bc5bf7f4e6d,0xbf7f0e58bf676bd8,0xbf4f7a1fbf76ba07,0xbf791298bf7d3aac,0xbf0b9a6bbf514d3d
.quad 0x3600000036000000,0x3600000036000000,0x35ffd39735fffb11,0x35ff0e5835ff84ab,0x35ff4e6d35ffec43,0x35fc3b2835fe1324,0x35fe70b035ffd397,0x35f78bc535fbaccd
.quad 0x35fd3aac35ffb10f,0x35f1090835f853f8,0x35fbaccd35ff84ab,0x35e8bf3c35f40bdd,0x35f9c79d35ff4e6d,0x35debe0535eed89e,0x35f78bc535ff0e58,0x35d3184935e8bf3c
.quad 0x35f4fa0b35fec46d,0x35c5e40335e1c598,0x35f2135235fe70b0,0x35b73a2335d9f26a,0x35eed89e35fe1324,0x35a7365635d14d3d,0x35eb4b0c35fdabcc,0x3595f6d935c7de65
.quad 0x35e76bd835fd3aac,0x35839c3d35bdaef9,0x35e33c5a35fcbfc9,0x3560924f35b2c8c9,0x35debe0535fc3b28,0x3538442a35a73656,0x35d9f26a35fbaccd,0x350e9a22359b02c6
.quad 0x3600000036000000,0x3600000036000000,0x35fdabcc35fe70b0,0x35fbaccd35fcbfc9,0x35f6ba0735f9c79d,0x35eed89e35f31447,0x35eb4b0c35f21352,0x35d9f26a35e33c5a
.quad 0x35db941a35e76bd8,0x35bdaef935cd9f02,0x35c7de6535d9f26a,0x359b02c635b2c8c9,0x35b085bb35c9d112,0x356633753593682a,0x3595f6d935b73a23,0x350e9a223560924f
.quad 0x35715aea35a26799,0x3448bd363514a031,0x353263ef358b9a6b,0xb42fb6803489cf86,0x34e05c1335663375,0xb5088e93b3490ab0,0x342fb680353263ef,0xb560924fb4bb6ecf
.quad 0xb3c8fb3034f8cfcc,0xb5987fc0b52c7cd4,0xb4bb6ecf3489cf86,0xb5bb8f3bb576e0cb,0xb5209ae533490ab0,0xb5d84853b59d7fd1,0xb560924fb42fb680,0xb5edb293b5bb8f3b
.quad 0x3600000036000000,0x3600000036000000,0x35f9129835fa7302,0x35f5dec635f78bc5,0x35e4aa5935ea09a7,0x35d8485335debe05,0x35c3e20035cf7a1f,0x35a9941535b73a23
.quad 0x35987fc035abeb4a,0x355ae88035839c3d,0x3549b9533580e7e4,0x34a2abb6350e9a22,0x34af10a235209ae5,0xb47ab27333490ab0,0xb3fb2b743461bc2e,0xb549b953b4ec9a7f
.quad 0xb514a031b448bd36,0xb5a26799b5715aea,0xb580e7e4b51aa086,0xb5d31849b5ae3bde,0xb5b085bbb57c5d27,0xb5f31447b5d84853,0xb5d695e5b5a99415,0xb5ffd397b5f40bdd
.quad 0xb5f10908b5cd9f02,0xb5f853f8b5ffb10f,0xb5fe70b0b5e8bf3c,0xb5dd2d53b5fa7302,0xb5fe1324b5f9c79d,0xb5b085bbb5e4aa59,0xb5eff573b5fffb11,0xb56bcbbbb5bfc767
.quad 0x3600000036000000,0x3600000036000000,0x35f2135235f40bdd,0x35edb29335eff573,0x35c9d11235d14d3d,0x35b9684235c1d870,0x358b9a6b359b02c6,0x355536413576e0cb
.quad 0x34f8cfcc352c7cd4,0x33c8fb3034964083,0xb42fb6803396c32c,0xb5268f12b4d41501,0xb54f7bcab5088e93,0xb5a73656b588f59b,0xb5ae3bdeb58b9a6b,0xb5e33c5ab5cbbbf8
.quad 0xb5e1c598b5c5e403,0xb5fec46db5f4fa0b,0xb5fcbfc9b5edb293,0xb5f5dec6b5ff84ab,0xb5fc3b28b5ff4e6d,0xb5c9d112b5ea09a7,0xb5e04621b5f91298,0xb580e7e4b5b73a23
.quad 0xb5abeb4ab5db941a,0xb4964083b55ae880,0xb549b953b5a99415,0x34ec9a7fb42fb680,0xb416a905b54f7bca,0x3593682a35088e93,0x35027dc0b461bc2e,0x35d695e53595f6d9
.quad 0x0,0x0,0x3396c32c32c90e90,0x342fb68033fb2b74,0x3416a90533490ab0,0x34af10a2347ab273,0x3461bc2e3396c32c,0x35027dc034bb6ecf
.quad 0x3496408333c8fb30,0x352c7cd434f8cfcc,0x34bb6ecf33fb2b74,0x35553641351aa086,0x34e05c133416a905,0x357c5d273538442a,0x35027dc0342fb680,0x3590d3cd35553641
.quad 0x3514a0313448bd36,0x35a2679935715aea,0x35268f123461bc2e,0x35b2c8c935864b82,0x3538442a347ab273,0x35c1d8703593682a,0x3549b9533489cf86,0x35cf7a1f359ff6cb
.quad 0x355ae88034964083,0x35db941a35abeb4a,0x356bcbbb34a2abb6,0x35e60f8835b73a23,0x357c5d2734af10a2,0x35eed89e35c1d870,0x35864b8234bb6ecf,0x35f5dec635cbbbf8
.quad 0x0,0x0,0x3489cf863461bc2e,0x34bb6ecf34a2abb6,0x35088e9334e05c13,0x3538442a35209ae5,0x3549b95335268f12,0x35864b82356bcbbb
.quad 0x35839c3d355ae880,0x35abeb4a35987fc0,0x359ff6cb35864b82,0x35cbbbf835b73a23,0x35b96842359d7fd1,0x35e4aa5935d14d3d,0x35cf7a1f35b2c8c9,0x35f5dec635e60f88
.quad 0x35e1c59835c5e403,0x35fec46d35f4fa0b,0x35eff57335d695e5,0x35ff0e5835fdabcc,0x35f9c79d35e4aa59,0x35f6ba0735ffec43,0x35ff0e5835eff573,0x35e60f8835fbaccd
.quad 0x35ffb10f35f853f8,0x35cd9f0235f10908,0x35fbaccd35fdabcc,0x35ae3bde35e04621,0x35f3144735ffec43,0x3588f59b35c9d112,0x35e60f8835ff0e58,0x353e1d4a35ae3bde
.quad 0x0,0x0,0x34ec9a7f34d41501,0x350e9a2235027dc0,0x35663375354f7bca,0x3588f59b357c5d27,0x35a4d2253595f6d9,0x35bfc76735b2c8c9
.quad 0x35cd9f0235bdaef9,0x35e76bd835db941a,0x35eb4b0c35dd2d53,0x35fcbfc935f5dec6,0x35fc3b2835f31447,0x35fe132435ffec43,0x35ff84ab35fe70b0,0x35eb4b0c35f91298
.quad 0x35f4fa0b35fec46d,0x35c5e40335e1c598,0x35dd2d5335f40bdd,0x3590d3cd35bb8f3b,0x35b9684235debe05,0x35209ae53588f59b,0x358b9a6b35bfc767,0x3396c32c351aa086
.quad 0x352c7cd435987fc0,0xb4f8cfcc33c8fb30,0x3461bc2e35553641,0xb580e7e4b4d41501,0xb47ab27334e05c13,0xb5b96842b5663375,0xb53263ef32c90e90,0xb5e33c5ab5a99415
.quad 0x0,0x0,0x35268f12351aa086,0x353e1d4a353263ef,0x359d7fd13593682a,0x35b085bb35a73656,0x35d695e535cbbbf8,0x35e8bf3c35e04621
.quad 0x35f853f835f10908,0x35ffb10f35fd3aac,0x35ff0e5835ffd397,0x35f2135235fa7302,0x35ea09a735f6ba07,0x35c1d87035d84853,0x35bb8f3b35d695e5,0x356bcbbb359b02c6
.quad 0x35715aea35a26799,0x3448bd363514a031,0x34a2abb6353e1d4a,0xb50e9a22b3fb2b74,0xb4af10a23416a905,0xb59d7fd1b54f7bca,0xb576e0cbb4ec9a7f,0xb5dd2d53b5b2c8c9
.quad 0xb5bdaef9b5839c3d,0xb5fd3aacb5e76bd8,0xb5eb4b0cb5bfc767,0xb5f91298b5ff0e58,0xb5ff4e6db5ea09a7,0xb5d14d3db5f6ba07,0xb5f78bc5b5fe70b0,0xb58b9a6bb5cf7a1f
.quad 0x3e793f7800003f80,0x3f2c3f3e3ef13f62,0x3f183f4e00003f80,0x3f71beac3f753e95,0x3f5c3f0400003f80,0x3d49bf803f62bef1,0x3f7d3e1600003f80,0xbf67bedb3e95bf75
.quad 0x3f78be7900003f80,0xbf3e3f2cbef1bf62,0x3f4ebf1800003f80,0x3eac3f71bf75be95,0x3f04bf5c00003f80,0x3f803d49bf623ef1,0x3e16bf7d00003f80,0x3edbbf67be953f75
.quad 0xbe79bf7800003f80,0xbf2cbf3e3ef13f62,0xbf18bf4e00003f80,0xbf713eac3f753e95,0xbf5cbf0400003f80,0xbd493f803f62bef1,0xbf7dbe1600003f80,0x3f673edb3e95bf75
.quad 0xbf783e7900003f80,0x3f3ebf2cbef1bf62,0xbf4e3f1800003f80,0xbeacbf71bf75be95,0xbf043f5c00003f80,0xbf80bd49bf623ef1,0xbe163f7d00003f80,0xbedb3f67be953f75
.quad 0x3f713eac3f553f0e,0x3f7dbe163f7f3dc9,0xbd49bf803f0ebf55,0xbf78be79bf22bf46,0xbf673edbbf55bf0e,0x3f4e3f18bdc93f7f,0x3f3e3f2cbf0e3f55,0xbf04bf5c3f46bf22
.quad 0x3eacbf713f553f0e,0x3e163f7dbf7fbdc9,0xbf803d493f0ebf55,0x3e79bf783f223f46,0x3edb3f67bf55bf0e,0xbf183f4e3dc9bf7f,0x3f2cbf3ebf0e3f55,0x3f5cbf04bf463f22
.quad 0xbf71beac3f553f0e,0xbf7d3e163f7f3dc9,0x3d493f803f0ebf55,0x3f783e79bf22bf46,0x3f67bedbbf55bf0e,0xbf4ebf18bdc93f7f,0xbf3ebf2cbf0e3f55,0x3f043f5c3f46bf22
.quad 0xbeac3f713f553f0e,0xbe16bf7dbf7fbdc9,0x3f80bd493f0ebf55,0xbe793f783f223f46,0xbedbbf67bf55bf0e,0x3f18bf4e3dc9bf7f,0xbf2c3f3ebf0e3f55,0xbf5c3f04bf463f22
.quad 0x3f4ebf183f6dbec4,0x3edbbf673f22bf46,0xbf043f5cbf6d3ec4,0x3f2c3f3e3dc93f7f,0x3e16bf7d3f6dbec4,0xbf713eacbf46bf22,0x3e793f78bf6d3ec4,0x3d49bf803f7fbdc9
.quad 0xbf18bf4e3f6dbec4,0x3f673edbbf223f46,0x3f5c3f04bf6d3ec4,0xbf3e3f2cbdc9bf7f,0xbf7dbe163f6dbec4,0xbeacbf713f463f22,0x3f78be79bf6d3ec4,0x3f803d49bf7f3dc9
.quad 0xbf4e3f183f6dbec4,0xbedb3f673f22bf46,0x3f04bf5cbf6d3ec4,0xbf2cbf3e3dc93f7f,0xbe163f7d3f6dbec4,0x3f71beacbf46bf22,0xbe79bf78bf6d3ec4,0xbd493f803f7fbdc9
.quad 0x3f183f4e3f6dbec4,0xbf67bedbbf223f46,0xbf5cbf04bf6d3ec4,0x3f3ebf2cbdc9bf7f,0x3f7d3e163f6dbec4,0x3eac3f713f463f22,0xbf783e79bf6d3ec4,0xbf80bd49bf7f3dc9
.quad 0xbd49bf803e48bf7b,0xbf04bf5cbe95bf75,0x3f67bedb3f7b3e48,0xbe16bf7d3ef1bf62,0x3f3e3f2cbe483f7b,0x3e79bf783f75be95,0xbeac3f71bf7bbe48,0x3f18bf4e3f623ef1
.quad 0xbf803d493e48bf7b,0x3f5cbf043e953f75,0xbedbbf673f7b3e48,0x3f7dbe16bef13f62,0x3f2cbf3ebe483f7b,0x3f783e79bf753e95,0x3f713eacbf7bbe48,0x3f4e3f18bf62bef1
.quad 0x3d493f803e48bf7b,0x3f043f5cbe95bf75,0xbf673edb3f7b3e48,0x3e163f7d3ef1bf62,0xbf3ebf2cbe483f7b,0xbe793f783f75be95,0x3eacbf71bf7bbe48,0xbf183f4e3f623ef1
.quad 0x3f80bd493e48bf7b,0xbf5c3f043e953f75,0x3edb3f673f7b3e48,0xbf7d3e16bef13f62,0xbf2c3f3ebe483f7b,0xbf78be79bf753e95,0xbf71beacbf7bbe48,0xbf4ebf18bf62bef1
.quad 0x3f78be793f808000,0x3f3ebf2c3f62bef1,0x3f4ebf183f808000,0xbeacbf713e95bf75,0x3f04bf5c3f808000,0xbf80bd49bef1bf62,0x3e16bf7d3f808000,0xbedb3f67bf75be95
.quad 0xbe79bf783f808000,0x3f2c3f3ebf623ef1,0xbf18bf4e3f808000,0x3f71beacbe953f75,0xbf5cbf043f808000,0x3d49bf803ef13f62,0xbf7dbe163f808000,0xbf67bedb3f753e95
.quad 0xbf783e793f808000,0xbf3e3f2c3f62bef1,0xbf4e3f183f808000,0x3eac3f713e95bf75,0xbf043f5c3f808000,0x3f803d49bef1bf62,0xbe163f7d3f808000,0x3edbbf67bf75be95
.quad 0x3e793f783f808000,0xbf2cbf3ebf623ef1,0x3f183f4e3f808000,0xbf713eacbe953f75,0x3f5c3f043f808000,0xbd493f803ef13f62,0x3f7d3e163f808000,0x3f673edb3f753e95
.quad 0x3eacbf713f0ebf55,0xbe16bf7d3dc9bf7f,0xbf803d49bf55bf0e,0xbe793f78bf463f22,0x3edb3f67bf0e3f55,0x3f18bf4e3f7f3dc9,0x3f2cbf3e3f553f0e,0xbf5c3f04bf22bf46
.quad 0xbf71beac3f0ebf55,0x3f7dbe16bdc93f7f,0x3d493f80bf55bf0e,0xbf78be793f46bf22,0x3f67bedbbf0e3f55,0x3f4e3f18bf7fbdc9,0xbf3ebf2c3f553f0e,0xbf04bf5c3f223f46
.quad 0xbeac3f713f0ebf55,0x3e163f7d3dc9bf7f,0x3f80bd49bf55bf0e,0x3e79bf78bf463f22,0xbedbbf67bf0e3f55,0xbf183f4e3f7f3dc9,0xbf2c3f3e3f553f0e,0x3f5cbf04bf22bf46
.quad 0x3f713eac3f0ebf55,0xbf7d3e16bdc93f7f,0xbd49bf80bf55bf0e,0x3f783e793f46bf22,0xbf673edbbf0e3f55,0xbf4ebf18bf7fbdc9,0x3f3e3f2c3f553f0e,0x3f043f5c3f223f46
.quad 0xbf18bf4ebec4bf6d,0xbf67bedbbf46bf22,0x3f5c3f043ec43f6d,0x3f3ebf2c3f7fbdc9,0xbf7dbe16bec4bf6d,0x3eac3f71bf223f46,0x3f78be793ec43f6d,0xbf80bd49bdc9bf7f
.quad 0xbf4e3f18bec4bf6d,0x3edbbf673f463f22,0x3f04bf5c3ec43f6d,0x3f2c3f3ebf7f3dc9,0xbe163f7dbec4bf6d,0xbf713eac3f22bf46,0xbe79bf783ec43f6d,0x3d49bf803dc93f7f
.quad 0x3f183f4ebec4bf6d,0x3f673edbbf46bf22,0xbf5cbf043ec43f6d,0xbf3e3f2c3f7fbdc9,0x3f7d3e16bec4bf6d,0xbeacbf71bf223f46,0xbf783e793ec43f6d,0x3f803d49bdc9bf7f
.quad 0x3f4ebf18bec4bf6d,0xbedb3f673f463f22,0xbf043f5c3ec43f6d,0xbf2cbf3ebf7f3dc9,0x3e16bf7dbec4bf6d,0x3f71beac3f22bf46,0x3e793f783ec43f6d,0xbd493f803dc93f7f
.quad 0xbf803d49bf7bbe48,0xbf5c3f04bf753e95,0xbedbbf673e48bf7b,0xbf7d3e16bf62bef1,0x3f2cbf3e3f7b3e48,0xbf78be79be95bf75,0x3f713eacbe483f7b,0xbf4ebf183ef1bf62
.quad 0x3d493f80bf7bbe48,0xbf04bf5c3f75be95,0xbf673edb3e48bf7b,0xbe16bf7d3f623ef1,0xbf3ebf2c3f7b3e48,0x3e79bf783e953f75,0x3eacbf71be483f7b,0x3f18bf4ebef13f62
.quad 0x3f80bd49bf7bbe48,0x3f5cbf04bf753e95,0x3edb3f673e48bf7b,0x3f7dbe16bf62bef1,0xbf2c3f3e3f7b3e48,0x3f783e79be95bf75,0xbf71beacbe483f7b,0x3f4e3f183ef1bf62
.quad 0xbd49bf80bf7bbe48,0x3f043f5c3f75be95,0x3f67bedb3e48bf7b,0x3e163f7d3f623ef1,0x3f3e3f2c3f7b3e48,0xbe793f783e953f75,0xbeac3f71be483f7b,0xbf183f4ebef13f62
.quad 0x80003f8080003f80,0x80003f8080003f80,0xbf183f4ebe793f78,0xbf7d3e16bf5c3f04,0xbf753e95bef13f62,0xbe95bf75bf62bef1,0xbf71beacbf2c3f3e,0x3f67bedbbd49bf80
.quad 0xbf0ebf55bf553f0e,0x3f0e3f553f55bf0e,0x3d49bf80bf713eac,0xbf3e3f2c3f673edb,0x3f22bf46bf7f3dc9,0xbf46bf223dc93f7f,0x3f78be79bf7dbe16,0x3f04bf5cbf4e3f18
.quad 0x3f6d3ec4bf6dbec4,0x3f6d3ec4bf6dbec4,0x3f043f5cbf4ebf18,0xbe793f78be16bf7d,0xbdc93f7fbf22bf46,0xbf7fbdc93f46bf22,0xbf2c3f3ebedbbf67,0xbd49bf803f713eac
.quad 0xbf7b3e48be48bf7b,0x3f7bbe483e483f7b,0xbf67bedb3d49bf80,0x3eac3f71bf3e3f2c,0xbef1bf623e95bf75,0xbf623ef1bf75be95,0x3e16bf7d3f04bf5c,0xbf18bf4ebe79bf78
.quad 0x80003f8080003f80,0x80003f8080003f80,0xbf4ebf18bf78be79,0xbe16bf7dbf04bf5c,0x3f75be953ef1bf62,0x3e953f753f623ef1,0xbeac3f713f3e3f2c,0xbedbbf67bf803d49
.quad 0xbf0ebf55bf553f0e,0x3f0e3f553f55bf0e,0x3f803d49beacbf71,0xbf2cbf3ebedb3f67,0xbf223f463f7fbdc9,0x3f463f22bdc9bf7f,0xbe79bf78be163f7d,0xbf5cbf043f183f4e
.quad 0x3f6d3ec4bf6dbec4,0x3f6d3ec4bf6dbec4,0xbf5c3f043f18bf4e,0xbf78be793f7dbe16,0x3dc9bf7f3f223f46,0x3f7f3dc9bf463f22,0x3f3e3f2cbf673edb,0xbf803d493eacbf71
.quad 0xbf7b3e48be48bf7b,0x3f7bbe483e483f7b,0x3edbbf673f803d49,0xbf713eacbf2cbf3e,0x3ef13f62be953f75,0x3f62bef13f753e95,0xbf7dbe16bf5cbf04,0xbf4e3f18bf783e79
.quad 0x80003f8080003f80,0x80003f8080003f80,0x3f18bf4e3e79bf78,0x3f7dbe163f5cbf04,0xbf753e95bef13f62,0xbe95bf75bf62bef1,0x3f713eac3f2cbf3e,0xbf673edb3d493f80
.quad 0xbf0ebf55bf553f0e,0x3f0e3f553f55bf0e,0xbd493f803f71beac,0x3f3ebf2cbf67bedb,0x3f22bf46bf7f3dc9,0xbf46bf223dc93f7f,0xbf783e793f7d3e16,0xbf043f5c3f4ebf18
.quad 0x3f6d3ec4bf6dbec4,0x3f6d3ec4bf6dbec4,0xbf04bf5c3f4e3f18,0x3e79bf783e163f7d,0xbdc93f7fbf22bf46,0xbf7fbdc93f46bf22,0x3f2cbf3e3edb3f67,0x3d493f80bf71beac
.quad 0xbf7b3e48be48bf7b,0x3f7bbe483e483f7b,0x3f673edbbd493f80,0xbeacbf713f3ebf2c,0xbef1bf623e95bf75,0xbf623ef1bf75be95,0xbe163f7dbf043f5c,0x3f183f4e3e793f78
.quad 0x80003f8080003f80,0x80003f8080003f80,0x3f4e3f183f783e79,0x3e163f7d3f043f5c,0x3f75be953ef1bf62,0x3e953f753f623ef1,0x3eacbf71bf3ebf2c,0x3edb3f673f80bd49
.quad 0xbf0ebf55bf553f0e,0x3f0e3f553f55bf0e,0xbf80bd493eac3f71,0x3f2c3f3e3edbbf67,0xbf223f463f7fbdc9,0x3f463f22bdc9bf7f,0x3e793f783e16bf7d,0x3f5c3f04bf18bf4e
.quad 0x3f6d3ec4bf6dbec4,0x3f6d3ec4bf6dbec4,0x3f5cbf04bf183f4e,0x3f783e79bf7d3e16,0x3dc9bf7f3f223f46,0x3f7f3dc9bf463f22,0xbf3ebf2c3f67bedb,0x3f80bd49beac3f71
.quad 0xbf7b3e48be48bf7b,0x3f7bbe483e483f7b,0xbedb3f67bf80bd49,0x3f71beac3f2c3f3e,0x3ef13f62be953f75,0x3f62bef13f753e95,0x3f7d3e163f5c3f04,0x3f4ebf183f78be79
.quad 0x3f8000003f800000,0x3f8000003f800000,0x3f4e3f183f783e79,0x3e163f7d3f043f5c,0x3e953f753f623ef1,0xbf753e95bef13f62,0xbeac3f713f3e3f2c,0xbedbbf67bf803d49
.quad 0xbf553f0e3f0e3f55,0x3f55bf0ebf0ebf55,0xbf80bd493eac3f71,0x3f2c3f3e3edbbf67,0xbf46bf223dc93f7f,0xbf223f463f7fbdc9,0xbe79bf78be163f7d,0xbf5cbf043f183f4e
.quad 0x3ec4bf6dbec43f6d,0x3ec4bf6dbec43f6d,0x3f5cbf04bf183f4e,0x3f783e79bf7d3e16,0x3f7f3dc9bf463f22,0xbdc93f7fbf22bf46,0x3f3e3f2cbf673edb,0xbf803d493eacbf71
.quad 0x3e483f7bbf7b3e48,0xbe48bf7b3f7bbe48,0xbedb3f67bf80bd49,0x3f71beac3f2c3f3e,0xbf623ef1bf75be95,0x3ef13f62be953f75,0xbf7dbe16bf5cbf04,0xbf4e3f18bf783e79
.quad 0x3f8000003f800000,0x3f8000003f800000,0xbf183f4ebe793f78,0xbf7d3e16bf5c3f04,0xbe95bf75bf62bef1,0x3f75be953ef1bf62,0x3f713eac3f2cbf3e,0xbf673edb3d493f80
.quad 0xbf553f0e3f0e3f55,0x3f55bf0ebf0ebf55,0x3d49bf80bf713eac,0xbf3e3f2c3f673edb,0x3f463f22bdc9bf7f,0x3f22bf46bf7f3dc9,0xbf783e793f7d3e16,0xbf043f5c3f4ebf18
.quad 0x3ec4bf6dbec43f6d,0x3ec4bf6dbec43f6d,0x3f043f5cbf4ebf18,0xbe793f78be16bf7d,0xbf7fbdc93f46bf22,0x3dc9bf7f3f223f46,0x3f2cbf3e3edb3f67,0x3d493f80bf71beac
.quad 0x3e483f7bbf7b3e48,0xbe48bf7b3f7bbe48,0xbf67bedb3d49bf80,0x3eac3f71bf3e3f2c,0x3f62bef13f753e95,0xbef1bf623e95bf75,0xbe163f7dbf043f5c,0x3f183f4e3e793f78
.quad 0x3f8000003f800000,0x3f8000003f800000,0xbf4ebf18bf78be79,0xbe16bf7dbf04bf5c,0x3e953f753f623ef1,0xbf753e95bef13f62,0x3eacbf71bf3ebf2c,0x3edb3f673f80bd49
.quad 0xbf553f0e3f0e3f55,0x3f55bf0ebf0ebf55,0x3f803d49beacbf71,0xbf2cbf3ebedb3f67,0xbf46bf223dc93f7f,0xbf223f463f7fbdc9,0x3e793f783e16bf7d,0x3f5c3f04bf18bf4e
.quad 0x3ec4bf6dbec43f6d,0x3ec4bf6dbec43f6d,0xbf5c3f043f18bf4e,0xbf78be793f7dbe16,0x3f7f3dc9bf463f22,0xbdc93f7fbf22bf46,0xbf3ebf2c3f67bedb,0x3f80bd49beac3f71
.quad 0x3e483f7bbf7b3e48,0xbe48bf7b3f7bbe48,0x3edbbf673f803d49,0xbf713eacbf2cbf3e,0xbf623ef1bf75be95,0x3ef13f62be953f75,0x3f7d3e163f5c3f04,0x3f4ebf183f78be79
.quad 0x3f8000003f800000,0x3f8000003f800000,0x3f18bf4e3e79bf78,0x3f7dbe163f5cbf04,0xbe95bf75bf62bef1,0x3f75be953ef1bf62,0xbf71beacbf2c3f3e,0x3f67bedbbd49bf80
.quad 0xbf553f0e3f0e3f55,0x3f55bf0ebf0ebf55,0xbd493f803f71beac,0x3f3ebf2cbf67bedb,0x3f463f22bdc9bf7f,0x3f22bf46bf7f3dc9,0x3f78be79bf7dbe16,0x3f04bf5cbf4e3f18
.quad 0x3ec4bf6dbec43f6d,0x3ec4bf6dbec43f6d,0xbf04bf5c3f4e3f18,0x3e79bf783e163f7d,0xbf7fbdc93f46bf22,0x3dc9bf7f3f223f46,0xbf2c3f3ebedbbf67,0xbd49bf803f713eac
.quad 0x3e483f7bbf7b3e48,0xbe48bf7b3f7bbe48,0x3f673edbbd493f80,0xbeacbf713f3ebf2c,0x3f62bef13f753e95,0xbef1bf623e95bf75,0x3e16bf7d3f04bf5c,0xbf18bf4ebe79bf78
.quad 0x3f7ff84a3f800000,0x3f7fba9e3f7fe129,0x3f7fcbe23f800000,0x3f7e2b723f7f2f9d,0x3f7f78083f800000,0x3f7b3bab3f7de0b1,0x3f7efcc93f800000,0x3f76ef5b3f7bf531
.quad 0x3f7e5a383f800000,0x3f714c7a3f796e4e,0x3f7d906e3f800000,0x3f6a5ad93f764d97,0x3f7c9f8a3f800000,0x3f62241a3f7294f8,0x3f7b87b23f800000,0x3f58b3a13f6e46be
.quad 0x3f7a49103f800000,0x3f4e16893f696591,0x3f78e3d63f800000,0x3f425b893f63f473,0x3f77583a3f800000,0x3f3592e73f5df6be,0x3f75a67b3f800000,0x3f27ce613f577026
.quad 0x3f73ced93f800000,0x3f19210f3f5064af,0x3f71d19f3f800000,0x3f099f4e3f48d8b3,0x3f6faf1b3f800000,0x3ef2bd433f40d0da,0x3f6d67a13f800000,0x3ed0eb2a3f385216
.quad 0x3f7f3f543f7f84ab,0x3f7e868b3f7eea9d,0x3f7aed373f7cbfc9,0x3f76167a3f78b47b,0x3f72d4eb3f778bc5,0x3f6667713f6d1c1d,0x3f6715993f6ff573,0x3f4fefa83f5c61c7
.quad 0x3f57dc7f3f660f88,0x3f33587a3f46e22a,0x3f4564393f59f26a,0x3f11796b3f2d1469,0x3f2ff3e63f4bbbf8,0x3ed6a3993f0f8784,0x3f17de123f3b8f3b,0x3e8402703eddbe79
.quad 0x3efafef73f299415,0x3db5f8da3e97a117,0x3ec27b553f15f6d9,0xbda973ba3e1c76de,0x3e870ada3f00e7e4,0xbe80f8c03bc90f88,0x3e1324ca3ed53641,0xbed3c867be1008b7
.quad 0x3cafea693ea68f12,0xbf102dd5be919ddd,0xbdcefdb73e6c9a7f,0xbf3238aabed8106b,0xbe636c833e09cf86,0xbf4f0417bf0cead0,0xbeadf73c3d16c32c,0xbf65b710bf2ac082
.quad 0x3f7d906e3f7e1324,0x3f7c5d3a3f7cfe73,0x3f6faf1b3f731447,0x3f67c1873f6be858,0x3f5627fe3f5ebe05,0x3f425b893f4cae79,0x3f3238aa3f41d870,0x3f0ee0db3f212ff9
.quad 0x3f05a02c3f1d7fd1,0x3ea218873ed8106b,0x3ea5129f3ee63375,0x3d55880e3e419b37,0x3ddb7d373e888e93,0xbe5d4b1abd621469,0xbde7fa9a3d96a905,0xbeeff7fbbe97a117
.quad 0xbea80b1fbdfab273,0xbf2ff3e6bf04f484,0xbf06f686bea09ae5,0xbf5b2c79bf36206c,0xbf33587abefc5d27,0xbf76841bbf5c61c7,0xbf570348bf273656,0xbf7fffb1bf756d97
.quad 0xbf703b37bf49d112,0xbf76ef5bbf7fc38f,0xbf7dc68cbf64aa59,0xbf5bfb34bf7ac516,0xbf7efcc9bf76ba07,0xbf311722bf66becc,0xbf73ced9bf7f4e6d,0xbef2bd43bf44e3f5
.quad 0x3f7aed373f7baccd,0x3f7940c03f7a1e84,0x3f5e5aa63f633c5a,0x3f5389c73f591e6a,0x3f2b561b3f373a23,0x3f11796b3f1ebc12,0x3ece0bea3ef6e0cb,0x3e6fa8b23ea395c5
.quad 0x3dc27c393e541501,0xbe06b26ebc96c9b6,0xbe636c83bdafb680,0xbef58035beb554ec,0xbf044889bebe1d4a,0xbf436051bf26050a,0xbf425b89bf1ff6cb,0xbf71d19fbf5df6be
.quad 0xbf6cd007bf531849,0xbf7fdaafbf7bf531,0xbf7f5ce9bf740bdd,0xbf6b99fbbf7c7eb0,0xbf7822d1bf7ffb11,0xbf37c655bf5f8327,0xbf57dc7fbf75dec6,0xbed6a399bf286605
.quad 0xbf21cbfbbf5695e5,0xbd83db0abebb31a0,0xbeb6ccc3bf24d225,0x3e9920febcfb49ba,0xbd3c6dd5bec9b953,0x3f1f599f3e9d9e78,0x3e8a11f7bde1bc2e,0x3f5cc7d13f1c420c
.quad 0x3c7b514b00000000,0x3d3c6dd53cfb49ba,0x3d2351cb00000000,0x3df475c03da3308c,0x3d83db0a00000000,0x3e44b0b93e039502,0x3db5f8da00000000,0x3e870ada3e354098
.quad 0x3de7fa9a00000000,0x3eab02013e667c66,0x3e0cec4a00000000,0x3ece0bea3e8b9507,0x3e25c58c00000000,0x3eeff7fb3ea395c5,0x3e3e853e00000000,0x3f084b923ebb31a0
.quad 0x3e57278f00000000,0x3f17de123ed25a09,0x3e6fa8b200000000,0x3f269de33ee900b7,0x3e84027000000000,0x3f34768f3eff17b2,0x3e901c2c00000000,0x3f4154e13f0a48ad
.quad 0x3e9c1faf00000000,0x3f4d26fd3f14b039,0x3ea80b1f00000000,0x3f57dc7f3f1ebc12,0x3eb3dca500000000,0x3f61668a3f286605,0x3ebf926f00000000,0x3f69b7e43f31a81d
.quad 0x3d9cecf93d7b2b74,0x3ddb7d373dbc3ac3,0x3e4ada4f3e22abb6,0x3e8d17c03e72b651,0x3ea218873e827dc0,0x3edf28a93ec1071e,0x3edc53c13eb263ef,0x3f1553b73f0242b1
.quad 0x3f099f4e3ee0924f,0x3f36ad7f3f212ff9,0x3f2302d33f064b82,0x3f52a6493f3ca003,0x3f39f2ac3f1b02c6,0x3f686b393f53fac3,0x3f4e16893f2e3bde,0x3f77583a3f66becc
.quad 0x3f5f20db3f3fc767,0x3f7efcc93f748422,0x3f6cd0073f4f7a1f,0x3f7f1f493f7cfe73,0x3f76ef5b3f5d2d53,0x3f77beb73f7ffec4,0x3f7d57de3f68bf3c,0x3f6912ae3f7d7474
.quad 0x3f7ff0e33f721352,0x3f5389c73f756d97,0x3f7eb0693f791298,0x3f37c6553f6816a8,0x3f799b433f7dabcc,0x3f16999f3f55b993,0x3f70c5013f7fd397,0x3ee1fb6a3f3ebc1b
.quad 0x3e0cec4a3dfab273,0x3e2bf8043e1c76de,0x3eb3dca53ea09ae5,0x3ed97cb93ec6d529,0x3f0c42c93efc5d27,0x3f269de33f19c200,0x3f37c6553f273656,0x3f546b3b3f46e22a
.quad 0x3f5a5ba03f49d112,0x3f72d4eb3f6816a8,0x3f7254703f64aa59,0x3f7fa6e33f7b61fc,0x3f7e868b3f76ba07,0x3f79f35e3f7f9c18,0x3f7e5a383f7f4e6d,0x3f62241a3f748422
.quad 0x3f71d19f3f7e1324,0x3f39f2ac3f5ac450,0x3f5988ad3f731447,0x3f0448893f33e7bc,0x3f36ad7f3f5ebe05,0x3e8a11f73f0242b1,0x3f0af1b73f41d870,0x3b490fc63e919ddd
.quad 0x3eb0eacb3f1d7fd1,0xbe870ada3d2fe007,0x3e06b26e3ee63375,0xbf02ef9fbe4dee60,0xbdb5f8da3e888e93,0xbf38dd65beddbe79,0xbe9c1faf3d96a905,0xbf61668abf239da9
.quad 0x3e4ada4f3e3b6ecf,0x3e698bba3e5a3997,0x3efdbabb3eebcbbb,0x3f102dd53f07a136,0x3f3e35c53f32c8c9,0x3f52a6493f48d8b3,0x3f6a5ad93f604621,0x3f78e3d63f7294f8
.quad 0x3f7ed7d43f7a7302,0x3f7dc68c3f7ff4e6,0x3f799b433f7f0e58,0x3f60a6cf3f6f6830,0x3f5b2c793f6db293,0x3f256bcb3f42de29,0x3f269de33f47de65,0x3ea80b1f3eff17b2
.quad 0x3ec27b553f10d3cd,0xbd0a342f3e354098,0x3d9064b43e9aa086,0xbec8477cbe28defc,0xbe7bdba43c490e90,0xbf3238aabef9a02d,0xbf099f4ebe8e9a22,0xbf686b39bf40d0da
.quad 0xbf466354bf0b9a6b,0xbf7f7808bf6e46be,0xbf6f20b0bf43e200,0xbf74484bbf7fe129,0xbf7fba9ebf6b4b0c,0xbf485bcabf73913f,0xbf76841bbf7e70b0,0xbf019573bf4ac77f
.quad 0x3600000036000000,0x3600000036000000,0x35ffcbe235fff84a,0x35fefcc935ff7808,0x35ff2f9d35ffe129,0x35fbf53135fde0b1,0x35fe2b7235ffba9e,0x35f6ef5b35fb3bab
.quad 0x35fcbfc935ff84ab,0x35eff57335f78bc5,0x35faed3735ff3f54,0x35e7159935f2d4eb,0x35f8b47b35feea9d,0x35dc61c735ed1c1d,0x35f6167a35fe868b,0x35cfefa835e66771
.quad 0x35f3144735fe1324,0x35c1d87035debe05,0x35efaf1b35fd906e,0x35b238aa35d627fe,0x35ebe85835fcfe73,0x35a12ff935ccae79,0x35e7c18735fc5d3a,0x358ee0db35c25b89
.quad 0x35e33c5a35fbaccd,0x3576e0cb35b73a23,0x35de5aa635faed37,0x354e0bea35ab561b,0x35d91e6a35fa1e84,0x352395c5359ebc12,0x35d389c735f940c0,0x34efa8b23591796b
.quad 0x3600000036000000,0x3600000036000000,0x35fd906e35fe5a38,0x35fb87b235fc9f8a,0x35f64d9735f96e4e,0x35ee46be35f294f8,0x35ea5ad935f14c7a,0x35d8b3a135e2241a
.quad 0x35d9f26a35e60f88,0x35bb8f3b35cbbbf8,0x35c5643935d7dc7f,0x3597de1235aff3e6,0x35ad146935c6e22a,0x355dbe79358f8784,0x3591796b35b3587a,0x350402703556a399
.quad 0x35663375359d7fd1,0x3416a90535088e93,0x3525129f3585a02c,0xb467fa9a345b7d37,0x34c19b373558106b,0xb517a117b3e21469,0x33d5880e35221887,0xb56ff7fbb4dd4b1a
.quad 0xb42fb68034d41501,0xb59ff6cbb53e1d4a,0xb4e36c8334427c39,0xb5c25b89b5844889,0xb53554ecb316c9b6,0xb5ddf6beb5a6050a,0xb5758035b486b26e,0xb5f1d19fb5c36051
.quad 0x3600000036000000,0x3600000036000000,0x35f8e3d635fa4910,0x35f5a67b35f7583a,0x35e3f47335e96591,0x35d7702635ddf6be,0x35c25b8935ce1689,0x35a7ce6135b592e7
.quad 0x3595f6d935a99415,0x355536413580e7e4,0x35427b55357afef7,0x349324ca35070ada,0x349c76de3517a117,0xb49008b732490f88,0xb42973ba3435f8da,0xb553c867b500f8c0
.quad 0xb5209ae5b47ab273,0xb5a73656b57c5d27,0xb586f686b5280b1f,0xb5d70348b5b3587a,0xb5b6206cb584f484,0xb5f56d97b5dc61c7,0xb5db2c79b5aff3e6,0xb5ffffb1b5f6841b
.quad 0xb5f40bddb5d31849,0xb5f5dec6b5fffb11,0xb5ff5ce9b5ecd007,0xb5d7dc7fb5f822d1,0xb5fc7eb0b5fbf531,0xb5a86605b5df8327,0xb5eb99fbb5ffdaaf,0xb556a399b5b7c655
.quad 0x3600000036000000,0x3600000036000000,0x35f1d19f35f3ced9,0x35ed67a135efaf1b,0x35c8d8b335d064af,0x35b8521635c0d0da,0x35899f4e3599210f,0x3550eb2a3572bd43
.quad 0x34ec9a7f35268f12,0x3396c32c3489cf86,0xb44efdb7332fea69,0xb52df73cb4e36c83,0xb558106bb5119ddd,0xb5aac082b58cead0,0xb5b238aab5902dd5,0xb5e5b710b5cf0417
.quad 0xb5e4aa59b5c9d112,0xb5ff4e6db5f6ba07,0xb5fdc68cb5f03b37,0xb5f3ced9b5fefcc9,0xb5fac516b5ffc38f,0xb5c4e3f5b5e6becc,0xb5dbfb34b5f6ef5b,0xb572bd43b5b11722
.quad 0xb5a4d225b5d695e5,0xb461bc2eb549b953,0xb536ccc3b5a1cbfb,0x350a11f7b3bc6dd5,0xb37b49bab53b31a0,0x359c420c351d9e78,0x351920feb403db0a,0x35dcc7d1359f599f
.quad 0x0,0x0,0x33a351cb32fb514b,0x3435f8da3403db0a,0x3423308c337b49ba,0x34b5409834839502,0x347475c033bc6dd5,0x35070ada34c4b0b9
.quad 0x34a2abb633fb2b74,0x353263ef35027dc0,0x34cada4f341cecf9,0x355c53c135221887,0x34f2b651343c3ac3,0x358242b13541071e,0x350d17c0345b7d37,0x359553b7355f28a9
.quad 0x35209ae5347ab273,0x35a73656357c5d27,0x3533dca5348cec4a,0x35b7c655358c42c9,0x3546d529349c76de,0x35c6e22a3599c200,0x35597cb934abf804,0x35d46b3b35a69de3
.quad 0x356bcbbb34bb6ecf,0x35e0462135b2c8c9,0x357dbabb34cada4f,0x35ea5ad935be35c5,0x3587a13634da3997,0x35f294f835c8d8b3,0x35902dd534e98bba,0x35f8e3d635d2a649
.quad 0x0,0x0,0x348cec4a3467fa9a,0x34be853e34a5c58c,0x350b950734e67c66,0x353b31a0352395c5,0x354e0bea352b0201,0x35884b92356ff7fb
.quad 0x35864b823560924f,0x35ae3bde359b02c6,0x35a302d335899f4e,0x35ce168935b9f2ac,0x35bca00335a12ff9,0x35e6becc35d3fac3,0x35d2a64935b6ad7f,0x35f7583a35e86b39
.quad 0x35e4aa5935c9d112,0x35ff4e6d35f6ba07,0x35f2547035da5ba0,0x35fe5a3835fe868b,0x35fb61fc35e816a8,0x35f4842235ff9c18,0x35ffa6e335f2d4eb,0x35e2241a35f9f35e
.quad 0x35ff0e5835fa7302,0x35c7de6535edb293,0x35f99b4335fed7d4,0x35a69de335db2c79,0x35ef683035fff4e6,0x357f17b235c2de29,0x35e0a6cf35fdc68c,0x35280b1f35a56bcb
.quad 0x0,0x0,0x34efa8b234d7278f,0x35101c2c35040270,0x356900b735525a09,0x358a48ad357f17b2,0x35a69de33597de12,0x35c154e135b4768f
.quad 0x35cf7a1f35bfc767,0x35e8bf3c35dd2d53,0x35ecd00735df20db,0x35fd57de35f6ef5b,0x35fcfe7335f48422,0x35fd747435fffec4,0x35ff1f4935fefcc9,0x35e912ae35f7beb7
.quad 0x35f3144735fe1324,0x35c1d87035debe05,0x35d988ad35f1d19f,0x358af1b735b6ad7f,0x35b3e7bc35dac450,0x35119ddd358242b1,0x3584488935b9f2ac,0x31c90fc6350a11f7
.quad 0x351aa0863590d3cd,0xb50e9a2232c90e90,0x341064b435427b55,0xb5899f4eb4fbdba4,0xb4a8defc34b54098,0xb5c0d0dab579a02d,0xb548477cb38a342f,0xb5e86b39b5b238aa
.quad 0x0,0x0,0x35280b1f351c1faf,0x353f926f3533dca5,0x359ebc123594b039,0x35b1a81d35a86605,0x35d7dc7f35cd26fd,0x35e9b7e435e1668a
.quad 0x35f9129835f21352,0x35ffd39735fdabcc,0x35feb06935fff0e3,0x35f0c50135f99b43,0x35e816a835f56d97,0x35bebc1b35d5b993,0x35b7c65535d389c7,0x3561fb6a3596999f
.quad 0x35663375359d7fd1,0x3416a90535088e93,0x3486b26e3530eacb,0xb51c1fafb435f8da,0xb4cdee6033afe007,0xb5a39da9b55dbe79,0xb582ef9fb5070ada,0xb5e1668ab5b8dd65
.quad 0xb5c3e200b58b9a6b,0xb5fe70b0b5eb4b0c,0xb5ef20b0b5c66354,0xb5f6841bb5ffba9e,0xb5ffe129b5ee46be,0xb5cac77fb5f3913f,0xb5f4484bb5ff7808,0xb5819573b5c85bca
.quad 0x3e953f7500003f80,0x3f463f223f0e3f55,0x3f223f4600003f80,0x3f62bef13f7b3e48,0x3f623ef100003f80,0xbdc9bf7f3f55bf0e,0x3f7f3dc900003f80,0xbf75be953e48bf7b
.quad 0x3f75be9500003f80,0xbf223f46bf0ebf55,0x3f46bf2200003f80,0x3ef13f62bf7bbe48,0x3ef1bf6200003f80,0x3f7fbdc9bf553f0e,0x3dc9bf7f00003f80,0x3e95bf75be483f7b
.quad 0xbe95bf7500003f80,0xbf46bf223f0e3f55,0xbf22bf4600003f80,0xbf623ef13f7b3e48,0xbf62bef100003f80,0x3dc93f7f3f55bf0e,0xbf7fbdc900003f80,0x3f753e953e48bf7b
.quad 0xbf753e9500003f80,0x3f22bf46bf0ebf55,0xbf463f2200003f80,0xbef1bf62bf7bbe48,0xbef13f6200003f80,0xbf7f3dc9bf553f0e,0xbdc93f7f00003f80,0xbe953f75be483f7b
.quad 0x3f7f3dc93f6d3ec4,0x3f62bef13f7bbe48,0xbe95bf753ec4bf6d,0xbf7f3dc9bf55bf0e,0xbf463f22bf6dbec4,0x3f753e953e483f7b,0x3f623ef1bec43f6d,0xbf46bf223f0ebf55
.quad 0x3dc9bf7f3f6d3ec4,0x3ef13f62bf7b3e48,0xbf753e953ec4bf6d,0xbdc9bf7f3f553f0e,0x3f223f46bf6dbec4,0xbe953f75be48bf7b,0x3ef1bf62bec43f6d,0x3f22bf46bf0e3f55
.quad 0xbf7fbdc93f6d3ec4,0xbf623ef13f7bbe48,0x3e953f753ec4bf6d,0x3f7fbdc9bf55bf0e,0x3f46bf22bf6dbec4,0xbf75be953e483f7b,0xbf62bef1bec43f6d,0x3f463f223f0ebf55
.quad 0xbdc93f7f3f6d3ec4,0xbef1bf62bf7b3e48,0x3f75be953ec4bf6d,0x3dc93f7f3f553f0e,0xbf22bf46bf6dbec4,0x3e95bf75be48bf7b,0xbef13f62bec43f6d,0xbf223f46bf0e3f55
.quad 0x3ef1bf623f35bf35,0xbdc9bf7f3e48bf7b,0xbdc93f7fbf353f35,0x3f753e953f0e3f55,0xbe95bf753f35bf35,0xbf223f46bf7bbe48,0x3f223f46bf353f35,0xbef1bf623f55bf0e
.quad 0xbf62bef13f35bf35,0x3f7fbdc9be483f7b,0x3f7f3dc9bf353f35,0xbe953f75bf0ebf55,0xbf753e953f35bf35,0xbf46bf223f7b3e48,0x3f46bf22bf353f35,0x3f62bef1bf553f0e
.quad 0xbef13f623f35bf35,0x3dc93f7f3e48bf7b,0x3dc9bf7fbf353f35,0xbf75be953f0e3f55,0x3e953f753f35bf35,0x3f22bf46bf7bbe48,0xbf22bf46bf353f35,0x3ef13f623f55bf0e
.quad 0x3f623ef13f35bf35,0xbf7f3dc9be483f7b,0xbf7fbdc9bf353f35,0x3e95bf75bf0ebf55,0x3f75be953f35bf35,0x3f463f223f7b3e48,0xbf463f22bf353f35,0xbf623ef1bf553f0e
.quad 0xbf22bf46bec4bf6d,0xbf75be95bf55bf0e,0x3ef1bf623f6dbec4,0xbf46bf22be48bf7b,0x3f7f3dc93ec43f6d,0xbef1bf623f0ebf55,0x3e953f75bf6d3ec4,0xbdc9bf7f3f7bbe48
.quad 0xbf463f22bec4bf6d,0x3e95bf753f553f0e,0xbf62bef13f6dbec4,0x3f22bf463e483f7b,0x3dc9bf7f3ec43f6d,0x3f62bef1bf0e3f55,0x3f75be95bf6d3ec4,0x3f7fbdc9bf7b3e48
.quad 0x3f223f46bec4bf6d,0x3f753e95bf55bf0e,0xbef13f623f6dbec4,0x3f463f22be48bf7b,0xbf7fbdc93ec43f6d,0x3ef13f623f0ebf55,0xbe95bf75bf6d3ec4,0x3dc93f7f3f7bbe48
.quad 0x3f46bf22bec4bf6d,0xbe953f753f553f0e,0x3f623ef13f6dbec4,0xbf223f463e483f7b,0xbdc93f7f3ec43f6d,0xbf623ef1bf0e3f55,0xbf753e95bf6d3ec4,0xbf7f3dc9bf7b3e48
.quad 0x3f75be953f808000,0x3f22bf463f55bf0e,0x3f46bf223f808000,0xbef1bf623e48bf7b,0x3ef1bf623f808000,0xbf7f3dc9bf0ebf55,0x3dc9bf7f3f808000,0xbe953f75bf7bbe48
.quad 0xbe95bf753f808000,0x3f463f22bf553f0e,0xbf22bf463f808000,0x3f62bef1be483f7b,0xbf62bef13f808000,0xbdc9bf7f3f0e3f55,0xbf7fbdc93f808000,0xbf75be953f7b3e48
.quad 0xbf753e953f808000,0xbf223f463f55bf0e,0xbf463f223f808000,0x3ef13f623e48bf7b,0xbef13f623f808000,0x3f7fbdc9bf0ebf55,0xbdc93f7f3f808000,0x3e95bf75bf7bbe48
.quad 0x3e953f753f808000,0xbf46bf22bf553f0e,0x3f223f463f808000,0xbf623ef1be483f7b,0x3f623ef13f808000,0x3dc93f7f3f0e3f55,0x3f7f3dc93f808000,0x3f753e953f7b3e48
.quad 0x3dc9bf7f3ec4bf6d,0xbef1bf62be48bf7b,0xbf753e95bf6dbec4,0x3dc93f7fbf0e3f55,0x3f223f46bec43f6d,0x3e95bf753f7bbe48,0x3ef1bf623f6d3ec4,0xbf223f46bf55bf0e
.quad 0xbf7fbdc93ec4bf6d,0x3f62bef13e483f7b,0x3e953f75bf6dbec4,0xbf7f3dc93f0ebf55,0x3f46bf22bec43f6d,0x3f753e95bf7b3e48,0xbf62bef13f6d3ec4,0xbf46bf223f553f0e
.quad 0xbdc93f7f3ec4bf6d,0x3ef13f62be48bf7b,0x3f75be95bf6dbec4,0xbdc9bf7fbf0e3f55,0xbf22bf46bec43f6d,0xbe953f753f7bbe48,0xbef13f623f6d3ec4,0x3f22bf46bf55bf0e
.quad 0x3f7f3dc93ec4bf6d,0xbf623ef13e483f7b,0xbe95bf75bf6dbec4,0x3f7fbdc93f0ebf55,0xbf463f22bec43f6d,0xbf75be95bf7b3e48,0x3f623ef13f6d3ec4,0x3f463f223f553f0e
.quad 0xbf62bef1bf35bf35,0xbf7f3dc9bf7bbe48,0x3f7f3dc93f353f35,0x3e95bf753f55bf0e,0xbf753e95bf35bf35,0x3f463f22be483f7b,0x3f46bf223f353f35,0xbf623ef1bf0ebf55
.quad 0xbef13f62bf35bf35,0xbdc9bf7f3f7b3e48,0x3dc9bf7f3f353f35,0x3f753e95bf553f0e,0x3e953f75bf35bf35,0xbf223f463e48bf7b,0xbf22bf463f353f35,0xbef1bf623f0e3f55
.quad 0x3f623ef1bf35bf35,0x3f7fbdc9bf7bbe48,0xbf7fbdc93f353f35,0xbe953f753f55bf0e,0x3f75be95bf35bf35,0xbf46bf22be483f7b,0xbf463f223f353f35,0x3f62bef1bf0ebf55
.quad 0x3ef1bf62bf35bf35,0x3dc93f7f3f7b3e48,0xbdc93f7f3f353f35,0xbf75be95bf553f0e,0xbe95bf75bf35bf35,0x3f22bf463e48bf7b,0x3f223f463f353f35,0x3ef13f623f0e3f55
.quad 0xbf463f22bf6d3ec4,0xbe953f75bf0e3f55,0xbf62bef1bec4bf6d,0xbf223f46bf7b3e48,0x3dc9bf7f3f6dbec4,0xbf623ef1bf55bf0e,0x3f75be953ec43f6d,0xbf7f3dc9be48bf7b
.quad 0x3f223f46bf6d3ec4,0xbf75be953f0ebf55,0xbef13f62bec4bf6d,0xbf46bf223f7bbe48,0xbf7fbdc93f6dbec4,0xbef1bf623f553f0e,0xbe95bf753ec43f6d,0xbdc9bf7f3e483f7b
.quad 0x3f46bf22bf6d3ec4,0x3e95bf75bf0e3f55,0x3f623ef1bec4bf6d,0x3f22bf46bf7b3e48,0xbdc93f7f3f6dbec4,0x3f62bef1bf55bf0e,0xbf753e953ec43f6d,0x3f7fbdc9be48bf7b
.quad 0xbf22bf46bf6d3ec4,0x3f753e953f0ebf55,0x3ef1bf62bec4bf6d,0x3f463f223f7bbe48,0x3f7f3dc93f6dbec4,0x3ef13f623f553f0e,0x3e953f753ec43f6d,0x3dc93f7f3e483f7b
.quad 0x80003f8080003f80,0x80003f8080003f80,0xbf223f46be953f75,0xbf7f3dc9bf623ef1,0xbf7b3e48bf0e3f55,0xbe48bf7bbf55bf0e,0xbf62bef1bf463f22,0x3f75be953dc9bf7f
.quad 0xbec4bf6dbf6d3ec4,0x3ec43f6d3f6dbec4,0x3e95bf75bf7f3dc9,0xbf623ef13f463f22,0x3f55bf0ebf7bbe48,0xbf0ebf55be483f7b,0x3f7f3dc9bf62bef1,0x3f46bf22bf753e95
.quad 0x3f353f35bf35bf35,0x3f353f35bf35bf35,0x3dc93f7fbef1bf62,0xbf223f463e95bf75,0xbf0e3f55be48bf7b,0xbf55bf0e3f7bbe48,0xbf753e953dc9bf7f,0x3ef1bf623f223f46
.quad 0xbf6dbec43ec4bf6d,0x3f6d3ec4bec43f6d,0xbef1bf623f22bf46,0xbe953f75bf7f3dc9,0x3e48bf7b3f55bf0e,0xbf7bbe48bf0ebf55,0x3f46bf223f75be95,0x3dc9bf7f3ef1bf62
.quad 0x80003f8080003f80,0x80003f8080003f80,0xbf46bf22bf75be95,0xbdc9bf7fbef1bf62,0x3f7bbe483f0ebf55,0x3e483f7b3f553f0e,0xbef13f623f223f46,0xbe95bf75bf7fbdc9
.quad 0xbec4bf6dbf6d3ec4,0x3ec43f6d3f6dbec4,0x3f753e95bdc9bf7f,0xbef1bf62bf223f46,0xbf553f0e3f7b3e48,0x3f0e3f553e48bf7b,0x3dc9bf7fbef13f62,0xbf22bf463e953f75
.quad 0x3f353f35bf35bf35,0x3f353f35bf35bf35,0xbf7f3dc93f62bef1,0xbf46bf223f753e95,0x3f0ebf553e483f7b,0x3f553f0ebf7b3e48,0x3e953f75bf7fbdc9,0xbf62bef13f46bf22
.quad 0xbf6dbec43ec4bf6d,0x3f6d3ec4bec43f6d,0x3f62bef13f463f22,0xbf75be95bdc9bf7f,0xbe483f7bbf553f0e,0x3f7b3e483f0e3f55,0xbf22bf46be95bf75,0xbf7fbdc9bf62bef1
.quad 0x80003f8080003f80,0x80003f8080003f80,0x3f22bf463e95bf75,0x3f7fbdc93f62bef1,0xbf7b3e48bf0e3f55,0xbe48bf7bbf55bf0e,0x3f623ef13f46bf22,0xbf753e95bdc93f7f
.quad 0xbec4bf6dbf6d3ec4,0x3ec43f6d3f6dbec4,0xbe953f753f7fbdc9,0x3f62bef1bf46bf22,0x3f55bf0ebf7bbe48,0xbf0ebf55be483f7b,0xbf7fbdc93f623ef1,0xbf463f223f75be95
.quad 0x3f353f35bf35bf35,0x3f353f35bf35bf35,0xbdc9bf7f3ef13f62,0x3f22bf46be953f75,0xbf0e3f55be48bf7b,0xbf55bf0e3f7bbe48,0x3f75be95bdc93f7f,0xbef13f62bf22bf46
.quad 0xbf6dbec43ec4bf6d,0x3f6d3ec4bec43f6d,0x3ef13f62bf223f46,0x3e95bf753f7fbdc9,0x3e48bf7b3f55bf0e,0xbf7bbe48bf0ebf55,0xbf463f22bf753e95,0xbdc93f7fbef13f62
.quad 0x80003f8080003f80,0x80003f8080003f80,0x3f463f223f753e95,0x3dc93f7f3ef13f62,0x3f7bbe483f0ebf55,0x3e483f7b3f553f0e,0x3ef1bf62bf22bf46,0x3e953f753f7f3dc9
.quad 0xbec4bf6dbf6d3ec4,0x3ec43f6d3f6dbec4,0xbf75be953dc93f7f,0x3ef13f623f22bf46,0xbf553f0e3f7b3e48,0x3f0e3f553e48bf7b,0xbdc93f7f3ef1bf62,0x3f223f46be95bf75
.quad 0x3f353f35bf35bf35,0x3f353f35bf35bf35,0x3f7fbdc9bf623ef1,0x3f463f22bf75be95,0x3f0ebf553e483f7b,0x3f553f0ebf7b3e48,0xbe95bf753f7f3dc9,0x3f623ef1bf463f22
.quad 0xbf6dbec43ec4bf6d,0x3f6d3ec4bec43f6d,0xbf623ef1bf46bf22,0x3f753e953dc93f7f,0xbe483f7bbf553f0e,0x3f7b3e483f0e3f55,0x3f223f463e953f75,0x3f7f3dc93f623ef1
.quad 0x3f8000003f800000,0x3f8000003f800000,0x3f463f223f753e95,0x3dc93f7f3ef13f62,0x3e483f7b3f553f0e,0xbf7b3e48bf0e3f55,0xbef13f623f223f46,0xbe95bf75bf7fbdc9
.quad 0xbf6d3ec43ec43f6d,0x3f6dbec4bec4bf6d,0xbf75be953dc93f7f,0x3ef13f623f22bf46,0xbf0ebf55be483f7b,0xbf553f0e3f7b3e48,0x3dc9bf7fbef13f62,0xbf22bf463e953f75
.quad 0x3f35bf35bf353f35,0x3f35bf35bf353f35,0x3f7fbdc9bf623ef1,0x3f463f22bf75be95,0x3f553f0ebf7b3e48,0xbf0e3f55be48bf7b,0x3e953f75bf7fbdc9,0xbf62bef13f46bf22
.quad 0xbec43f6dbf6dbec4,0x3ec4bf6d3f6d3ec4,0xbf623ef1bf46bf22,0x3f753e953dc93f7f,0xbf7bbe48bf0ebf55,0xbe483f7bbf553f0e,0xbf22bf46be95bf75,0xbf7fbdc9bf62bef1
.quad 0x3f8000003f800000,0x3f8000003f800000,0xbf223f46be953f75,0xbf7f3dc9bf623ef1,0xbe48bf7bbf55bf0e,0x3f7bbe483f0ebf55,0x3f623ef13f46bf22,0xbf753e95bdc93f7f
.quad 0xbf6d3ec43ec43f6d,0x3f6dbec4bec4bf6d,0x3e95bf75bf7f3dc9,0xbf623ef13f463f22,0x3f0e3f553e48bf7b,0x3f55bf0ebf7bbe48,0xbf7fbdc93f623ef1,0xbf463f223f75be95
.quad 0x3f35bf35bf353f35,0x3f35bf35bf353f35,0x3dc93f7fbef1bf62,0xbf223f463e95bf75,0xbf55bf0e3f7bbe48,0x3f0ebf553e483f7b,0x3f75be95bdc93f7f,0xbef13f62bf22bf46
.quad 0xbec43f6dbf6dbec4,0x3ec4bf6d3f6d3ec4,0xbef1bf623f22bf46,0xbe953f75bf7f3dc9,0x3f7b3e483f0e3f55,0x3e48bf7b3f55bf0e,0xbf463f22bf753e95,0xbdc93f7fbef13f62
.quad 0x3f8000003f800000,0x3f8000003f800000,0xbf46bf22bf75be95,0xbdc9bf7fbef1bf62,0x3e483f7b3f553f0e,0xbf7b3e48bf0e3f55,0x3ef1bf62bf22bf46,0x3e953f753f7f3dc9
.quad 0xbf6d3ec43ec43f6d,0x3f6dbec4bec4bf6d,0x3f753e95bdc9bf7f,0xbef1bf62bf223f46,0xbf0ebf55be483f7b,0xbf553f0e3f7b3e48,0xbdc93f7f3ef1bf62,0x3f223f46be95bf75
.quad 0x3f35bf35bf353f35,0x3f35bf35bf353f35,0xbf7f3dc93f62bef1,0xbf46bf223f753e95,0x3f553f0ebf7b3e48,0xbf0e3f55be48bf7b,0xbe95bf753f7f3dc9,0x3f623ef1bf463f22
.quad 0xbec43f6dbf6dbec4,0x3ec4bf6d3f6d3ec4,0x3f62bef13f463f22,0xbf75be95bdc9bf7f,0xbf7bbe48bf0ebf55,0xbe483f7bbf553f0e,0x3f223f463e953f75,0x3f7f3dc93f623ef1
.quad 0x3f8000003f800000,0x3f8000003f800000,0x3f22bf463e95bf75,0x3f7fbdc93f62bef1,0xbe48bf7bbf55bf0e,0x3f7bbe483f0ebf55,0xbf62bef1bf463f22,0x3f75be953dc9bf7f
.quad 0xbf6d3ec43ec43f6d,0x3f6dbec4bec4bf6d,0xbe953f753f7fbdc9,0x3f62bef1bf46bf22,0x3f0e3f553e48bf7b,0x3f55bf0ebf7bbe48,0x3f7f3dc9bf62bef1,0x3f46bf22bf753e95
.quad 0x3f35bf35bf353f35,0x3f35bf35bf353f35,0xbdc9bf7f3ef13f62,0x3f22bf46be953f75,0xbf55bf0e3f7bbe48,0x3f0ebf553e483f7b,0xbf753e953dc9bf7f,0x3ef1bf623f223f46
.quad 0xbec43f6dbf6dbec4,0x3ec4bf6d3f6d3ec4,0x3ef13f62bf223f46,0x3e95bf753f7fbdc9,0x3f7b3e483f0e3f55,0x3e48bf7b3f55bf0e,0x3f46bf223f75be95,0x3dc9bf7f3ef1bf62
.quad 0x3f7ff4e63f800000,0x3f7f9c183f7fd397,0x3f7fc38f3f800000,0x3f7de0b13f7f0e58,0x3f7f6ac73f800000,0x3f7ac5163f7dabcc,0x3f7eea9d3f800000,0x3f764d973f7baccd
.quad 0x3f7e43233f800000,0x3f7080663f791298,0x3f7d74743f800000,0x3f6965913f75dec6,0x3f7c7eb03f800000,0x3f6106f23f721352,0x3f7b61fc3f800000,0x3f5770263f6db293
.quad 0x3f7a1e843f800000,0x3f4cae793f68bf3c,0x3f78b47b3f800000,0x3f40d0da3f633c5a,0x3f7724173f800000,0x3f33e7bc3f5d2d53,0x3f756d973f800000,0x3f26050a3f5695e5
.quad 0x3f73913f3f800000,0x3f173c073f4f7a1f,0x3f718f573f800000,0x3f07a1363f47de65,0x3f6f68303f800000,0x3eee94793f3fc767,0x3f6d1c1d3f800000,0x3ecc9b8b3f373a23
.quad 0x3f7eea9d3f7f4e6d,0x3f7de0b13f7e70b0,0x3f7a1e843f7c3b28,0x3f7484223f778bc5,0x3f718f573f76ba07,0x3f63f4733f6b4b0c,0x3f655e0b3f6ed89e,0x3f4cae793f59f26a
.quad 0x3f55b9933f64aa59,0x3f2f61a53f43e200,0x3f42de293f584853,0x3f0cead03f299415,0x3f2d14693f49d112,0x3ecc9b8b3f0b9a6b,0x3f14b0393f396842,0x3e72b6513ed53641
.quad 0x3ef41f073f273656,0x3d8a200a3e8e9a22,0x3ebb31a03f13682a,0xbdd53db93e09cf86,0x3e7ee6e13efc5d27,0xbe8b9507bc490e90,0x3e0395023ecf7bca,0xbeddbe79be22abb6
.quad 0x3bc90f883ea09ae5,0xbf14b039be9aa086,0xbdee38763e605c13,0xbf36206cbee0924f,0xbe72b6513dfab273,0xbf5233c6bf10d3cd,0xbeb554ec3cc90ab0,0xbf6816a8bf2e3bde
.quad 0x3f7c7eb03f7d3aac,0x3f7ac5163f7baccd,0x3f6d1c1d3f710908,0x3f63f4733f68bf3c,0x3f5233c63f5b941a,0x3f3ca0033f47de65,0x3f2d14693f3daef9,0x3f07a1363f1b02c6
.quad 0x3eff17b23f187fc0,0x3e919ddd3ec9b953,0x3e97a1173edae880,0x3c96c9b63e22abb6,0x3da3308c3e78cfcc,0xbe7ee6e1bdafb680,0xbe1008b73d48fb30,0xbeff17b2bea68f12
.quad 0xbeb554ecbe164083,0xbf36206cbf0b9a6b,0xbf0cead0beac7cd4,0xbf5f8327bf3b8f3b,0xbf385216bf039c3d,0xbf78b47bbf604621,0xbf5ac450bf2beb4a,0xbf7fe129bf778bc5
.quad 0xbf7294f8bf4d9f02,0xbf748422bf7ffb11,0xbf7e9bc9bf676bd8,0xbf577026bf791298,0xbf7e4323bf7853f8,0xbf2ac082bf633c5a,0xbf718f57bf7fb10f,0xbee363fabf3fc767
.quad 0x3f78b47b3f79c79d,0x3f764d973f778bc5,0x3f591e6a3f5ebe05,0x3f4cae793f531849,0x3f239da93f3085bb,0x3f07a1363f15f6d9,0x3ebb31a03ee63375,0x3e419b373e8e9a22
.quad 0x3d6214693e2f10a2,0xbe354098bd7b2b74,0xbe8586cebdfab273,0xbf04f484bec9b953,0xbf0cead0becf7bca,0xbf4ac77fbf2e3bde,0xbf48d8b3bf273656,0xbf756d97bf633c5a
.quad 0xbf708066bf584853,0xbf7f2f9dbf7dabcc,0xbf7fe129bf76ba07,0xbf66beccbf7a7302,0xbf756d97bf7fec43,0xbf2f61a5bf59f26a,0xbf5233c6bf731447,0xbec1071ebf1ff6cb
.quad 0xbf19c200bf514d3d,0xbc96c9b6bea68f12,0xbea395c5bf1d7fd1,0x3eaf713a3c490e90,0xbbc90f88beb8442a,0x3f2866053eb263ef,0x3e9d9e78bd96a905,0x3f6282103f24d225
.quad 0x3c96c9b600000000,0x3d6214693d16c32c,0x3d2fe00700000000,0x3e0395023dafb680,0x3d8a200a00000000,0x3e4dee603e09cf86,0x3dbc3ac300000000,0x3e8b95073e3b6ecf
.quad 0x3dee387600000000,0x3eaf713a3e6c9a7f,0x3e1008b700000000,0x3ed25a093e8e9a22,0x3e28defc00000000,0x3ef41f073ea68f12,0x3e419b3700000000,0x3f0a48ad3ebe1d4a
.quad 0x3e5a399700000000,0x3f19c2003ed53641,0x3e72b65100000000,0x3f2866053eebcbbb,0x3e8586ce00000000,0x3f36206c3f00e7e4,0x3e919ddd00000000,0x3f42de293f0b9a6b
.quad 0x3e9d9e7800000000,0x3f4e8d903f15f6d9,0x3ea986c400000000,0x3f591e6a3f1ff6cb,0x3eb554ec00000000,0x3f6282103f299415,0x3ec1071e00000000,0x3f6aab7b3f32c8c9
.quad 0x3dbc3ac33d96a905,0x3e0395023de1bc2e,0x3e5a39973e2f10a2,0x3e97a1173e827dc0,0x3ea986c43e888e93,0x3ee900b73ec9b953,0x3ee363fa3eb8442a,0x3f19c2003f064b82
.quad 0x3f0cead03ee63375,0x3f3a7ca43f24d225,0x3f26050a3f08f59b,0x3f55b9933f3fc767,0x3f3ca0033f1d7fd1,0x3f6aab7b3f5695e5,0x3f5064af3f3085bb,0x3f78b47b3f68bf3c
.quad 0x3f6106f23f41d870,0x3f7f6ac73f75dec6,0x3f6e46be3f514d3d,0x3f7e9bc93f7dabcc,0x3f77f1103f5ebe05,0x3f764d973f7ffb11,0x3f7de0b13f6a09a7,0x3f66becc3f7cbfc9
.quad 0x3f7ffec43f731447,0x3f5064af3f740bdd,0x3f7e43233f79c79d,0x3f33e7bc3f660f88,0x3f78b47b3f7e1324,0x3f121eb03f531849,0x3f6f68303f7fec43,0x3ed8106b3f3b8f3b
.quad 0x3e28defc3e164083,0x3e4dee603e3b6ecf,0x3ec1071e3eac7cd4,0x3ee900b73ed53641,0x3f121eb03f039c3d,0x3f2d14693f1ff6cb,0x3f3ca0033f2beb4a,0x3f591e6a3f4bbbf8
.quad 0x3f5df6be3f4d9f02,0x3f756d973f6b4b0c,0x3f7484223f676bd8,0x3f7ff4e63f7cbfc9,0x3f7f2f9d3f7853f8,0x3f77f1103f7f0e58,0x3f7d74743f7fb10f,0x3f5df6be3f721352
.quad 0x3f6f68303f7d3aac,0x3f33e7bc3f5695e5,0x3f55b9933f710908,0x3ef9a02d3f2e3bde,0x3f31a81d3f5b941a,0x3e72b6513ef6e0cb,0x3f04f4843f3daef9,0xbcfb49ba3e827dc0
.quad 0x3ea395c53f187fc0,0xbe97a1173c490e90,0x3dd53db93edae880,0xbf0a48adbe6c9a7f,0xbdee38763e78cfcc,0xbf3ebc1bbeebcbbb,0xbea986c43d48fb30,0xbf655e0bbf299415
.quad 0x3e72b6513e605c13,0x3e8b95073e827dc0,0x3f07a1363efc5d27,0x3f19c2003f10d3cd,0x3f44e3f53f396842,0x3f591e6a3f4f7a1f,0x3f6e46be3f64aa59,0x3f7b61fc3f75dec6
.quad 0x3f7f9c183f7c3b28,0x3f7bf5313f7f84ab,0x3f7724173f7e1324,0x3f5ac4503f6b4b0c,0x3f55b9933f6a09a7,0x3f1c420c3f3b8f3b,0x3f1ebc123f41d870,0x3e919ddd3eebcbbb
.quad 0x3eaf713a3f08f59b,0xbda3308c3e09cf86,0x3cfb49ba3e888e93,0xbeddbe79be541501,0xbe919dddbcc90ab0,0xbf3a7ca4bf064b82,0xbf121eb0bea09ae5,0xbf6d1c1dbf47de65
.quad 0xbf4cae79bf13682a,0xbf7ff4e6bf721352,0xbf7294f8bf49d112,0xbf708066bf7ffb11,0xbf7ffec4bf6ed89e,0xbf40d0dabf6ff573,0xbf73913fbf7f4e6d,0xbeee9479bf43e200
.quad 0x3600000036000000,0x3600000036000000,0x35ffc38f35fff4e6,0x35feea9d35ff6ac7,0x35ff0e5835ffd397,0x35fbaccd35fdabcc,0x35fde0b135ff9c18,0x35f64d9735fac516
.quad 0x35fc3b2835ff4e6d,0x35eed89e35f6ba07,0x35fa1e8435feea9d,0x35e55e0b35f18f57,0x35f78bc535fe70b0,0x35d9f26a35eb4b0c,0x35f4842235fde0b1,0x35ccae7935e3f473
.quad 0x35f1090835fd3aac,0x35bdaef935db941a,0x35ed1c1d35fc7eb0,0x35ad146935d233c6,0x35e8bf3c35fbaccd,0x359b02c635c7de65,0x35e3f47335fac516,0x3587a13635bca003
.quad 0x35debe0535f9c79d,0x3566337535b085bb,0x35d91e6a35f8b47b,0x353b31a035a39da9,0x35d3184935f78bc5,0x350e9a223595f6d9,0x35ccae7935f64d97,0x34c19b373587a136
.quad 0x3600000036000000,0x3600000036000000,0x35fd747435fe4323,0x35fb61fc35fc7eb0,0x35f5dec635f91298,0x35edb29335f21352,0x35e9659135f08066,0x35d7702635e106f2
.quad 0x35d8485335e4aa59,0x35b9684235c9d112,0x35c2de2935d5b993,0x3594b03935ad1469,0x35a9941535c3e200,0x35553641358b9a6b,0x358cead035af61a5,0x34f2b651354c9b8b
.quad 0x355ae88035987fc0,0x33c8fb3034f8cfcc,0x3517a117357f17b2,0xb49008b73423308c,0x34a2abb63549b953,0xb5268f12b42fb680,0x3316c9b635119ddd,0xb57f17b2b4fee6e1
.quad 0xb47ab27334af10a2,0xb5a73656b54f7bca,0xb50586ce33e21469,0xb5c8d8b3b58cead0,0xb549b953b3fb2b74,0xb5e33c5ab5ae3bde,0xb584f484b4b54098,0xb5f56d97b5cac77f
.quad 0x3600000036000000,0x3600000036000000,0x35f8b47b35fa1e84,0x35f56d9735f72417,0x35e33c5a35e8bf3c,0x35d695e535dd2d53,0x35c0d0da35ccae79,0x35a6050a35b3e7bc
.quad 0x3593682a35a73656,0x354f7bca357c5d27,0x353b31a035741f07,0x3483950234fee6e1,0x3489cf86350e9a22,0xb4a2abb6b2c90e90,0xb4553db9340a200a,0xb55dbe79b50b9507
.quad 0xb52c7cd4b4964083,0xb5abeb4ab5839c3d,0xb58cead0b53554ec,0xb5dac450b5b85216,0xb5bb8f3bb58b9a6b,0xb5f78bc5b5e04621,0xb5df8327b5b6206c,0xb5ffe129b5f8b47b
.quad 0xb5f6ba07b5d84853,0xb5f31447b5ffec43,0xb5ffe129b5f08066,0xb5d233c6b5f56d97,0xb5fa7302b5fdabcc,0xb59ff6cbb5d9f26a,0xb5e6beccb5ff2f9d,0xb541071eb5af61a5
.quad 0x3600000036000000,0x3600000036000000,0x35f18f5735f3913f,0x35ed1c1d35ef6830,0x35c7de6535cf7a1f,0x35b73a2335bfc767,0x3587a13635973c07,0x354c9b8b356e9479
.quad 0x34e05c1335209ae5,0x33490ab0347ab273,0xb46e387632490f88,0xb53554ecb4f2b651,0xb560924fb51aa086,0xb5ae3bdeb590d3cd,0xb5b6206cb594b039,0xb5e816a8b5d233c6
.quad 0xb5e76bd8b5cd9f02,0xb5ffb10fb5f853f8,0xb5fe9bc9b5f294f8,0xb5f18f57b5fe4323,0xb5f91298b5fffb11,0xb5bfc767b5e33c5a,0xb5d77026b5f48422,0xb56363fab5aac082
.quad 0xb59d7fd1b5d14d3d,0xb416a905b538442a,0xb52395c5b599c200,0x351d9e78b2490f88,0x32c90e90b5268f12,0x35a4d225353263ef,0x352f713ab316c9b6,0x35e2821035a86605
.quad 0x0,0x0,0x33afe0073316c9b6,0x343c3ac3340a200a,0x342fb6803396c32c,0x34bb6ecf3489cf86,0x3483950233e21469,0x350b950734cdee60
.quad 0x34af10a23416a905,0x3538442a35088e93,0x34da3997343c3ac3,0x356363fa352986c4,0x35027dc03461bc2e,0x35864b823549b953,0x3517a11734839502,0x3599c200356900b7
.quad 0x352c7cd434964083,0x35abeb4a35839c3d,0x3541071e34a8defc,0x35bca00335921eb0,0x3555364134bb6ecf,0x35cbbbf8359ff6cb,0x356900b734cdee60,0x35d91e6a35ad1469
.quad 0x357c5d2734e05c13,0x35e4aa5935b96842,0x3587a13634f2b651,0x35ee46be35c4e3f5,0x3590d3cd35027dc0,0x35f5dec635cf7a1f,0x3599c200350b9507,0x35fb61fc35d91e6a
.quad 0x0,0x0,0x349008b7346e3876,0x34c19b3734a8defc,0x350e9a2234ec9a7f,0x353e1d4a35268f12,0x35525a09352f713a,0x358a48ad35741f07
.quad 0x3588f59b35663375,0x35b085bb359d7fd1,0x35a6050a358cead0,0x35d064af35bca003,0x35bfc76735a4d225,0x35e8bf3c35d695e5,0x35d5b99335ba7ca4,0x35f8b47b35eaab7b
.quad 0x35e76bd835cd9f02,0x35ffb10f35f853f8,0x35f4842235ddf6be,0x35fd747435ff2f9d,0x35fcbfc935eb4b0c,0x35f2135235ff0e58,0x35fff4e635f56d97,0x35ddf6be35f7f110
.quad 0x35fe132435fc3b28,0x35c1d87035ea09a7,0x35f7241735ff9c18,0x359ebc1235d5b993,0x35eb4b0c35ff84ab,0x356bcbbb35bb8f3b,0x35dac45035fbf531,0x35119ddd359c420c
.quad 0x0,0x0,0x34f2b65134da3997,0x35119ddd350586ce,0x356bcbbb35553641,0x358b9a6b3580e7e4,0x35a866053599c200,0x35c2de2935b6206c
.quad 0x35d14d3d35c1d870,0x35ea09a735debe05,0x35ee46be35e106f2,0x35fde0b135f7f110,0x35fdabcc35f5dec6,0x35fcbfc935fffb11,0x35fe9bc935ff6ac7,0x35e6becc35f64d97
.quad 0x35f1090835fd3aac,0x35bdaef935db941a,0x35d5b99335ef6830,0x3584f48435b1a81d,0x35ae3bde35d695e5,0x35027dc03576e0cb,0x3579a02d35b3e7bc,0xb37b49ba34f2b651
.quad 0x35088e933588f59b,0xb5209ae5b3490ab0,0x337b49ba352f713a,0xb5921eb0b5119ddd,0xb4d415013489cf86,0xb5c7de65b5864b82,0xb55dbe79b423308c,0xb5ed1c1db5ba7ca4
.quad 0x0,0x0,0x352986c4351d9e78,0x3541071e353554ec,0x359ff6cb3595f6d9,0x35b2c8c935a99415,0x35d91e6a35ce8d90,0x35eaab7b35e28210
.quad 0x35f9c79d35f31447,0x35ffec4335fe1324,0x35fe432335fffec4,0x35ef683035f8b47b,0x35e60f8835f40bdd,0x35bb8f3b35d31849,0x35b3e7bc35d064af,0x3558106b35921eb0
.quad 0x355ae88035987fc0,0x33c8fb3034f8cfcc,0x34553db9352395c5,0xb52986c4b46e3876,0xb4ec9a7f32c90e90,0xb5a99415b56bcbbb,0xb58a48adb517a117,0xb5e55e0bb5bebc1b
.quad 0xb5c9d112b593682a,0xb5ff4e6db5eed89e,0xb5f294f8b5ccae79,0xb5f3913fb5fffec4,0xb5fffb11b5f21352,0xb5c3e200b5eff573,0xb5f08066b5fff4e6,0xb56e9479b5c0d0da
.quad 0x3eac3f7100003f80,0x3f5c3f043f223f46,0x3f2c3f3e00003f80,0x3f4ebf183f7f3dc9,0x3f673edb00003f80,0xbe79bf783f46bf22,0x3f803d4900003f80,0xbf7dbe163dc9bf7f
.quad 0x3f71beac00003f80,0xbf043f5cbf22bf46,0x3f3ebf2c00003f80,0x3f183f4ebf7fbdc9,0x3edbbf6700003f80,0x3f78be79bf463f22,0x3d49bf8000003f80,0x3e16bf7dbdc93f7f
.quad 0xbeacbf7100003f80,0xbf5cbf043f223f46,0xbf2cbf3e00003f80,0xbf4e3f183f7f3dc9,0xbf67bedb00003f80,0x3e793f783f46bf22,0xbf80bd4900003f80,0x3f7d3e163dc9bf7f
.quad 0xbf713eac00003f80,0x3f04bf5cbf22bf46,0xbf3e3f2c00003f80,0xbf18bf4ebf7fbdc9,0xbedb3f6700003f80,0xbf783e79bf463f22,0xbd493f8000003f80,0xbe163f7dbdc93f7f
.quad 0x3f7dbe163f7b3e48,0x3f2cbf3e3f62bef1,0xbf04bf5c3e48bf7b,0xbf673edbbf75be95,0xbf183f4ebf7bbe48,0x3f80bd493ef13f62,0x3f783e79be483f7b,0xbf71beac3e95bf75
.quad 0xbe16bf7d3f7b3e48,0x3f3e3f2cbf623ef1,0xbf5c3f043e48bf7b,0xbedbbf673f753e95,0x3f4e3f18bf7bbe48,0x3d493f80bef1bf62,0x3e79bf78be483f7b,0x3eacbf71be953f75
.quad 0xbf7d3e163f7b3e48,0xbf2c3f3e3f62bef1,0x3f043f5c3e48bf7b,0x3f67bedbbf75be95,0x3f18bf4ebf7bbe48,0xbf803d493ef13f62,0xbf78be79be483f7b,0x3f713eac3e95bf75
.quad 0x3e163f7d3f7b3e48,0xbf3ebf2cbf623ef1,0x3f5cbf043e48bf7b,0x3edb3f673f753e95,0xbf4ebf18bf7bbe48,0xbd49bf80bef1bf62,0xbe793f78be483f7b,0xbeac3f71be953f75
.quad 0x3d49bf803ec4bf6d,0xbf18bf4ebe95bf75,0x3eac3f71bec43f6d,0x3f78be793f623ef1,0xbf2cbf3e3ec4bf6d,0xbe163f7dbf753e95,0x3f673edbbec43f6d,0xbf5cbf043ef1bf62
.quad 0xbf80bd493ec4bf6d,0x3f4ebf183e953f75,0x3f71beacbec43f6d,0x3e793f78bf62bef1,0xbf3e3f2c3ec4bf6d,0xbf7dbe163f75be95,0x3edbbf67bec43f6d,0x3f04bf5cbef13f62
.quad 0xbd493f803ec4bf6d,0x3f183f4ebe95bf75,0xbeacbf71bec43f6d,0xbf783e793f623ef1,0x3f2c3f3e3ec4bf6d,0x3e16bf7dbf753e95,0xbf67bedbbec43f6d,0x3f5c3f043ef1bf62
.quad 0x3f803d493ec4bf6d,0xbf4e3f183e953f75,0xbf713eacbec43f6d,0xbe79bf78bf62bef1,0x3f3ebf2c3ec4bf6d,0x3f7d3e163f75be95,0xbedb3f67bec43f6d,0xbf043f5cbef13f62
.quad 0xbf78be79bf55bf0e,0xbf673edbbf7f3dc9,0xbe16bf7d3f0ebf55,0xbf803d49bf46bf22,0x3f5cbf043f553f0e,0xbf71beacbdc9bf7f,0x3f4e3f18bf0e3f55,0xbf3ebf2c3f22bf46
.quad 0xbe793f78bf55bf0e,0xbedbbf673f7fbdc9,0xbf7d3e163f0ebf55,0xbd49bf803f463f22,0xbf04bf5c3f553f0e,0x3eacbf713dc93f7f,0x3f18bf4ebf0e3f55,0x3f2cbf3ebf223f46
.quad 0x3f783e79bf55bf0e,0x3f67bedbbf7f3dc9,0x3e163f7d3f0ebf55,0x3f80bd49bf46bf22,0xbf5c3f043f553f0e,0x3f713eacbdc9bf7f,0xbf4ebf18bf0e3f55,0x3f3e3f2c3f22bf46
.quad 0x3e79bf78bf55bf0e,0x3edb3f673f7fbdc9,0x3f7dbe163f0ebf55,0x3d493f803f463f22,0x3f043f5c3f553f0e,0xbeac3f713dc93f7f,0xbf183f4ebf0e3f55,0xbf2c3f3ebf223f46
.quad 0x3f71beac3f808000,0x3f04bf5c3f46bf22,0x3f3ebf2c3f808000,0xbf18bf4e3dc9bf7f,0x3edbbf673f808000,0xbf783e79bf22bf46,0x3d49bf803f808000,0xbe163f7dbf7fbdc9
.quad 0xbeacbf713f808000,0x3f5c3f04bf463f22,0xbf2cbf3e3f808000,0x3f4ebf18bdc93f7f,0xbf67bedb3f808000,0xbe79bf783f223f46,0xbf80bd493f808000,0xbf7dbe163f7f3dc9
.quad 0xbf713eac3f808000,0xbf043f5c3f46bf22,0xbf3e3f2c3f808000,0x3f183f4e3dc9bf7f,0xbedb3f673f808000,0x3f78be79bf22bf46,0xbd493f803f808000,0x3e16bf7dbf7fbdc9
.quad 0x3eac3f713f808000,0xbf5cbf04bf463f22,0x3f2c3f3e3f808000,0xbf4e3f18bdc93f7f,0x3f673edb3f808000,0x3e793f783f223f46,0x3f803d493f808000,0x3f7d3e163f7f3dc9
.quad 0xbe16bf7d3e48bf7b,0xbf3ebf2cbef1bf62,0xbf5c3f04bf7bbe48,0x3edb3f67be953f75,0x3f4e3f18be483f7b,0xbd49bf803f62bef1,0x3e79bf783f7b3e48,0xbeac3f71bf75be95
.quad 0xbf7d3e163e48bf7b,0x3f2cbf3e3ef13f62,0x3f043f5cbf7bbe48,0xbf673edb3e95bf75,0x3f18bf4ebe483f7b,0x3f80bd49bf623ef1,0xbf78be793f7b3e48,0xbf71beac3f753e95
.quad 0x3e163f7d3e48bf7b,0x3f3e3f2cbef1bf62,0x3f5cbf04bf7bbe48,0xbedbbf67be953f75,0xbf4ebf18be483f7b,0x3d493f803f62bef1,0xbe793f783f7b3e48,0x3eacbf71bf75be95
.quad 0x3f7dbe163e48bf7b,0xbf2c3f3e3ef13f62,0xbf04bf5cbf7bbe48,0x3f67bedb3e95bf75,0xbf183f4ebe483f7b,0xbf803d49bf623ef1,0x3f783e793f7b3e48,0x3f713eac3f753e95
.quad 0xbf80bd49bf6dbec4,0xbf4e3f18bf753e95,0x3f71beac3f6d3ec4,0xbe79bf783ef1bf62,0xbf3e3f2cbf6dbec4,0x3f7d3e163e953f75,0x3edbbf673f6d3ec4,0xbf043f5cbf62bef1
.quad 0xbd493f80bf6dbec4,0xbf18bf4e3f75be95,0xbeacbf713f6d3ec4,0x3f78be79bef13f62,0x3f2c3f3ebf6dbec4,0xbe163f7dbe95bf75,0xbf67bedb3f6d3ec4,0xbf5cbf043f623ef1
.quad 0x3f803d49bf6dbec4,0x3f4ebf18bf753e95,0xbf713eac3f6d3ec4,0x3e793f783ef1bf62,0x3f3ebf2cbf6dbec4,0xbf7dbe163e953f75,0xbedb3f673f6d3ec4,0x3f04bf5cbf62bef1
.quad 0x3d49bf80bf6dbec4,0x3f183f4e3f75be95,0x3eac3f713f6d3ec4,0xbf783e79bef13f62,0xbf2cbf3ebf6dbec4,0x3e16bf7dbe95bf75,0x3f673edb3f6d3ec4,0x3f5c3f043f623ef1
.quad 0xbe793f78bf0e3f55,0x3edb3f673dc93f7f,0xbf7d3e16bf55bf0e,0x3d493f80bf223f46,0xbf04bf5c3f0ebf55,0xbeac3f71bf7f3dc9,0x3f18bf4e3f553f0e,0xbf2c3f3ebf46bf22
.quad 0x3f783e79bf0e3f55,0xbf673edbbdc9bf7f,0x3e163f7dbf55bf0e,0xbf803d493f22bf46,0xbf5c3f043f0ebf55,0xbf71beac3f7fbdc9,0xbf4ebf183f553f0e,0xbf3ebf2c3f463f22
.quad 0x3e79bf78bf0e3f55,0xbedbbf673dc93f7f,0x3f7dbe16bf55bf0e,0xbd49bf80bf223f46,0x3f043f5c3f0ebf55,0x3eacbf71bf7f3dc9,0xbf183f4e3f553f0e,0x3f2cbf3ebf46bf22
.quad 0xbf78be79bf0e3f55,0x3f67bedbbdc9bf7f,0xbe16bf7dbf55bf0e,0x3f80bd493f22bf46,0x3f5cbf043f0ebf55,0x3f713eac3f7fbdc9,0x3f4e3f183f553f0e,0x3f3e3f2c3f463f22
.quad 0x80003f8080003f80,0x80003f8080003f80,0xbf2c3f3ebeac3f71,0xbf803d49bf673edb,0xbf7f3dc9bf223f46,0xbdc9bf7fbf46bf22,0xbf4ebf18bf5c3f04,0x3f7dbe163e79bf78
.quad 0xbe48bf7bbf7b3e48,0x3e483f7b3f7bbe48,0x3f04bf5cbf7dbe16,0xbf783e793f183f4e,0x3f75be95bf62bef1,0xbe95bf75bef13f62,0x3f673edbbf2cbf3e,0x3f71beacbf80bd49
.quad 0x3ec43f6dbec4bf6d,0x3ec43f6dbec4bf6d,0xbeac3f71bd49bf80,0xbf673edb3f2cbf3e,0xbf623ef13e95bf75,0xbef1bf623f753e95,0xbf78be793f18bf4e,0x3f5cbf043e163f7d
.quad 0xbf0ebf553f55bf0e,0x3f0e3f55bf553f0e,0x3e16bf7d3f78be79,0xbf4e3f18bf5cbf04,0x3f46bf223f7f3dc9,0xbf22bf463dc9bf7f,0x3f803d493f673edb,0x3f3ebf2c3f71beac
.quad 0x80003f8080003f80,0x80003f8080003f80,0xbf3ebf2cbf71beac,0xbd49bf80bedbbf67,0x3f7fbdc93f22bf46,0x3dc93f7f3f463f22,0xbf183f4e3f043f5c,0xbe16bf7dbf78be79
.quad 0xbe48bf7bbf7b3e48,0x3e483f7b3f7bbe48,0x3f5c3f043e16bf7d,0xbe79bf78bf4e3f18,0xbf753e953f623ef1,0x3e953f753ef1bf62,0x3edbbf67bf3e3f2c,0xbeacbf71bd493f80
.quad 0x3ec43f6dbec4bf6d,0x3ec43f6dbec4bf6d,0xbf71beac3f80bd49,0xbedbbf673f3e3f2c,0x3f62bef1be953f75,0x3ef13f62bf75be95,0xbe793f78bf4ebf18,0xbf04bf5c3f7dbe16
.quad 0xbf0ebf553f55bf0e,0x3f0e3f55bf553f0e,0x3f7d3e163e793f78,0xbf18bf4e3f04bf5c,0xbf463f22bf7fbdc9,0x3f223f46bdc93f7f,0x3d49bf803edbbf67,0xbf2cbf3ebeacbf71
.quad 0x80003f8080003f80,0x80003f8080003f80,0x3f2cbf3e3eacbf71,0x3f80bd493f67bedb,0xbf7f3dc9bf223f46,0xbdc9bf7fbf46bf22,0x3f4e3f183f5cbf04,0xbf7d3e16be793f78
.quad 0xbe48bf7bbf7b3e48,0x3e483f7b3f7bbe48,0xbf043f5c3f7d3e16,0x3f78be79bf18bf4e,0x3f75be95bf62bef1,0xbe95bf75bef13f62,0xbf67bedb3f2c3f3e,0xbf713eac3f803d49
.quad 0x3ec43f6dbec4bf6d,0x3ec43f6dbec4bf6d,0x3eacbf713d493f80,0x3f67bedbbf2c3f3e,0xbf623ef13e95bf75,0xbef1bf623f753e95,0x3f783e79bf183f4e,0xbf5c3f04be16bf7d
.quad 0xbf0ebf553f55bf0e,0x3f0e3f55bf553f0e,0xbe163f7dbf783e79,0x3f4ebf183f5c3f04,0x3f46bf223f7f3dc9,0xbf22bf463dc9bf7f,0xbf80bd49bf67bedb,0xbf3e3f2cbf713eac
.quad 0x80003f8080003f80,0x80003f8080003f80,0x3f3e3f2c3f713eac,0x3d493f803edb3f67,0x3f7fbdc93f22bf46,0x3dc93f7f3f463f22,0x3f18bf4ebf04bf5c,0x3e163f7d3f783e79
.quad 0xbe48bf7bbf7b3e48,0x3e483f7b3f7bbe48,0xbf5cbf04be163f7d,0x3e793f783f4ebf18,0xbf753e953f623ef1,0x3e953f753ef1bf62,0xbedb3f673f3ebf2c,0x3eac3f713d49bf80
.quad 0x3ec43f6dbec4bf6d,0x3ec43f6dbec4bf6d,0x3f713eacbf803d49,0x3edb3f67bf3ebf2c,0x3f62bef1be953f75,0x3ef13f62bf75be95,0x3e79bf783f4e3f18,0x3f043f5cbf7d3e16
.quad 0xbf0ebf553f55bf0e,0x3f0e3f55bf553f0e,0xbf7dbe16be79bf78,0x3f183f4ebf043f5c,0xbf463f22bf7fbdc9,0x3f223f46bdc93f7f,0xbd493f80bedb3f67,0x3f2c3f3e3eac3f71
.quad 0x3f8000003f800000,0x3f8000003f800000,0x3f3e3f2c3f713eac,0x3d493f803edb3f67,0x3dc93f7f3f463f22,0xbf7f3dc9bf223f46,0xbf183f4e3f043f5c,0xbe16bf7dbf78be79
.quad 0xbf7b3e483e483f7b,0x3f7bbe48be48bf7b,0xbf5cbf04be163f7d,0x3e793f783f4ebf18,0xbe95bf75bef13f62,0xbf753e953f623ef1,0x3edbbf67bf3e3f2c,0xbeacbf71bd493f80
.quad 0x3f6dbec4bf6d3ec4,0x3f6dbec4bf6d3ec4,0x3f713eacbf803d49,0x3edb3f67bf3ebf2c,0x3ef13f62bf75be95,0xbf623ef13e95bf75,0xbe793f78bf4ebf18,0xbf04bf5c3f7dbe16
.quad 0xbf553f0ebf0ebf55,0x3f55bf0e3f0e3f55,0xbf7dbe16be79bf78,0x3f183f4ebf043f5c,0xbf22bf463dc9bf7f,0xbf463f22bf7fbdc9,0x3d49bf803edbbf67,0xbf2cbf3ebeacbf71
.quad 0x3f8000003f800000,0x3f8000003f800000,0xbf2c3f3ebeac3f71,0xbf803d49bf673edb,0xbdc9bf7fbf46bf22,0x3f7fbdc93f22bf46,0x3f4e3f183f5cbf04,0xbf7d3e16be793f78
.quad 0xbf7b3e483e483f7b,0x3f7bbe48be48bf7b,0x3f04bf5cbf7dbe16,0xbf783e793f183f4e,0x3e953f753ef1bf62,0x3f75be95bf62bef1,0xbf67bedb3f2c3f3e,0xbf713eac3f803d49
.quad 0x3f6dbec4bf6d3ec4,0x3f6dbec4bf6d3ec4,0xbeac3f71bd49bf80,0xbf673edb3f2cbf3e,0xbef1bf623f753e95,0x3f62bef1be953f75,0x3f783e79bf183f4e,0xbf5c3f04be16bf7d
.quad 0xbf553f0ebf0ebf55,0x3f55bf0e3f0e3f55,0x3e16bf7d3f78be79,0xbf4e3f18bf5cbf04,0x3f223f46bdc93f7f,0x3f46bf223f7f3dc9,0xbf80bd49bf67bedb,0xbf3e3f2cbf713eac
.quad 0x3f8000003f800000,0x3f8000003f800000,0xbf3ebf2cbf71beac,0xbd49bf80bedbbf67,0x3dc93f7f3f463f22,0xbf7f3dc9bf223f46,0x3f18bf4ebf04bf5c,0x3e163f7d3f783e79
.quad 0xbf7b3e483e483f7b,0x3f7bbe48be48bf7b,0x3f5c3f043e16bf7d,0xbe79bf78bf4e3f18,0xbe95bf75bef13f62,0xbf753e953f623ef1,0xbedb3f673f3ebf2c,0x3eac3f713d49bf80
.quad 0x3f6dbec4bf6d3ec4,0x3f6dbec4bf6d3ec4,0xbf71beac3f80bd49,0xbedbbf673f3e3f2c,0x3ef13f62bf75be95,0xbf623ef13e95bf75,0x3e79bf783f4e3f18,0x3f043f5cbf7d3e16
.quad 0xbf553f0ebf0ebf55,0x3f55bf0e3f0e3f55,0x3f7d3e163e793f78,0xbf18bf4e3f04bf5c,0xbf22bf463dc9bf7f,0xbf463f22bf7fbdc9,0xbd493f80bedb3f67,0x3f2c3f3e3eac3f71
.quad 0x3f8000003f800000,0x3f8000003f800000,0x3f2cbf3e3eacbf71,0x3f80bd493f67bedb,0xbdc9bf7fbf46bf22,0x3f7fbdc93f22bf46,0xbf4ebf18bf5c3f04,0x3f7dbe163e79bf78
.quad 0xbf7b3e483e483f7b,0x3f7bbe48be48bf7b,0xbf043f5c3f7d3e16,0x3f78be79bf18bf4e,0x3e953f753ef1bf62,0x3f75be95bf62bef1,0x3f673edbbf2cbf3e,0x3f71beacbf80bd49
.quad 0x3f6dbec4bf6d3ec4,0x3f6dbec4bf6d3ec4,0x3eacbf713d493f80,0x3f67bedbbf2c3f3e,0xbef1bf623f753e95,0x3f62bef1be953f75,0xbf78be793f18bf4e,0x3f5cbf043e163f7d
.quad 0xbf553f0ebf0ebf55,0x3f55bf0e3f0e3f55,0xbe163f7dbf783e79,0x3f4ebf183f5c3f04,0x3f223f46bdc93f7f,0x3f46bf223f7f3dc9,0x3f803d493f673edb,0x3f3ebf2c3f71beac
.quad 0x3f7ff0e33f800000,0x3f7f78083f7fc38f,0x3f7fba9e3f800000,0x3f7d906e3f7eea9d,0x3f7f5ce93f800000,0x3f7a49103f7d7474,0x3f7ed7d43f800000,0x3f75a67b3f7b61fc
.quad 0x3f7e2b723f800000,0x3f6faf1b3f78b47b,0x3f7d57de3f800000,0x3f686b393f756d97,0x3f7c5d3a3f800000,0x3f5fe4e93f718f57,0x3f7b3bab3f800000,0x3f5627fe3f6d1c1d
.quad 0x3f79f35e3f800000,0x3f4b41fa3f6816a8,0x3f7884863f800000,0x3f3f41fc3f628210,0x3f76ef5b3f800000,0x3f3238aa3f5c61c7,0x3f75341d3f800000,0x3f24381a3f55b993
.quad 0x3f73530e3f800000,0x3f1553b73f4e8d90,0x3f714c7a3f800000,0x3f05a02c3f46e22a,0x3f6f20b03f800000,0x3eea66813f3ebc1b,0x3f6cd0073f800000,0x3ec8477c3f36206c
.quad 0x3f7e868b3f7f0e58,0x3f7d1cdd3f7de0b1,0x3f7940c03f7baccd,0x3f72d4eb3f764d97,0x3f703b373f75dec6,0x3f61668a3f696591,0x3f6398ac3f6db293,0x3f4955213f577026
.quad 0x3f5389c73f633c5a,0x3f2b561b3f40d0da,0x3f404c5c3f5695e5,0x3f084b923f26050a,0x3f2a2a803f47de65,0x3ec27b553f07a136,0x3f11796b3f373a23,0x3e5d4b1a3ecc9b8b
.quad 0x3eed30633f24d225,0x3d3c6dd53e8586ce,0x3eb3dca53f10d3cd,0xbe0077453dee3876,0x3e6fa8b23ef6e0cb,0xbe9620d2bcfb49ba,0x3de7fa9a3ec9b953,0xbee79a5dbe354098
.quad 0xbc16cb583e9aa086,0xbf19210fbea395c5,0xbe06b26e3e541501,0xbf39f2acbee900b7,0xbe80f8c03de1bc2e,0xbf554aa4bf14b039,0xbebca7af3c490e90,0xbf6a5ad9bf31a81d
.quad 0x3f7b3bab3f7c3b28,0x3f78e3d63f7a1e84,0x3f6a5ad93f6ed89e,0x3f5fe4e93f655e0b,0x3f4e16893f584853,0x3f36ad7f3f42de29,0x3f27ce613f396842,0x3f003a063f14b039
.quad 0x3ef2bd433f13682a,0x3e80f8c03ebb31a0,0x3e8a11f73ecf7bca,0xbc7b514b3e039502,0x3d55880e3e605c13,0xbe901c2cbdee3876,0xbe2bf8043cc90ab0,0xbf06f686beb554ec
.quad 0xbec27b55be2f10a2,0xbf3c17d9bf121eb0,0xbf12c39abeb8442a,0xbf6398acbf40d0da,0xbf3d27b8bf08f59b,0xbf7a9c59bf63f473,0xbf5e5aa6bf3085bb,0xbf7f7808bf796e4e
.quad 0xbf74bf62bf514d3d,0xbf71d19fbf7ff4e6,0xbf7f3f54bf6a09a7,0xbf52a649bf772417,0xbf7d57debf79c79d,0xbf24381abf5f8327,0xbf6f20b0bf7fec43,0xbed3c867bf3a7ca4
.quad 0x3f76167a3f778bc5,0x3f72d4eb3f748422,0x3f5389c73f59f26a,0x3f4564393f4cae79,0x3f1ba2993f299415,0x3efafef73f0cead0,0x3ea80b1f3ed53641,0x3e1324ca3e72b651
.quad 0x3c7b514b3e09cf86,0xbe636c83bdd53db9,0xbe9920febe22abb6,0xbf0ee0dbbeddbe79,0xbf1553b7bee0924f,0xbf51c0c2bf36206c,0xbf4f0417bf2e3bde,0xbf788486bf6816a8
.quad 0xbf73ced9bf5d2d53,0xbf7dfa38bf7eea9d,0xbf7ffd39bf791298,0xbf61668abf77f110,0xbf725470bf7f84ab,0xbf269de3bf53fac3,0xbf4c3578bf6ff573,0xbeab0201bf173c07
.quad 0xbf11796bbf4bbbf8,0x3ce22a7abe919ddd,0xbe901c2cbf15f6d9,0x3ec5625c3d621469,0x3d0a342fbea68f12,0x3f3117223ec6d529,0x3eb0eacbbd16c32c,0x3f67c1873f2d1469
.quad 0x3cafea6900000000,0x3d83db0a3d2fe007,0x3d3c6dd500000000,0x3e0cec4a3dbc3ac3,0x3d9064b400000000,0x3e57278f3e1008b7,0x3dc27c3900000000,0x3e901c2c3e419b37
.quad 0x3df475c000000000,0x3eb3dca53e72b651,0x3e1324ca00000000,0x3ed6a3993e919ddd,0x3e2bf80400000000,0x3ef840c83ea986c4,0x3e44b0b900000000,0x3f0c42c93ec1071e
.quad 0x3e5d4b1a00000000,0x3f1ba2993ed8106b,0x3e75c35a00000000,0x3f2a2a803eee9479,0x3e870ada00000000,0x3f37c6553f0242b1,0x3e931f3500000000,0x3f4463373f0cead0
.quad 0x3e9f1cdf00000000,0x3f4fefa83f173c07,0x3eab020100000000,0x3f5a5ba03f212ff9,0x3eb6ccc300000000,0x3f6398ac3f2ac082,0x3ec27b5500000000,0x3f6b99fb3f33e7bc
.quad 0x3ddb7d373dafb680,0x3e195be03e039502,0x3e698bba3e3b6ecf,0x3ea218873e8b9507,0x3eb0eacb3e8e9a22,0x3ef2bd433ed25a09,0x3eea66813ebe1d4a,0x3f1e1e223f0a48ad
.quad 0x3f102dd53eebcbbb,0x3f3e35c53f286605,0x3f28fd413f0b9a6b,0x3f58b3a13f42de29,0x3f3f41fc3f1ff6cb,0x3f6cd0073f591e6a,0x3f52a6493f32c8c9,0x3f79f35e3f6aab7b
.quad 0x3f62df7b3f43e200,0x3f7fba9e3f772417,0x3f6faf1b3f531849,0x3f7dfa383f7e4323,0x3f78e3d63f604621,0x3f74bf623f7fe129,0x3f7e5a383f6b4b0c,0x3f644fac3f7bf531
.quad 0x3f7ffd393f740bdd,0x3f4d26fd3f7294f8,0x3f7dc68c3f7a7302,0x3f2ff3e63f63f473,0x3f77beb73f7e70b0,0x3f0d92813f5064af,0x3f6dfcf23f7ffb11,0x3ece0bea3f385216
.quad 0x3e44b0b93e2f10a2,0x3e6fa8b23e5a3997,0x3ece0bea3eb8442a,0x3ef840c83ee363fa,0x3f17de123f08f59b,0x3f33587a3f26050a,0x3f4154e13f3085bb,0x3f5d924d3f5064af
.quad 0x3f61668a3f514d3d,0x3f77beb73f6e46be,0x3f76841b3f6a09a7,0x3f7ff84a3f7de0b1,0x3f7fa6e33f79c79d,0x3f75a67b3f7e4323,0x3f7c5d3a3f7fec43,0x3f5988ad3f6f6830
.quad 0x3f6cd0073f7c3b28,0x3f2da8593f5233c6,0x3f51c0c23f6ed89e,0x3eea66813f286605,0x3f2c800f3f584853,0x3e5101f13ee900b7,0x3efdbabb3f396842,0xbd83db0a3e667c66
.quad 0x3e9620d23f13682a,0xbea80b1fbc96c9b6,0x3d9cecf93ecf7bca,0xbf11796bbe8586ce,0xbe1324ca3e605c13,0xbf446337bef9a02d,0xbeb6ccc33cc90ab0,0xbf6912aebf2f61a5
.quad 0x3e8d17c03e827dc0,0x3ea218873e97a117,0x3f102dd53f064b82,0x3f2302d33f19c200,0x3f4b41fa3f3fc767,0x3f5f20db3f55b993,0x3f71d19f3f68bf3c,0x3f7d57de3f78b47b
.quad 0x3f7ff84a3f7dabcc,0x3f799b433f7e9bc9,0x3f74484b3f7cbfc9,0x3f546b3b3f66becc,0x3f4fefa83f660f88,0x3f12c39a3f33e7bc,0x3f16999f3f3b8f3b,0x3e75c35a3ed8106b
.quad 0x3e9c1faf3f00e7e4,0xbe0077453dbc3ac3,0xbc16cb583e6c9a7f,0xbef2bd43be7ee6e1,0xbea5129fbd7b2b74,0xbf425b89bf0f8784,0xbf1a6293beb263ef,0xbf714c7abf4e8d90
.quad 0xbf52a649bf1b02c6,0xbf7fe705bf756d97,0xbf75a67bbf4f7a1f,0xbf6c3624bf7f9c18,0xbf7fdaafbf721352,0xbf38dd65bf6be858,0xbf703b37bf7fd397,0xbed97cb9bf3ca003
.quad 0x3600000036000000,0x3600000036000000,0x35ffba9e35fff0e3,0x35fed7d435ff5ce9,0x35feea9d35ffc38f,0x35fb61fc35fd7474,0x35fd906e35ff7808,0x35f5a67b35fa4910
.quad 0x35fbaccd35ff0e58,0x35edb29335f5dec6,0x35f940c035fe868b,0x35e398ac35f03b37,0x35f64d9735fde0b1,0x35d7702635e96591,0x35f2d4eb35fd1cdd,0x35c9552135e1668a
.quad 0x35eed89e35fc3b28,0x35b9684235d84853,0x35ea5ad935fb3bab,0x35a7ce6135ce1689,0x35e55e0b35fa1e84,0x3594b03935c2de29,0x35dfe4e935f8e3d6,0x35803a0635b6ad7f
.quad 0x35d9f26a35f78bc5,0x3555364135a99415,0x35d389c735f6167a,0x35280b1f359ba299,0x35ccae7935f48422,0x34f2b651358cead0,0x35c5643935f2d4eb,0x349324ca357afef7
.quad 0x3600000036000000,0x3600000036000000,0x35fd57de35fe2b72,0x35fb3bab35fc5d3a,0x35f56d9735f8b47b,0x35ed1c1d35f18f57,0x35e86b3935efaf1b,0x35d627fe35dfe4e9
.quad 0x35d695e535e33c5a,0x35b73a2335c7de65,0x35c04c5c35d389c7,0x3591796b35aa2a80,0x35a6050a35c0d0da,0x354c9b8b3587a136,0x35884b9235ab561b,0x34dd4b1a35427b55
.quad 0x354f7bca3593682a,0x33490ab034e05c13,0x350a11f73572bd43,0xb4abf80433d5880e,0x34839502353b31a0,0xb53554ecb46e3876,0xb2fb514b3500f8c0,0xb586f686b5101c2c
.quad 0xb4a2abb63489cf86,0xb5ae3bdeb560924f,0xb51920fe32fb514b,0xb5cf0417b59553b7,0xb55dbe79b4553db9,0xb5e816a8b5b6206c,0xb58ee0dbb4e36c83,0xb5f88486b5d1c0c2
.quad 0x3600000036000000,0x3600000036000000,0x35f8848635f9f35e,0x35f5341d35f6ef5b,0x35e2821035e816a8,0x35d5b99335dc61c7,0x35bf41fc35cb41fa,0x35a4381a35b238aa
.quad 0x3590d3cd35a4d225,0x3549b9533576e0cb,0x3533dca5356d3063,0x3467fa9a34efa8b2,0x346e3876350586ce,0xb4b54098b37b49ba,0xb480774533bc6dd5,0xb5679a5db51620d2
.quad 0xb538442ab4af10a2,0xb5b085bbb588f59b,0xb592c39ab5427b55,0xb5de5aa6b5bd27b8,0xb5c0d0dab5921eb0,0xb5f96e4eb5e3f473,0xb5e398acb5bc17d9,0xb5ff7808b5fa9c59
.quad 0xb5f91298b5dd2d53,0xb5eff573b5ff84ab,0xb5fffd39b5f3ced9,0xb5cc3578b5f25470,0xb5f7f110b5feea9d,0xb5973c07b5d3fac3,0xb5e1668ab5fdfa38,0xb52b0201b5a69de3
.quad 0x3600000036000000,0x3600000036000000,0x35f14c7a35f3530e,0x35ecd00735ef20b0,0x35c6e22a35ce8d90,0x35b6206c35bebc1b,0x3585a02c359553b7,0x3548477c356a6681
.quad 0x34d41501351aa086,0x32c90e903461bc2e,0xb486b26eb296cb58,0xb53ca7afb500f8c0,0xb56900b7b52395c5,0xb5b1a81db594b039,0xb5b9f2acb599210f,0xb5ea5ad9b5d54aa4
.quad 0xb5ea09a7b5d14d3d,0xb5ffec43b5f9c79d,0xb5ff3f54b5f4bf62,0xb5ef20b0b5fd57de,0xb5f72417b5fff4e6,0xb5ba7ca4b5df8327,0xb5d2a649b5f1d19f,0xb553c867b5a4381a
.quad 0xb595f6d9b5cbbbf8,0xb396c32cb5268f12,0xb5101c2cb591796b,0x3530eacb338a342f,0x33e21469b5119ddd,0x35ad14693546d529,0x3545625c33622a7a,0x35e7c18735b11722
.quad 0x0,0x0,0x33bc6dd5332fea69,0x34427c39341064b4,0x343c3ac333afe007,0x34c19b37349008b7,0x348cec4a3403db0a,0x35101c2c34d7278f
.quad 0x34bb6ecf342fb680,0x353e1d4a350e9a22,0x34e98bba345b7d37,0x356a66813530eacb,0x350b950734839502,0x358a48ad35525a09,0x3522188734995be0,0x359e1e223572bd43
.quad 0x3538442a34af10a2,0x35b085bb3588f59b,0x354e0bea34c4b0b9,0x35c154e13597de12,0x356363fa34da3997,0x35d064af35a6050a,0x357840c834efa8b2,0x35dd924d35b3587a
.quad 0x35864b8235027dc0,0x35e8bf3c35bfc767,0x35902dd5350d17c0,0x35f1d19f35cb41fa,0x3599c2003517a117,0x35f8b47b35d5b993,0x35a302d335221887,0x35fd57de35df20db
.quad 0x0,0x0,0x349324ca347475c0,0x34c4b0b934abf804,0x35119ddd34f2b651,0x3541071e352986c4,0x3556a3993533dca5,0x358c42c9357840c8
.quad 0x358b9a6b356bcbbb,0x35b2c8c9359ff6cb,0x35a8fd4135902dd5,0x35d2a64935bf41fc,0x35c2de2935a86605,0x35eaab7b35d91e6a,0x35d8b3a135be35c5,0x35f9f35e35ecd007
.quad 0x35ea09a735d14d3d,0x35ffec4335f9c79d,0x35f6841b35e1668a,0x35fc5d3a35ffa6e3,0x35fde0b135ee46be,0x35ef683035fe4323,0x35fff84a35f7beb7,0x35d988ad35f5a67b
.quad 0x35fcbfc935fdabcc,0x35bb8f3b35e60f88,0x35f4484b35fff84a,0x3596999f35cfefa8,0x35e6becc35fe9bc9,0x3558106b35b3e7bc,0x35d46b3b35f99b43,0x34f5c35a3592c39a
.quad 0x0,0x0,0x34f5c35a34dd4b1a,0x35131f3535070ada,0x356e94793558106b,0x358cead0358242b1,0x35aa2a80359ba299,0x35c4633735b7c655
.quad 0x35d3184935c3e200,0x35eb4b0c35e04621,0x35efaf1b35e2df7b,0x35fe5a3835f8e3d6,0x35fe432335f72417,0x35fbf53135ffe129,0x35fdfa3835ffba9e,0x35e44fac35f4bf62
.quad 0x35eed89e35fc3b28,0x35b9684235d84853,0x35d1c0c235ecd007,0x357dbabb35ac800f,0x35a8660535d233c6,0x34e67c66356900b7,0x356a668135ada859,0xb403db0a34d101f1
.quad 0x34ec9a7f3580e7e4,0xb53263efb3fb2b74,0xb296cb58351c1faf,0xb59a6293b525129f,0xb4fee6e1343c3ac3,0xb5ce8d90b58f8784,0xb572bd43b4807745,0xb5f14c7ab5c25b89
.quad 0x0,0x0,0x352b0201351f1cdf,0x35427b553536ccc3,0x35a12ff935973c07,0x35b3e7bc35aac082,0x35da5ba035cfefa8,0x35eb99fb35e398ac
.quad 0x35fa730235f40bdd,0x35fffb1135fe70b0,0x35fdc68c35fffd39,0x35edfcf235f7beb7,0x35e3f47335f294f8,0x35b8521635d064af,0x35aff3e635cd26fd,0x354e0bea358d9281
.quad 0x354f7bca3593682a,0x33490ab034e05c13,0x341cecf9351620d2,0xb536ccc3b49324ca,0xb50586ceb316c9b6,0xb5af61a5b579a02d,0xb591796bb5280b1f,0xb5e912aeb5c46337
.quad 0xb5cf7a1fb59b02c6,0xb5ffd397b5f21352,0xb5f5a67bb5d2a649,0xb5f03b37b5ffdaaf,0xb5ff9c18b5f56d97,0xb5bca003b5ebe858,0xb5ec3624b5ffe705,0xb5597cb9b5b8dd65
.size TABLE, 94208
.section .rodata,"a"
.p2align 6
.amdhsa_kernel concat_heads__ssm_conv_s4__spectral_gfnet__prompt_kernel
  .amdhsa_next_free_vgpr 248
  .amdhsa_next_free_sgpr 102
  .amdhsa_accum_offset 248
  .amdhsa_group_segment_fixed_size 0
  .amdhsa_kernarg_size 120
  .amdhsa_user_sgpr_count 2
  .amdhsa_user_sgpr_kernarg_segment_ptr 1
  .amdhsa_system_sgpr_workgroup_id_x 1
.end_amdhsa_kernel
```
